```python
import torch

def _softmax(x, axis=-1):
    return torch.softmax(x, dim=axis)
def _gelu(x):
    return torch.nn.functional.gelu(x, approximate="tanh")
def _silu(x):
    return torch.nn.functional.silu(x)
def _sigmoid(x):
    return torch.sigmoid(x)
def _layernorm(x, axis=-1, eps=1e-5):
    m = x.mean(dim=axis, keepdim=True)
    v = x.var(dim=axis, keepdim=True, unbiased=False)
    return (x - m) / torch.sqrt(v + eps)
def _scatter_add(tgt, idx, src, axis=0):
    return tgt.clone().index_add_(axis, idx, src)
def _segment_sum(src, seg, n):
    out = torch.zeros((n,) + src.shape[1:], dtype=src.dtype)
    return out.index_add_(0, seg, src)
def _pad(x, pw):
    flat = tuple(v for pair in reversed(pw) for v in pair)
    return torch.nn.functional.pad(x, flat)

kernel_name = 'parallel_sum__spectral_fnet__swiglu_ffn__prompt'

def setup_inputs():

    _w = (lambda a: (lambda t: t.to(torch.bfloat16) if t.is_floating_point() else t)(torch.as_tensor(a)))
    def _A_setup():
        B, S, D = 1, 2048, 640
        ns = torch.arange(S)[:, None] * torch.arange(S)[None, :]
        nd = torch.arange(D)[:, None] * torch.arange(D)[None, :]
        Ws_re = torch.cos(-2.0 * torch.pi * ns / S).to(float)
        Ws_im = torch.sin(-2.0 * torch.pi * ns / S).to(float)
        Wd_re = torch.cos(-2.0 * torch.pi * nd / D).to(float)
        Wd_im = torch.sin(-2.0 * torch.pi * nd / D).to(float)
        return {
            "x": _w((lambda *s: torch.randn(*s, dtype=torch.bfloat16) * 0.05)(B, S, D)),
            "dft_seq_re": _w(Ws_re),
            "dft_seq_im": _w(Ws_im),
            "dft_hid_re": _w(Wd_re),
            "dft_hid_im": _w(Wd_im),
        }
    _A_in = _A_setup()

    def _B_setup():
        B, S, D, F = 1, 2048, 640, 1536
        return {
            "x": _w((lambda *s: torch.randn(*s, dtype=torch.bfloat16) * 0.05)(B, S, D)),
            "w_gate": _w((lambda *s: torch.randn(*s, dtype=torch.bfloat16) * 0.2)(D, F)),
            "w_up": _w((lambda *s: torch.randn(*s, dtype=torch.bfloat16) * 0.2)(D, F)),
            "w_down": _w((lambda *s: torch.randn(*s, dtype=torch.bfloat16) * 0.2)(F, D)),
        }
    _B_in = _B_setup()

    return {
        "A_x": _A_in["x"],
        "A_dft_seq_re": _A_in["dft_seq_re"],
        "A_dft_seq_im": _A_in["dft_seq_im"],
        "A_dft_hid_re": _A_in["dft_hid_re"],
        "A_dft_hid_im": _A_in["dft_hid_im"],
        "B_x": _B_in["x"],
        "B_w_gate": _B_in["w_gate"],
        "B_w_up": _B_in["w_up"],
        "B_w_down": _B_in["w_down"],
    }

def reference(A_x, A_dft_seq_re, A_dft_seq_im, A_dft_hid_re, A_dft_hid_im, B_x, B_w_gate, B_w_up, B_w_down):
    def _A_ref(x, dft_seq_re, dft_seq_im, dft_hid_re, dft_hid_im):
        a = torch.einsum("bsd,ed->bse", x, dft_hid_re)
        b = torch.einsum("bsd,ed->bse", x, dft_hid_im)
        y = torch.einsum("ts,bse->bte", dft_seq_re, a) - torch.einsum("ts,bse->bte", dft_seq_im, b)
        return y

    def _B_ref(x, w_gate, w_up, w_down):
        g = _silu(x @ w_gate)
        u = x @ w_up
        return (g * u) @ w_down

    x = A_x
    xn = _layernorm(x, axis=-1)
    return x + _A_ref(xn, A_dft_seq_re, A_dft_seq_im, A_dft_hid_re, A_dft_hid_im) + _B_ref(xn, B_w_gate, B_w_up, B_w_down)
```

```asm
; @launch grid=(256,1,1) block=(512,1,1) lds=163840
.amdgcn_target "amdgcn-amd-amdhsa--gfx950"
.text
.globl parallel_sum__spectral_fnet__swiglu_ffn__prompt_kernel
.p2align 8
.type parallel_sum__spectral_fnet__swiglu_ffn__prompt_kernel,@function
parallel_sum__spectral_fnet__swiglu_ffn__prompt_kernel:
    s_load_dwordx2 s[28:29], s[0:1], 0
    s_load_dwordx4 s[36:39], s[0:1], 48
    s_load_dwordx8 s[40:47], s[0:1], 64
    s_load_dwordx4 s[32:35], s[0:1], 24
    s_cmp_ge_u32 s2, 256
    s_cbranch_scc1 L_end
    v_lshrrev_b32 v1, 6, v0
    v_and_b32 v0, 63, v0
    v_readfirstlane_b32 s48, v1
    s_and_b32 s49, s2, 7
    s_lshr_b32 s50, s2, 3
    s_cmp_eq_u32 s48, 7
    s_cbranch_scc0 L_nopf
    s_getpc_b64 s[54:55]
L_pc:
    s_mul_i32 s53, s50, 1792
    v_min_u32 v2, 13, v0
    v_lshl_add_u32 v2, v2, 7, s53
    v_min_u32 v2, L_end-L_pc, v2
    global_load_dword v1, v2, s[54:55]
L_nopf:
    s_mul_i32 s54, s50, 43
    s_lshr_b32 s54, s54, 7
    s_mul_i32 s55, s54, 3
    s_sub_u32 s55, s50, s55
    s_and_b32 s56, s49, 1
    s_lshl_b32 s56, s56, 3
    s_add_u32 s54, s54, s56
    s_lshr_b32 s56, s49, 1
    s_mul_i32 s56, s56, 3
    s_add_u32 s55, s55, s56
    s_cmp_ge_u32 s50, 24
    s_cbranch_scc1 L_notffn
    s_cmp_lt_u32 s48, 2
    s_cbranch_scc1 L_ffn_wl
    s_cmp_lt_u32 s48, 4
    s_cbranch_scc1 L_ffn_xl
    s_branch L_ffn_cons
L_notffn:
    s_and_b32 s54, s50, 3
    s_lshr_b32 s55, s49, 2
    s_lshl_b32 s55, s55, 3
    s_add_u32 s54, s54, s55
    s_and_b32 s55, s49, 1
    s_lshl_b32 s55, s55, 2
    s_add_u32 s54, s54, s55
    s_bfe_u32 s55, s49, 0x10001
    s_bfe_u32 s14, s50, 0x10002
    s_lshl_b32 s15, s54, 1
    s_add_u32 s15, s15, s55
    s_lshl_b32 s15, s15, 1
    s_add_u32 s15, s15, s14
    s_cmp_lt_u32 s48, 4
    s_cbranch_scc1 L_dft_ld
    s_branch L_dft_cons
L_ffn_wl:
    v_lshrrev_b32 v8, 3, v0
    v_bfe_u32 v9, v0, 4, 1
    v_bfe_u32 v10, v0, 1, 2
    v_xor_b32 v10, v10, v9
    v_and_b32 v9, 1, v0
    v_lshlrev_b32 v9, 4, v9
    v_lshl_add_u32 v10, v10, 5, v9
    v_mul_u32_u24 v8, 3072, v8
    v_add_u32 v4, v8, v10
    v_xor_b32 v10, 64, v10
    v_add_u32 v5, v8, v10
    v_add_u32 v5, 24576, v5
    v_add_u32 v6, 49152, v4
    v_add_u32 v7, 49152, v5
    s_mul_i32 s64, s50, 43
    s_lshr_b32 s64, s64, 7
    s_mul_i32 s65, s64, 3
    s_sub_u32 s65, s50, s65
    s_and_b32 s58, s64, 1
    s_mul_i32 s58, s58, 5
    s_lshl_b32 s59, s55, 8
    s_mul_i32 s56, s58, 196608
    s_add_u32 s56, s56, s59
    s_add_u32 s59, s59, 1966080
    s_lshl_b32 s57, s48, 13
    s_mov_b32 s6, 0x280000
    s_mov_b32 s7, 0x20000
    s_mov_b32 s23, 0x20000
    s_waitcnt lgkmcnt(0)
    s_mov_b32 s4, s28
    s_mov_b32 s5, s29
    s_cmp_eq_u32 s48, 0
    s_cselect_b32 s20, s36, s38
    s_cselect_b32 s21, s37, s39
    s_mov_b32 s22, 0x1e0000
    s_add_u32 m0, s57, 0
    s_nop 0
    buffer_load_dwordx4 v4, s[20:23], s56 offen offset:0  lds
    s_add_u32 m0, s57, 1024
    s_nop 0
    buffer_load_dwordx4 v5, s[20:23], s56 offen offset:0  lds
    s_add_u32 m0, s57, 2048
    s_nop 0
    buffer_load_dwordx4 v6, s[20:23], s56 offen offset:0  lds
    s_add_u32 m0, s57, 3072
    s_nop 0
    buffer_load_dwordx4 v7, s[20:23], s56 offen offset:0  lds
    s_add_u32 m0, s57, 3968
    s_nop 0
    buffer_load_dwordx4 v4, s[20:23], s56 offen offset:128  lds
    s_add_u32 m0, s57, 4992
    s_nop 0
    buffer_load_dwordx4 v5, s[20:23], s56 offen offset:128  lds
    s_add_u32 m0, s57, 6016
    s_nop 0
    buffer_load_dwordx4 v6, s[20:23], s56 offen offset:128  lds
    s_add_u32 m0, s57, 7040
    s_nop 0
    buffer_load_dwordx4 v7, s[20:23], s56 offen offset:128  lds
    s_add_u32 s56, s56, 98304
    s_barrier
    s_add_u32 m0, s57, 16384
    s_nop 0
    buffer_load_dwordx4 v4, s[20:23], s56 offen offset:0  lds
    s_add_u32 m0, s57, 17408
    s_nop 0
    buffer_load_dwordx4 v5, s[20:23], s56 offen offset:0  lds
    s_add_u32 m0, s57, 18432
    s_nop 0
    buffer_load_dwordx4 v6, s[20:23], s56 offen offset:0  lds
    s_add_u32 m0, s57, 19456
    s_nop 0
    buffer_load_dwordx4 v7, s[20:23], s56 offen offset:0  lds
    s_add_u32 m0, s57, 20352
    s_nop 0
    buffer_load_dwordx4 v4, s[20:23], s56 offen offset:128  lds
    s_add_u32 m0, s57, 21376
    s_nop 0
    buffer_load_dwordx4 v5, s[20:23], s56 offen offset:128  lds
    s_add_u32 m0, s57, 22400
    s_nop 0
    buffer_load_dwordx4 v6, s[20:23], s56 offen offset:128  lds
    s_add_u32 m0, s57, 23424
    s_nop 0
    buffer_load_dwordx4 v7, s[20:23], s56 offen offset:128  lds
    s_add_u32 s56, s56, 98304
    s_cmp_eq_u32 s56, s59
    s_cselect_b32 s60, 1966080, 0
    s_sub_u32 s56, s56, s60
    s_load_dwordx2 s[12:13], s[46:47], 0x18000
    s_lshr_b32 s51, s50, 2
    s_lshr_b32 s53, s49, 1
    s_lshl_b32 s53, s53, 3
    s_add_u32 s51, s51, s53
    s_and_b32 s52, s50, 3
    s_and_b32 s53, s49, 1
    s_lshl_b32 s53, s53, 2
    s_add_u32 s52, s52, s53
    s_mov_b32 s10, 0xc00000
    s_mov_b32 s11, 0x20000
    s_mov_b32 s18, 0x280000
    s_mov_b32 s19, 0x20000
    s_mov_b32 s8, s46
    s_mov_b32 s9, s47
    s_mov_b32 s16, s42
    s_mov_b32 s17, s43
    s_waitcnt lgkmcnt(0)
    s_add_u32 s12, s12, 1
    s_add_u32 s13, s13, 1
    s_mov_b32 s76, 0
    s_mul_i32 s77, s52, 245760
    s_mul_i32 s53, s76, 5120
    s_add_u32 s77, s77, s53
    s_add_u32 s77, s77, 0x100000
    s_sub_u32 s75, s77, 122880
    s_sub_u32 s76, 24, s76
    s_lshr_b32 s53, s48, 1
    s_mul_i32 s72, s53, 122880
    s_and_b32 s53, s48, 1
    s_sub_i32 s71, s76, s53
    s_mul_i32 s53, s53, 5120
    s_add_u32 s72, s72, s53
    s_add_u32 s73, s72, s75
    s_add_u32 s72, s72, s77
    v_lshlrev_b32 v2, 4, v0
    s_and_b32 s41, s48, 1
    s_lshr_b32 s42, s48, 1
    s_lshl_b32 s38, s51, 9
    s_add_u32 s38, s38, 0x80000
    s_lshl_b32 s43, s41, 1
    s_add_u32 s44, s43, s42
    s_sub_u32 s43, s43, s42
    s_add_u32 s43, s43, 1
    v_and_b32 v217, 15, v0
    v_lshrrev_b32 v218, 4, v0
    s_lshl_b32 s39, s44, 9
    s_add_u32 s39, s39, s51
    s_mul_i32 s39, s39, 1280
    s_mul_i32 s53, s52, 160
    s_add_u32 s39, s39, s53
    s_mul_i32 s40, s48, 3072
    s_add_u32 s40, s40, 151552
    v_add_u32 v219, 0, v0
    v_min_u32 v219, 159, v219
    v_mul_u32_u24 v220, 205, v219
    v_lshrrev_b32 v220, 11, v220
    v_mul_u32_u24 v220, 40800, v220
    v_lshl_add_u32 v228, v219, 4, v220
    v_add_u32 v219, 64, v0
    v_min_u32 v219, 159, v219
    v_mul_u32_u24 v220, 205, v219
    v_lshrrev_b32 v220, 11, v220
    v_mul_u32_u24 v220, 40800, v220
    v_lshl_add_u32 v229, v219, 4, v220
    v_add_u32 v219, 128, v0
    v_min_u32 v219, 159, v219
    v_mul_u32_u24 v220, 205, v219
    v_lshrrev_b32 v220, 11, v220
    v_mul_u32_u24 v220, 40800, v220
    v_lshl_add_u32 v230, v219, 4, v220
    v_mul_u32_u24 v219, 160, v217
    v_and_b32 v220, 1, v218
    v_lshl_add_u32 v219, v220, 4, v219
    v_add_u32 v231, s40, v219
    s_lshr_b32 s45, s52, 2
    s_lshl_b32 s47, s45, 31
    s_or_b32 s47, s47, 0x3a000000
    s_mul_i32 s46, s45, 640
    s_lshl_b32 s45, s45, 1
    s_sub_u32 s45, 1, s45
    s_mul_i32 s53, s52, 80
    v_mul_u32_u24 v222, 163840, v218
    v_and_b32 v227, 7, v0
    v_bfe_u32 v219, v0, 3, 1
    v_lshl_add_u32 v227, v227, 1, v219
    v_add_u32 v219, s53, v227
    v_add_u32 v219, 0, v219
    v_mul_lo_u32 v219, v219, s45
    v_add_u32 v219, s46, v219
    v_and_b32 v220, 1, v219
    v_mul_u32_u24 v220, 81920, v220
    v_add_u32 v220, v220, v222
    v_lshrrev_b32 v221, 1, v219
    v_cmp_eq_u32 vcc, 160, v221
    s_nop 1
    v_cndmask_b32 v221, v221, 0, vcc
    v_lshl_add_u32 v248, v221, 4, v220
    v_cmp_eq_u32 vcc, 0, v219
    v_mov_b32 v221, 0x7ffffff0
    s_nop 0
    v_cndmask_b32 v248, v248, v221, vcc
    v_add_u32 v219, s53, v227
    v_add_u32 v219, 16, v219
    v_mul_lo_u32 v219, v219, s45
    v_add_u32 v219, s46, v219
    v_and_b32 v220, 1, v219
    v_mul_u32_u24 v220, 81920, v220
    v_add_u32 v220, v220, v222
    v_lshrrev_b32 v221, 1, v219
    v_cmp_eq_u32 vcc, 160, v221
    s_nop 1
    v_cndmask_b32 v221, v221, 0, vcc
    v_lshl_add_u32 v249, v221, 4, v220
    v_add_u32 v219, s53, v227
    v_add_u32 v219, 32, v219
    v_mul_lo_u32 v219, v219, s45
    v_add_u32 v219, s46, v219
    v_and_b32 v220, 1, v219
    v_mul_u32_u24 v220, 81920, v220
    v_add_u32 v220, v220, v222
    v_lshrrev_b32 v221, 1, v219
    v_cmp_eq_u32 vcc, 160, v221
    s_nop 1
    v_cndmask_b32 v221, v221, 0, vcc
    v_lshl_add_u32 v250, v221, 4, v220
    v_add_u32 v219, s53, v227
    v_add_u32 v219, 48, v219
    v_mul_lo_u32 v219, v219, s45
    v_add_u32 v219, s46, v219
    v_and_b32 v220, 1, v219
    v_mul_u32_u24 v220, 81920, v220
    v_add_u32 v220, v220, v222
    v_lshrrev_b32 v221, 1, v219
    v_cmp_eq_u32 vcc, 160, v221
    s_nop 1
    v_cndmask_b32 v221, v221, 0, vcc
    v_lshl_add_u32 v251, v221, 4, v220
    v_add_u32 v219, s53, v227
    v_add_u32 v219, 64, v219
    v_mul_lo_u32 v219, v219, s45
    v_add_u32 v219, s46, v219
    v_and_b32 v220, 1, v219
    v_mul_u32_u24 v220, 81920, v220
    v_add_u32 v220, v220, v222
    v_lshrrev_b32 v221, 1, v219
    v_cmp_eq_u32 vcc, 160, v221
    s_nop 1
    v_cndmask_b32 v221, v221, 0, vcc
    v_lshl_add_u32 v252, v221, 4, v220
    s_mul_i32 s45, s45, s51
    s_and_b32 s45, s45, 31
    s_mul_i32 s36, s45, 2560
    s_mul_i32 s37, s42, 1310720
    s_add_u32 s36, s36, s37
    s_add_u32 s36, s36, 0x300000
    s_add_u32 s37, s36, 655360
    s_lshr_b32 s45, s45, 3
    s_lshl_b32 s53, s44, 9
    s_add_u32 s53, s53, s51
    v_lshl_add_u32 v219, v217, 5, s53
    s_lshl_b32 s53, s43, 9
    s_add_u32 s53, s53, s51
    v_lshl_add_u32 v220, v217, 5, s53
    s_sub_u32 s53, 4, s45
    s_and_b32 s53, s53, 3
    s_lshl_b32 s46, s42, 5
    s_add_u32 s53, s53, s46
    v_lshl_add_u32 v221, v218, 2, s53
    v_add_u32 v222, 16, v221
    v_mul_u32_u24 v223, v219, v221
    v_and_b32 v223, 2047, v223
    v_cvt_f32_u32 v223, v223
    v_mul_f32 v223, s47, v223
    v_sin_f32 v224, v223
    v_cos_f32 v223, v223
    v_mul_u32_u24 v225, v219, v222
    v_and_b32 v225, 2047, v225
    v_cvt_f32_u32 v225, v225
    v_mul_f32 v225, s47, v225
    v_sin_f32 v226, v225
    v_cos_f32 v225, v225
    s_nop 0
    v_cvt_pk_bf16_f32 v232, v223, v224
    v_cvt_pk_bf16_f32 v236, v225, v226
    v_mul_u32_u24 v223, v220, v221
    v_and_b32 v223, 2047, v223
    v_cvt_f32_u32 v223, v223
    v_mul_f32 v223, s47, v223
    v_sin_f32 v224, v223
    v_cos_f32 v223, v223
    v_mul_u32_u24 v225, v220, v222
    v_and_b32 v225, 2047, v225
    v_cvt_f32_u32 v225, v225
    v_mul_f32 v225, s47, v225
    v_sin_f32 v226, v225
    v_cos_f32 v225, v225
    s_nop 0
    v_cvt_pk_bf16_f32 v240, v223, v224
    v_cvt_pk_bf16_f32 v244, v225, v226
    s_sub_u32 s53, 5, s45
    s_and_b32 s53, s53, 3
    s_lshl_b32 s46, s42, 5
    s_add_u32 s53, s53, s46
    v_lshl_add_u32 v221, v218, 2, s53
    v_add_u32 v222, 16, v221
    v_mul_u32_u24 v223, v219, v221
    v_and_b32 v223, 2047, v223
    v_cvt_f32_u32 v223, v223
    v_mul_f32 v223, s47, v223
    v_sin_f32 v224, v223
    v_cos_f32 v223, v223
    v_mul_u32_u24 v225, v219, v222
    v_and_b32 v225, 2047, v225
    v_cvt_f32_u32 v225, v225
    v_mul_f32 v225, s47, v225
    v_sin_f32 v226, v225
    v_cos_f32 v225, v225
    s_nop 0
    v_cvt_pk_bf16_f32 v233, v223, v224
    v_cvt_pk_bf16_f32 v237, v225, v226
    v_mul_u32_u24 v223, v220, v221
    v_and_b32 v223, 2047, v223
    v_cvt_f32_u32 v223, v223
    v_mul_f32 v223, s47, v223
    v_sin_f32 v224, v223
    v_cos_f32 v223, v223
    v_mul_u32_u24 v225, v220, v222
    v_and_b32 v225, 2047, v225
    v_cvt_f32_u32 v225, v225
    v_mul_f32 v225, s47, v225
    v_sin_f32 v226, v225
    v_cos_f32 v225, v225
    s_nop 0
    v_cvt_pk_bf16_f32 v241, v223, v224
    v_cvt_pk_bf16_f32 v245, v225, v226
    s_sub_u32 s53, 6, s45
    s_and_b32 s53, s53, 3
    s_lshl_b32 s46, s42, 5
    s_add_u32 s53, s53, s46
    v_lshl_add_u32 v221, v218, 2, s53
    v_add_u32 v222, 16, v221
    v_mul_u32_u24 v223, v219, v221
    v_and_b32 v223, 2047, v223
    v_cvt_f32_u32 v223, v223
    v_mul_f32 v223, s47, v223
    v_sin_f32 v224, v223
    v_cos_f32 v223, v223
    v_mul_u32_u24 v225, v219, v222
    v_and_b32 v225, 2047, v225
    v_cvt_f32_u32 v225, v225
    v_mul_f32 v225, s47, v225
    v_sin_f32 v226, v225
    v_cos_f32 v225, v225
    s_nop 0
    v_cvt_pk_bf16_f32 v234, v223, v224
    v_cvt_pk_bf16_f32 v238, v225, v226
    v_mul_u32_u24 v223, v220, v221
    v_and_b32 v223, 2047, v223
    v_cvt_f32_u32 v223, v223
    v_mul_f32 v223, s47, v223
    v_sin_f32 v224, v223
    v_cos_f32 v223, v223
    v_mul_u32_u24 v225, v220, v222
    v_and_b32 v225, 2047, v225
    v_cvt_f32_u32 v225, v225
    v_mul_f32 v225, s47, v225
    v_sin_f32 v226, v225
    v_cos_f32 v225, v225
    s_nop 0
    v_cvt_pk_bf16_f32 v242, v223, v224
    v_cvt_pk_bf16_f32 v246, v225, v226
    s_sub_u32 s53, 7, s45
    s_and_b32 s53, s53, 3
    s_lshl_b32 s46, s42, 5
    s_add_u32 s53, s53, s46
    v_lshl_add_u32 v221, v218, 2, s53
    v_add_u32 v222, 16, v221
    v_mul_u32_u24 v223, v219, v221
    v_and_b32 v223, 2047, v223
    v_cvt_f32_u32 v223, v223
    v_mul_f32 v223, s47, v223
    v_sin_f32 v224, v223
    v_cos_f32 v223, v223
    v_mul_u32_u24 v225, v219, v222
    v_and_b32 v225, 2047, v225
    v_cvt_f32_u32 v225, v225
    v_mul_f32 v225, s47, v225
    v_sin_f32 v226, v225
    v_cos_f32 v225, v225
    s_nop 0
    v_cvt_pk_bf16_f32 v235, v223, v224
    v_cvt_pk_bf16_f32 v239, v225, v226
    v_mul_u32_u24 v223, v220, v221
    v_and_b32 v223, 2047, v223
    v_cvt_f32_u32 v223, v223
    v_mul_f32 v223, s47, v223
    v_sin_f32 v224, v223
    v_cos_f32 v223, v223
    v_mul_u32_u24 v225, v220, v222
    v_and_b32 v225, 2047, v225
    v_cvt_f32_u32 v225, v225
    v_mul_f32 v225, s47, v225
    v_sin_f32 v226, v225
    v_cos_f32 v225, v225
    s_nop 0
    v_cvt_pk_bf16_f32 v243, v223, v224
    v_cvt_pk_bf16_f32 v247, v225, v226
    s_waitcnt vmcnt(8)
    s_barrier
    s_add_u32 m0, s57, 32768
    s_nop 0
    buffer_load_dwordx4 v4, s[20:23], s56 offen offset:0  lds
    s_add_u32 m0, s57, 33792
    s_nop 0
    buffer_load_dwordx4 v5, s[20:23], s56 offen offset:0  lds
    s_add_u32 m0, s57, 34816
    s_nop 0
    buffer_load_dwordx4 v6, s[20:23], s56 offen offset:0  lds
    s_add_u32 m0, s57, 35840
    s_nop 0
    buffer_load_dwordx4 v7, s[20:23], s56 offen offset:0  lds
    s_add_u32 m0, s57, 36736
    s_nop 0
    buffer_load_dwordx4 v4, s[20:23], s56 offen offset:128  lds
    s_add_u32 m0, s57, 37760
    s_nop 0
    buffer_load_dwordx4 v5, s[20:23], s56 offen offset:128  lds
    s_add_u32 m0, s57, 38784
    s_nop 0
    buffer_load_dwordx4 v6, s[20:23], s56 offen offset:128  lds
    s_add_u32 m0, s57, 39808
    s_nop 0
    buffer_load_dwordx4 v7, s[20:23], s56 offen offset:128  lds
    s_add_u32 s56, s56, 98304
    s_waitcnt vmcnt(8)
    s_barrier
    s_add_u32 m0, s57, 49152
    s_nop 0
    buffer_load_dwordx4 v4, s[20:23], s56 offen offset:0  lds
    s_add_u32 m0, s57, 50176
    s_nop 0
    buffer_load_dwordx4 v5, s[20:23], s56 offen offset:0  lds
    s_add_u32 m0, s57, 51200
    s_nop 0
    buffer_load_dwordx4 v6, s[20:23], s56 offen offset:0  lds
    s_add_u32 m0, s57, 52224
    s_nop 0
    buffer_load_dwordx4 v7, s[20:23], s56 offen offset:0  lds
    s_add_u32 m0, s57, 53120
    s_nop 0
    buffer_load_dwordx4 v4, s[20:23], s56 offen offset:128  lds
    s_add_u32 m0, s57, 54144
    s_nop 0
    buffer_load_dwordx4 v5, s[20:23], s56 offen offset:128  lds
    s_add_u32 m0, s57, 55168
    s_nop 0
    buffer_load_dwordx4 v6, s[20:23], s56 offen offset:128  lds
    s_add_u32 m0, s57, 56192
    s_nop 0
    buffer_load_dwordx4 v7, s[20:23], s56 offen offset:128  lds
    s_add_u32 s56, s56, 98304
    s_cmp_eq_u32 s56, s59
    s_cselect_b32 s60, 1966080, 0
    s_sub_u32 s56, s56, s60
    s_waitcnt vmcnt(8)
    s_barrier
    s_add_u32 m0, s57, 65536
    s_nop 0
    buffer_load_dwordx4 v4, s[20:23], s56 offen offset:0  lds
    s_add_u32 m0, s57, 66560
    s_nop 0
    buffer_load_dwordx4 v5, s[20:23], s56 offen offset:0  lds
    s_add_u32 m0, s57, 67584
    s_nop 0
    buffer_load_dwordx4 v6, s[20:23], s56 offen offset:0  lds
    s_add_u32 m0, s57, 68608
    s_nop 0
    buffer_load_dwordx4 v7, s[20:23], s56 offen offset:0  lds
    s_add_u32 m0, s57, 69504
    s_nop 0
    buffer_load_dwordx4 v4, s[20:23], s56 offen offset:128  lds
    s_add_u32 m0, s57, 70528
    s_nop 0
    buffer_load_dwordx4 v5, s[20:23], s56 offen offset:128  lds
    s_add_u32 m0, s57, 71552
    s_nop 0
    buffer_load_dwordx4 v6, s[20:23], s56 offen offset:128  lds
    s_add_u32 m0, s57, 72576
    s_nop 0
    buffer_load_dwordx4 v7, s[20:23], s56 offen offset:128  lds
    s_add_u32 s56, s56, 98304
    s_waitcnt vmcnt(8)
    s_barrier
    s_add_u32 m0, s57, 81920
    s_nop 0
    buffer_load_dwordx4 v4, s[20:23], s56 offen offset:0  lds
    s_add_u32 m0, s57, 82944
    s_nop 0
    buffer_load_dwordx4 v5, s[20:23], s56 offen offset:0  lds
    s_add_u32 m0, s57, 83968
    s_nop 0
    buffer_load_dwordx4 v6, s[20:23], s56 offen offset:0  lds
    s_add_u32 m0, s57, 84992
    s_nop 0
    buffer_load_dwordx4 v7, s[20:23], s56 offen offset:0  lds
    s_add_u32 m0, s57, 85888
    s_nop 0
    buffer_load_dwordx4 v4, s[20:23], s56 offen offset:128  lds
    s_add_u32 m0, s57, 86912
    s_nop 0
    buffer_load_dwordx4 v5, s[20:23], s56 offen offset:128  lds
    s_add_u32 m0, s57, 87936
    s_nop 0
    buffer_load_dwordx4 v6, s[20:23], s56 offen offset:128  lds
    s_add_u32 m0, s57, 88960
    s_nop 0
    buffer_load_dwordx4 v7, s[20:23], s56 offen offset:128  lds
    s_add_u32 s56, s56, 98304
    s_cmp_eq_u32 s56, s59
    s_cselect_b32 s60, 1966080, 0
    s_sub_u32 s56, s56, s60
    s_waitcnt vmcnt(8)
    s_barrier
    s_add_u32 m0, s57, 0
    s_nop 0
    buffer_load_dwordx4 v4, s[20:23], s56 offen offset:0  lds
    s_add_u32 m0, s57, 1024
    s_nop 0
    buffer_load_dwordx4 v5, s[20:23], s56 offen offset:0  lds
    s_add_u32 m0, s57, 2048
    s_nop 0
    buffer_load_dwordx4 v6, s[20:23], s56 offen offset:0  lds
    s_add_u32 m0, s57, 3072
    s_nop 0
    buffer_load_dwordx4 v7, s[20:23], s56 offen offset:0  lds
    s_add_u32 m0, s57, 3968
    s_nop 0
    buffer_load_dwordx4 v4, s[20:23], s56 offen offset:128  lds
    s_add_u32 m0, s57, 4992
    s_nop 0
    buffer_load_dwordx4 v5, s[20:23], s56 offen offset:128  lds
    s_add_u32 m0, s57, 6016
    s_nop 0
    buffer_load_dwordx4 v6, s[20:23], s56 offen offset:128  lds
    s_add_u32 m0, s57, 7040
    s_nop 0
    buffer_load_dwordx4 v7, s[20:23], s56 offen offset:128  lds
    s_add_u32 s56, s56, 98304
    s_waitcnt vmcnt(8)
    s_barrier
    s_add_u32 m0, s57, 16384
    s_nop 0
    buffer_load_dwordx4 v4, s[20:23], s56 offen offset:0  lds
    s_add_u32 m0, s57, 17408
    s_nop 0
    buffer_load_dwordx4 v5, s[20:23], s56 offen offset:0  lds
    s_add_u32 m0, s57, 18432
    s_nop 0
    buffer_load_dwordx4 v6, s[20:23], s56 offen offset:0  lds
    s_add_u32 m0, s57, 19456
    s_nop 0
    buffer_load_dwordx4 v7, s[20:23], s56 offen offset:0  lds
    s_add_u32 m0, s57, 20352
    s_nop 0
    buffer_load_dwordx4 v4, s[20:23], s56 offen offset:128  lds
    s_add_u32 m0, s57, 21376
    s_nop 0
    buffer_load_dwordx4 v5, s[20:23], s56 offen offset:128  lds
    s_add_u32 m0, s57, 22400
    s_nop 0
    buffer_load_dwordx4 v6, s[20:23], s56 offen offset:128  lds
    s_add_u32 m0, s57, 23424
    s_nop 0
    buffer_load_dwordx4 v7, s[20:23], s56 offen offset:128  lds
    s_add_u32 s56, s56, 98304
    s_cmp_eq_u32 s56, s59
    s_cselect_b32 s60, 1966080, 0
    s_sub_u32 s56, s56, s60
    s_waitcnt vmcnt(8)
    s_barrier
    s_add_u32 m0, s57, 32768
    s_nop 0
    buffer_load_dwordx4 v4, s[20:23], s56 offen offset:0  lds
    s_add_u32 m0, s57, 33792
    s_nop 0
    buffer_load_dwordx4 v5, s[20:23], s56 offen offset:0  lds
    s_add_u32 m0, s57, 34816
    s_nop 0
    buffer_load_dwordx4 v6, s[20:23], s56 offen offset:0  lds
    s_add_u32 m0, s57, 35840
    s_nop 0
    buffer_load_dwordx4 v7, s[20:23], s56 offen offset:0  lds
    s_add_u32 m0, s57, 36736
    s_nop 0
    buffer_load_dwordx4 v4, s[20:23], s56 offen offset:128  lds
    s_add_u32 m0, s57, 37760
    s_nop 0
    buffer_load_dwordx4 v5, s[20:23], s56 offen offset:128  lds
    s_add_u32 m0, s57, 38784
    s_nop 0
    buffer_load_dwordx4 v6, s[20:23], s56 offen offset:128  lds
    s_add_u32 m0, s57, 39808
    s_nop 0
    buffer_load_dwordx4 v7, s[20:23], s56 offen offset:128  lds
    s_add_u32 s56, s56, 98304
    s_add_u32 m0, s57, 49152
    s_nop 0
    buffer_load_dwordx4 v4, s[20:23], s56 offen offset:0  lds
    s_add_u32 m0, s57, 50176
    s_nop 0
    buffer_load_dwordx4 v5, s[20:23], s56 offen offset:0  lds
    s_add_u32 m0, s57, 51200
    s_nop 0
    buffer_load_dwordx4 v6, s[20:23], s56 offen offset:0  lds
    s_add_u32 m0, s57, 52224
    s_nop 0
    buffer_load_dwordx4 v7, s[20:23], s56 offen offset:0  lds
    s_add_u32 m0, s57, 53120
    s_nop 0
    buffer_load_dwordx4 v4, s[20:23], s56 offen offset:128  lds
    s_add_u32 m0, s57, 54144
    s_nop 0
    buffer_load_dwordx4 v5, s[20:23], s56 offen offset:128  lds
    s_add_u32 m0, s57, 55168
    s_nop 0
    buffer_load_dwordx4 v6, s[20:23], s56 offen offset:128  lds
    s_add_u32 m0, s57, 56192
    s_nop 0
    buffer_load_dwordx4 v7, s[20:23], s56 offen offset:128  lds
    s_add_u32 s56, s56, 98304
    s_cmp_eq_u32 s56, s59
    s_cselect_b32 s60, 1966080, 0
    s_sub_u32 s56, s56, s60
    s_waitcnt vmcnt(16)
    s_barrier
    s_add_u32 m0, s57, 65536
    s_nop 0
    buffer_load_dwordx4 v4, s[20:23], s56 offen offset:0  lds
    s_add_u32 m0, s57, 66560
    s_nop 0
    buffer_load_dwordx4 v5, s[20:23], s56 offen offset:0  lds
    s_add_u32 m0, s57, 67584
    s_nop 0
    buffer_load_dwordx4 v6, s[20:23], s56 offen offset:0  lds
    s_add_u32 m0, s57, 68608
    s_nop 0
    buffer_load_dwordx4 v7, s[20:23], s56 offen offset:0  lds
    s_add_u32 m0, s57, 69504
    s_nop 0
    buffer_load_dwordx4 v4, s[20:23], s56 offen offset:128  lds
    s_add_u32 m0, s57, 70528
    s_nop 0
    buffer_load_dwordx4 v5, s[20:23], s56 offen offset:128  lds
    s_add_u32 m0, s57, 71552
    s_nop 0
    buffer_load_dwordx4 v6, s[20:23], s56 offen offset:128  lds
    s_add_u32 m0, s57, 72576
    s_nop 0
    buffer_load_dwordx4 v7, s[20:23], s56 offen offset:128  lds
    s_add_u32 s56, s56, 98304
    s_waitcnt vmcnt(16)
    s_barrier
    s_add_u32 m0, s57, 81920
    s_nop 0
    buffer_load_dwordx4 v4, s[20:23], s56 offen offset:0  lds
    s_add_u32 m0, s57, 82944
    s_nop 0
    buffer_load_dwordx4 v5, s[20:23], s56 offen offset:0  lds
    s_add_u32 m0, s57, 83968
    s_nop 0
    buffer_load_dwordx4 v6, s[20:23], s56 offen offset:0  lds
    s_add_u32 m0, s57, 84992
    s_nop 0
    buffer_load_dwordx4 v7, s[20:23], s56 offen offset:0  lds
    s_add_u32 m0, s57, 85888
    s_nop 0
    buffer_load_dwordx4 v4, s[20:23], s56 offen offset:128  lds
    s_add_u32 m0, s57, 86912
    s_nop 0
    buffer_load_dwordx4 v5, s[20:23], s56 offen offset:128  lds
    s_add_u32 m0, s57, 87936
    s_nop 0
    buffer_load_dwordx4 v6, s[20:23], s56 offen offset:128  lds
    s_add_u32 m0, s57, 88960
    s_nop 0
    buffer_load_dwordx4 v7, s[20:23], s56 offen offset:128  lds
    s_add_u32 s56, s56, 98304
    s_cmp_eq_u32 s56, s59
    s_cselect_b32 s60, 1966080, 0
    s_sub_u32 s56, s56, s60
    s_add_u32 m0, s57, 0
    s_nop 0
    buffer_load_dwordx4 v4, s[20:23], s56 offen offset:0  lds
    s_add_u32 m0, s57, 1024
    s_nop 0
    buffer_load_dwordx4 v5, s[20:23], s56 offen offset:0  lds
    s_add_u32 m0, s57, 2048
    s_nop 0
    buffer_load_dwordx4 v6, s[20:23], s56 offen offset:0  lds
    s_add_u32 m0, s57, 3072
    s_nop 0
    buffer_load_dwordx4 v7, s[20:23], s56 offen offset:0  lds
    s_add_u32 m0, s57, 3968
    s_nop 0
    buffer_load_dwordx4 v4, s[20:23], s56 offen offset:128  lds
    s_add_u32 m0, s57, 4992
    s_nop 0
    buffer_load_dwordx4 v5, s[20:23], s56 offen offset:128  lds
    s_add_u32 m0, s57, 6016
    s_nop 0
    buffer_load_dwordx4 v6, s[20:23], s56 offen offset:128  lds
    s_add_u32 m0, s57, 7040
    s_nop 0
    buffer_load_dwordx4 v7, s[20:23], s56 offen offset:128  lds
    s_add_u32 s56, s56, 98304
    s_waitcnt vmcnt(24)
    s_barrier
    s_add_u32 m0, s57, 16384
    s_nop 0
    buffer_load_dwordx4 v4, s[20:23], s56 offen offset:0  lds
    s_add_u32 m0, s57, 17408
    s_nop 0
    buffer_load_dwordx4 v5, s[20:23], s56 offen offset:0  lds
    s_add_u32 m0, s57, 18432
    s_nop 0
    buffer_load_dwordx4 v6, s[20:23], s56 offen offset:0  lds
    s_add_u32 m0, s57, 19456
    s_nop 0
    buffer_load_dwordx4 v7, s[20:23], s56 offen offset:0  lds
    s_add_u32 m0, s57, 20352
    s_nop 0
    buffer_load_dwordx4 v4, s[20:23], s56 offen offset:128  lds
    s_add_u32 m0, s57, 21376
    s_nop 0
    buffer_load_dwordx4 v5, s[20:23], s56 offen offset:128  lds
    s_add_u32 m0, s57, 22400
    s_nop 0
    buffer_load_dwordx4 v6, s[20:23], s56 offen offset:128  lds
    s_add_u32 m0, s57, 23424
    s_nop 0
    buffer_load_dwordx4 v7, s[20:23], s56 offen offset:128  lds
    s_add_u32 s56, s56, 98304
    s_cmp_eq_u32 s56, s59
    s_cselect_b32 s60, 1966080, 0
    s_sub_u32 s56, s56, s60
    s_waitcnt vmcnt(24)
    s_barrier
    s_add_u32 m0, s57, 32768
    s_nop 0
    buffer_load_dwordx4 v4, s[20:23], s56 offen offset:0  lds
    s_add_u32 m0, s57, 33792
    s_nop 0
    buffer_load_dwordx4 v5, s[20:23], s56 offen offset:0  lds
    s_add_u32 m0, s57, 34816
    s_nop 0
    buffer_load_dwordx4 v6, s[20:23], s56 offen offset:0  lds
    s_add_u32 m0, s57, 35840
    s_nop 0
    buffer_load_dwordx4 v7, s[20:23], s56 offen offset:0  lds
    s_add_u32 m0, s57, 36736
    s_nop 0
    buffer_load_dwordx4 v4, s[20:23], s56 offen offset:128  lds
    s_add_u32 m0, s57, 37760
    s_nop 0
    buffer_load_dwordx4 v5, s[20:23], s56 offen offset:128  lds
    s_add_u32 m0, s57, 38784
    s_nop 0
    buffer_load_dwordx4 v6, s[20:23], s56 offen offset:128  lds
    s_add_u32 m0, s57, 39808
    s_nop 0
    buffer_load_dwordx4 v7, s[20:23], s56 offen offset:128  lds
    s_add_u32 s56, s56, 98304
    s_waitcnt vmcnt(24)
    s_barrier
    s_add_u32 m0, s57, 49152
    s_nop 0
    buffer_load_dwordx4 v4, s[20:23], s56 offen offset:0  lds
    s_add_u32 m0, s57, 50176
    s_nop 0
    buffer_load_dwordx4 v5, s[20:23], s56 offen offset:0  lds
    s_add_u32 m0, s57, 51200
    s_nop 0
    buffer_load_dwordx4 v6, s[20:23], s56 offen offset:0  lds
    s_add_u32 m0, s57, 52224
    s_nop 0
    buffer_load_dwordx4 v7, s[20:23], s56 offen offset:0  lds
    s_add_u32 m0, s57, 53120
    s_nop 0
    buffer_load_dwordx4 v4, s[20:23], s56 offen offset:128  lds
    s_add_u32 m0, s57, 54144
    s_nop 0
    buffer_load_dwordx4 v5, s[20:23], s56 offen offset:128  lds
    s_add_u32 m0, s57, 55168
    s_nop 0
    buffer_load_dwordx4 v6, s[20:23], s56 offen offset:128  lds
    s_add_u32 m0, s57, 56192
    s_nop 0
    buffer_load_dwordx4 v7, s[20:23], s56 offen offset:128  lds
    s_add_u32 s56, s56, 98304
    s_cmp_eq_u32 s56, s59
    s_cselect_b32 s60, 1966080, 0
    s_sub_u32 s56, s56, s60
    s_waitcnt vmcnt(24)
    s_barrier
    s_add_u32 m0, s57, 65536
    s_nop 0
    buffer_load_dwordx4 v4, s[20:23], s56 offen offset:0  lds
    s_add_u32 m0, s57, 66560
    s_nop 0
    buffer_load_dwordx4 v5, s[20:23], s56 offen offset:0  lds
    s_add_u32 m0, s57, 67584
    s_nop 0
    buffer_load_dwordx4 v6, s[20:23], s56 offen offset:0  lds
    s_add_u32 m0, s57, 68608
    s_nop 0
    buffer_load_dwordx4 v7, s[20:23], s56 offen offset:0  lds
    s_add_u32 m0, s57, 69504
    s_nop 0
    buffer_load_dwordx4 v4, s[20:23], s56 offen offset:128  lds
    s_add_u32 m0, s57, 70528
    s_nop 0
    buffer_load_dwordx4 v5, s[20:23], s56 offen offset:128  lds
    s_add_u32 m0, s57, 71552
    s_nop 0
    buffer_load_dwordx4 v6, s[20:23], s56 offen offset:128  lds
    s_add_u32 m0, s57, 72576
    s_nop 0
    buffer_load_dwordx4 v7, s[20:23], s56 offen offset:128  lds
    s_add_u32 s56, s56, 98304
    s_waitcnt vmcnt(24)
    s_barrier
    s_add_u32 m0, s57, 81920
    s_nop 0
    buffer_load_dwordx4 v4, s[20:23], s56 offen offset:0  lds
    s_add_u32 m0, s57, 82944
    s_nop 0
    buffer_load_dwordx4 v5, s[20:23], s56 offen offset:0  lds
    s_add_u32 m0, s57, 83968
    s_nop 0
    buffer_load_dwordx4 v6, s[20:23], s56 offen offset:0  lds
    s_add_u32 m0, s57, 84992
    s_nop 0
    buffer_load_dwordx4 v7, s[20:23], s56 offen offset:0  lds
    s_add_u32 m0, s57, 85888
    s_nop 0
    buffer_load_dwordx4 v4, s[20:23], s56 offen offset:128  lds
    s_add_u32 m0, s57, 86912
    s_nop 0
    buffer_load_dwordx4 v5, s[20:23], s56 offen offset:128  lds
    s_add_u32 m0, s57, 87936
    s_nop 0
    buffer_load_dwordx4 v6, s[20:23], s56 offen offset:128  lds
    s_add_u32 m0, s57, 88960
    s_nop 0
    buffer_load_dwordx4 v7, s[20:23], s56 offen offset:128  lds
    s_add_u32 s56, s56, 98304
    s_cmp_eq_u32 s56, s59
    s_cselect_b32 s60, 1966080, 0
    s_sub_u32 s56, s56, s60
    s_waitcnt vmcnt(24)
    s_barrier
    s_add_u32 m0, s57, 0
    s_nop 0
    buffer_load_dwordx4 v4, s[20:23], s56 offen offset:0  lds
    s_add_u32 m0, s57, 1024
    s_nop 0
    buffer_load_dwordx4 v5, s[20:23], s56 offen offset:0  lds
    s_add_u32 m0, s57, 2048
    s_nop 0
    buffer_load_dwordx4 v6, s[20:23], s56 offen offset:0  lds
    s_add_u32 m0, s57, 3072
    s_nop 0
    buffer_load_dwordx4 v7, s[20:23], s56 offen offset:0  lds
    s_add_u32 m0, s57, 3968
    s_nop 0
    buffer_load_dwordx4 v4, s[20:23], s56 offen offset:128  lds
    s_add_u32 m0, s57, 4992
    s_nop 0
    buffer_load_dwordx4 v5, s[20:23], s56 offen offset:128  lds
    s_add_u32 m0, s57, 6016
    s_nop 0
    buffer_load_dwordx4 v6, s[20:23], s56 offen offset:128  lds
    s_add_u32 m0, s57, 7040
    s_nop 0
    buffer_load_dwordx4 v7, s[20:23], s56 offen offset:128  lds
    s_add_u32 s56, s56, 98304
    s_cmp_le_i32 s71, 14
    s_cselect_b32 s74, s73, s72
    s_add_u32 s74, s74, 71680
    s_add_u32 s78, s74, 4096
    buffer_load_dwordx4 v[128:131], v2, s[8:11], s74 offen offset:0 sc1
    buffer_load_dwordx4 v[132:135], v2, s[8:11], s74 offen offset:1024 sc1
    buffer_load_dwordx4 v[136:139], v2, s[8:11], s74 offen offset:2048 sc1
    buffer_load_dwordx4 v[140:143], v2, s[8:11], s74 offen offset:3072 sc1
    buffer_load_dwordx4 v[144:147], v2, s[8:11], s78 offen offset:0 sc1
    s_cmp_eq_u32 s48, 0
    s_cbranch_scc0 L_wl_t1
    s_waitcnt vmcnt(29)
    s_barrier
    s_add_u32 m0, s57, 16384
    s_nop 0
    buffer_load_dwordx4 v4, s[20:23], s56 offen offset:0  lds
    s_add_u32 m0, s57, 17408
    s_nop 0
    buffer_load_dwordx4 v5, s[20:23], s56 offen offset:0  lds
    s_add_u32 m0, s57, 18432
    s_nop 0
    buffer_load_dwordx4 v6, s[20:23], s56 offen offset:0  lds
    s_add_u32 m0, s57, 19456
    s_nop 0
    buffer_load_dwordx4 v7, s[20:23], s56 offen offset:0  lds
    s_add_u32 m0, s57, 20352
    s_nop 0
    buffer_load_dwordx4 v4, s[20:23], s56 offen offset:128  lds
    s_add_u32 m0, s57, 21376
    s_nop 0
    buffer_load_dwordx4 v5, s[20:23], s56 offen offset:128  lds
    s_add_u32 m0, s57, 22400
    s_nop 0
    buffer_load_dwordx4 v6, s[20:23], s56 offen offset:128  lds
    s_add_u32 m0, s57, 23424
    s_nop 0
    buffer_load_dwordx4 v7, s[20:23], s56 offen offset:128  lds
    s_add_u32 s56, s56, 98304
    s_cmp_eq_u32 s56, s59
    s_cselect_b32 s60, 1966080, 0
    s_sub_u32 s56, s56, s60
    s_cmp_le_u32 s76, 6
    s_cselect_b32 s74, s75, s77
    s_add_u32 m0, 32768, 0
    s_add_u32 s78, s74, 32768
    buffer_load_dwordx4 v2, s[8:11], s78 offen sc1 lds
    s_add_u32 m0, 33792, 0
    s_add_u32 s78, s74, 33792
    buffer_load_dwordx4 v2, s[8:11], s78 offen sc1 lds
    s_add_u32 m0, 34816, 0
    s_add_u32 s78, s74, 34816
    buffer_load_dwordx4 v2, s[8:11], s78 offen sc1 lds
    s_cmp_le_u32 s76, 7
    s_cselect_b32 s74, s75, s77
    s_add_u32 m0, 35840, 0
    s_add_u32 s78, s74, 35840
    buffer_load_dwordx4 v2, s[8:11], s78 offen sc1 lds
    s_add_u32 m0, 36864, 0
    s_add_u32 s78, s74, 36864
    buffer_load_dwordx4 v2, s[8:11], s78 offen sc1 lds
    s_add_u32 m0, 37888, 0
    s_add_u32 s78, s74, 37888
    buffer_load_dwordx4 v2, s[8:11], s78 offen sc1 lds
    s_add_u32 m0, 38912, 0
    s_add_u32 s78, s74, 38912
    buffer_load_dwordx4 v2, s[8:11], s78 offen sc1 lds
    s_add_u32 m0, 39936, 0
    s_add_u32 s78, s74, 39936
    buffer_load_dwordx4 v2, s[8:11], s78 offen sc1 lds
    s_waitcnt vmcnt(37)
    s_barrier
    s_cmp_le_u32 s76, 9
    s_cselect_b32 s74, s75, s77
    s_add_u32 m0, 49152, 0
    s_add_u32 s78, s74, 49152
    buffer_load_dwordx4 v2, s[8:11], s78 offen sc1 lds
    s_add_u32 m0, 50176, 0
    s_add_u32 s78, s74, 50176
    buffer_load_dwordx4 v2, s[8:11], s78 offen sc1 lds
    s_cmp_le_u32 s76, 10
    s_cselect_b32 s74, s75, s77
    s_add_u32 m0, 51200, 0
    s_add_u32 s78, s74, 51200
    buffer_load_dwordx4 v2, s[8:11], s78 offen sc1 lds
    s_add_u32 m0, 52224, 0
    s_add_u32 s78, s74, 52224
    buffer_load_dwordx4 v2, s[8:11], s78 offen sc1 lds
    s_add_u32 m0, 53248, 0
    s_add_u32 s78, s74, 53248
    buffer_load_dwordx4 v2, s[8:11], s78 offen sc1 lds
    s_add_u32 m0, 54272, 0
    s_add_u32 s78, s74, 54272
    buffer_load_dwordx4 v2, s[8:11], s78 offen sc1 lds
    s_add_u32 m0, 55296, 0
    s_add_u32 s78, s74, 55296
    buffer_load_dwordx4 v2, s[8:11], s78 offen sc1 lds
    s_cmp_le_u32 s76, 11
    s_cselect_b32 s74, s75, s77
    s_add_u32 m0, 56320, 0
    s_add_u32 s78, s74, 56320
    buffer_load_dwordx4 v2, s[8:11], s78 offen sc1 lds
    s_waitcnt vmcnt(37)
    s_barrier
    s_cmp_le_u32 s76, 12
    s_cselect_b32 s74, s75, s77
    s_add_u32 m0, 65536, 0
    s_add_u32 s78, s74, 65536
    buffer_load_dwordx4 v2, s[8:11], s78 offen sc1 lds
    s_cmp_le_u32 s76, 13
    s_cselect_b32 s74, s75, s77
    s_add_u32 m0, 66560, 0
    s_add_u32 s78, s74, 66560
    buffer_load_dwordx4 v2, s[8:11], s78 offen sc1 lds
    s_add_u32 m0, 67584, 0
    s_add_u32 s78, s74, 67584
    buffer_load_dwordx4 v2, s[8:11], s78 offen sc1 lds
    s_add_u32 m0, 68608, 0
    s_add_u32 s78, s74, 68608
    buffer_load_dwordx4 v2, s[8:11], s78 offen sc1 lds
    s_add_u32 m0, 69632, 0
    s_add_u32 s78, s74, 69632
    buffer_load_dwordx4 v2, s[8:11], s78 offen sc1 lds
    s_add_u32 m0, 70656, 0
    s_add_u32 s78, s74, 70656
    buffer_load_dwordx4 v2, s[8:11], s78 offen sc1 lds
    s_cmp_le_u32 s76, 0
    s_cselect_b32 s74, s75, s77
    s_add_u32 m0, 71680, 0
    s_add_u32 s78, s74, 122880
    buffer_load_dwordx4 v2, s[8:11], s78 offen sc1 lds
    s_add_u32 m0, 72704, 0
    s_add_u32 s78, s74, 123904
    buffer_load_dwordx4 v2, s[8:11], s78 offen sc1 lds
    s_cmp_le_i32 s71, 16
    s_cselect_b32 s74, s73, s72
    s_add_u32 s74, s74, 81920
    s_add_u32 s78, s74, 4096
    buffer_load_dwordx4 v[148:151], v2, s[8:11], s74 offen offset:0 sc1
    buffer_load_dwordx4 v[152:155], v2, s[8:11], s74 offen offset:1024 sc1
    buffer_load_dwordx4 v[156:159], v2, s[8:11], s74 offen offset:2048 sc1
    buffer_load_dwordx4 v[160:163], v2, s[8:11], s74 offen offset:3072 sc1
    buffer_load_dwordx4 v[164:167], v2, s[8:11], s78 offen offset:0 sc1
    s_waitcnt vmcnt(42)
    s_barrier
    s_cmp_le_u32 s76, 2
    s_cselect_b32 s74, s75, s77
    s_add_u32 m0, 81920, 0
    s_add_u32 s78, s74, 133120
    buffer_load_dwordx4 v2, s[8:11], s78 offen sc1 lds
    s_add_u32 m0, 82944, 0
    s_add_u32 s78, s74, 134144
    buffer_load_dwordx4 v2, s[8:11], s78 offen sc1 lds
    s_add_u32 m0, 83968, 0
    s_add_u32 s78, s74, 135168
    buffer_load_dwordx4 v2, s[8:11], s78 offen sc1 lds
    s_add_u32 m0, 84992, 0
    s_add_u32 s78, s74, 136192
    buffer_load_dwordx4 v2, s[8:11], s78 offen sc1 lds
    s_add_u32 m0, 86016, 0
    s_add_u32 s78, s74, 137216
    buffer_load_dwordx4 v2, s[8:11], s78 offen sc1 lds
    s_cmp_le_u32 s76, 3
    s_cselect_b32 s74, s75, s77
    s_add_u32 m0, 87040, 0
    s_add_u32 s78, s74, 138240
    buffer_load_dwordx4 v2, s[8:11], s78 offen sc1 lds
    s_add_u32 m0, 88064, 0
    s_add_u32 s78, s74, 139264
    buffer_load_dwordx4 v2, s[8:11], s78 offen sc1 lds
    s_add_u32 m0, 89088, 0
    s_add_u32 s78, s74, 140288
    buffer_load_dwordx4 v2, s[8:11], s78 offen sc1 lds
    s_waitcnt vmcnt(37)
    s_barrier
    s_cmp_le_u32 s76, 0
    s_cselect_b32 s74, s75, s77
    s_add_u32 m0, 0, 0
    s_add_u32 s78, s74, 0
    buffer_load_dwordx4 v2, s[8:11], s78 offen sc1 lds
    s_add_u32 m0, 1024, 0
    s_add_u32 s78, s74, 1024
    buffer_load_dwordx4 v2, s[8:11], s78 offen sc1 lds
    s_add_u32 m0, 2048, 0
    s_add_u32 s78, s74, 2048
    buffer_load_dwordx4 v2, s[8:11], s78 offen sc1 lds
    s_add_u32 m0, 3072, 0
    s_add_u32 s78, s74, 3072
    buffer_load_dwordx4 v2, s[8:11], s78 offen sc1 lds
    s_add_u32 m0, 4096, 0
    s_add_u32 s78, s74, 4096
    buffer_load_dwordx4 v2, s[8:11], s78 offen sc1 lds
    s_cmp_le_u32 s76, 1
    s_cselect_b32 s74, s75, s77
    s_add_u32 m0, 5120, 0
    s_add_u32 s78, s74, 5120
    buffer_load_dwordx4 v2, s[8:11], s78 offen sc1 lds
    s_add_u32 m0, 6144, 0
    s_add_u32 s78, s74, 6144
    buffer_load_dwordx4 v2, s[8:11], s78 offen sc1 lds
    s_add_u32 m0, 7168, 0
    s_add_u32 s78, s74, 7168
    buffer_load_dwordx4 v2, s[8:11], s78 offen sc1 lds
    s_cmp_le_i32 s71, 18
    s_cselect_b32 s74, s73, s72
    s_add_u32 s74, s74, 92160
    s_add_u32 s78, s74, 4096
    buffer_load_dwordx4 v[168:171], v2, s[8:11], s74 offen offset:0 sc1
    buffer_load_dwordx4 v[172:175], v2, s[8:11], s74 offen offset:1024 sc1
    buffer_load_dwordx4 v[176:179], v2, s[8:11], s74 offen offset:2048 sc1
    buffer_load_dwordx4 v[180:183], v2, s[8:11], s74 offen offset:3072 sc1
    buffer_load_dwordx4 v[184:187], v2, s[8:11], s78 offen offset:0 sc1
    s_barrier
    s_cmp_le_u32 s76, 3
    s_cselect_b32 s74, s75, s77
    s_add_u32 m0, 16384, 0
    s_add_u32 s78, s74, 16384
    buffer_load_dwordx4 v2, s[8:11], s78 offen sc1 lds
    s_add_u32 m0, 17408, 0
    s_add_u32 s78, s74, 17408
    buffer_load_dwordx4 v2, s[8:11], s78 offen sc1 lds
    s_add_u32 m0, 18432, 0
    s_add_u32 s78, s74, 18432
    buffer_load_dwordx4 v2, s[8:11], s78 offen sc1 lds
    s_add_u32 m0, 19456, 0
    s_add_u32 s78, s74, 19456
    buffer_load_dwordx4 v2, s[8:11], s78 offen sc1 lds
    s_cmp_le_u32 s76, 4
    s_cselect_b32 s74, s75, s77
    s_add_u32 m0, 20480, 0
    s_add_u32 s78, s74, 20480
    buffer_load_dwordx4 v2, s[8:11], s78 offen sc1 lds
    s_add_u32 m0, 21504, 0
    s_add_u32 s78, s74, 21504
    buffer_load_dwordx4 v2, s[8:11], s78 offen sc1 lds
    s_add_u32 m0, 22528, 0
    s_add_u32 s78, s74, 22528
    buffer_load_dwordx4 v2, s[8:11], s78 offen sc1 lds
    s_add_u32 m0, 23552, 0
    s_add_u32 s78, s74, 23552
    buffer_load_dwordx4 v2, s[8:11], s78 offen sc1 lds
    s_cmp_le_i32 s71, 20
    s_cselect_b32 s74, s73, s72
    s_add_u32 s74, s74, 102400
    s_add_u32 s78, s74, 4096
    buffer_load_dwordx4 v[188:191], v2, s[8:11], s74 offen offset:0 sc1
    buffer_load_dwordx4 v[192:195], v2, s[8:11], s74 offen offset:1024 sc1
    buffer_load_dwordx4 v[196:199], v2, s[8:11], s74 offen offset:2048 sc1
    buffer_load_dwordx4 v[200:203], v2, s[8:11], s74 offen offset:3072 sc1
    buffer_load_dwordx4 v[204:207], v2, s[8:11], s78 offen offset:0 sc1
    s_cmp_le_i32 s71, 22
    s_cselect_b32 s74, s73, s72
    s_add_u32 s74, s74, 112640
    s_add_u32 s78, s74, 4096
    buffer_load_dwordx4 v[208:211], v2, s[8:11], s74 offen offset:0 sc1
    buffer_load_dwordx4 v[212:215], v2, s[8:11], s74 offen offset:1024 sc1
    buffer_load_dwordx4 v[216:219], v2, s[8:11], s74 offen offset:2048 sc1
    buffer_load_dwordx4 v[220:223], v2, s[8:11], s74 offen offset:3072 sc1
    buffer_load_dwordx4 v[224:227], v2, s[8:11], s78 offen offset:0 sc1
    s_branch L_p2_help
L_wl_t1:
    s_waitcnt vmcnt(29)
    s_barrier
    s_add_u32 m0, s57, 16384
    s_nop 0
    buffer_load_dwordx4 v4, s[20:23], s56 offen offset:0  lds
    s_add_u32 m0, s57, 17408
    s_nop 0
    buffer_load_dwordx4 v5, s[20:23], s56 offen offset:0  lds
    s_add_u32 m0, s57, 18432
    s_nop 0
    buffer_load_dwordx4 v6, s[20:23], s56 offen offset:0  lds
    s_add_u32 m0, s57, 19456
    s_nop 0
    buffer_load_dwordx4 v7, s[20:23], s56 offen offset:0  lds
    s_add_u32 m0, s57, 20352
    s_nop 0
    buffer_load_dwordx4 v4, s[20:23], s56 offen offset:128  lds
    s_add_u32 m0, s57, 21376
    s_nop 0
    buffer_load_dwordx4 v5, s[20:23], s56 offen offset:128  lds
    s_add_u32 m0, s57, 22400
    s_nop 0
    buffer_load_dwordx4 v6, s[20:23], s56 offen offset:128  lds
    s_add_u32 m0, s57, 23424
    s_nop 0
    buffer_load_dwordx4 v7, s[20:23], s56 offen offset:128  lds
    s_add_u32 s56, s56, 98304
    s_cmp_eq_u32 s56, s59
    s_cselect_b32 s60, 1966080, 0
    s_sub_u32 s56, s56, s60
    s_cmp_le_u32 s76, 8
    s_cselect_b32 s74, s75, s77
    s_add_u32 m0, 40960, 0
    s_add_u32 s78, s74, 40960
    buffer_load_dwordx4 v2, s[8:11], s78 offen sc1 lds
    s_add_u32 m0, 41984, 0
    s_add_u32 s78, s74, 41984
    buffer_load_dwordx4 v2, s[8:11], s78 offen sc1 lds
    s_add_u32 m0, 43008, 0
    s_add_u32 s78, s74, 43008
    buffer_load_dwordx4 v2, s[8:11], s78 offen sc1 lds
    s_add_u32 m0, 44032, 0
    s_add_u32 s78, s74, 44032
    buffer_load_dwordx4 v2, s[8:11], s78 offen sc1 lds
    s_add_u32 m0, 45056, 0
    s_add_u32 s78, s74, 45056
    buffer_load_dwordx4 v2, s[8:11], s78 offen sc1 lds
    s_cmp_le_u32 s76, 9
    s_cselect_b32 s74, s75, s77
    s_add_u32 m0, 46080, 0
    s_add_u32 s78, s74, 46080
    buffer_load_dwordx4 v2, s[8:11], s78 offen sc1 lds
    s_add_u32 m0, 47104, 0
    s_add_u32 s78, s74, 47104
    buffer_load_dwordx4 v2, s[8:11], s78 offen sc1 lds
    s_add_u32 m0, 48128, 0
    s_add_u32 s78, s74, 48128
    buffer_load_dwordx4 v2, s[8:11], s78 offen sc1 lds
    s_waitcnt vmcnt(37)
    s_barrier
    s_cmp_le_u32 s76, 11
    s_cselect_b32 s74, s75, s77
    s_add_u32 m0, 57344, 0
    s_add_u32 s78, s74, 57344
    buffer_load_dwordx4 v2, s[8:11], s78 offen sc1 lds
    s_add_u32 m0, 58368, 0
    s_add_u32 s78, s74, 58368
    buffer_load_dwordx4 v2, s[8:11], s78 offen sc1 lds
    s_add_u32 m0, 59392, 0
    s_add_u32 s78, s74, 59392
    buffer_load_dwordx4 v2, s[8:11], s78 offen sc1 lds
    s_add_u32 m0, 60416, 0
    s_add_u32 s78, s74, 60416
    buffer_load_dwordx4 v2, s[8:11], s78 offen sc1 lds
    s_cmp_le_u32 s76, 12
    s_cselect_b32 s74, s75, s77
    s_add_u32 m0, 61440, 0
    s_add_u32 s78, s74, 61440
    buffer_load_dwordx4 v2, s[8:11], s78 offen sc1 lds
    s_add_u32 m0, 62464, 0
    s_add_u32 s78, s74, 62464
    buffer_load_dwordx4 v2, s[8:11], s78 offen sc1 lds
    s_add_u32 m0, 63488, 0
    s_add_u32 s78, s74, 63488
    buffer_load_dwordx4 v2, s[8:11], s78 offen sc1 lds
    s_add_u32 m0, 64512, 0
    s_add_u32 s78, s74, 64512
    buffer_load_dwordx4 v2, s[8:11], s78 offen sc1 lds
    s_waitcnt vmcnt(37)
    s_barrier
    s_cmp_le_u32 s76, 0
    s_cselect_b32 s74, s75, s77
    s_add_u32 m0, 73728, 0
    s_add_u32 s78, s74, 124928
    buffer_load_dwordx4 v2, s[8:11], s78 offen sc1 lds
    s_add_u32 m0, 74752, 0
    s_add_u32 s78, s74, 125952
    buffer_load_dwordx4 v2, s[8:11], s78 offen sc1 lds
    s_add_u32 m0, 75776, 0
    s_add_u32 s78, s74, 126976
    buffer_load_dwordx4 v2, s[8:11], s78 offen sc1 lds
    s_cmp_le_u32 s76, 1
    s_cselect_b32 s74, s75, s77
    s_add_u32 m0, 76800, 0
    s_add_u32 s78, s74, 128000
    buffer_load_dwordx4 v2, s[8:11], s78 offen sc1 lds
    s_add_u32 m0, 77824, 0
    s_add_u32 s78, s74, 129024
    buffer_load_dwordx4 v2, s[8:11], s78 offen sc1 lds
    s_add_u32 m0, 78848, 0
    s_add_u32 s78, s74, 130048
    buffer_load_dwordx4 v2, s[8:11], s78 offen sc1 lds
    s_add_u32 m0, 79872, 0
    s_add_u32 s78, s74, 131072
    buffer_load_dwordx4 v2, s[8:11], s78 offen sc1 lds
    s_add_u32 m0, 80896, 0
    s_add_u32 s78, s74, 132096
    buffer_load_dwordx4 v2, s[8:11], s78 offen sc1 lds
    s_cmp_le_i32 s71, 16
    s_cselect_b32 s74, s73, s72
    s_add_u32 s74, s74, 81920
    s_add_u32 s78, s74, 4096
    buffer_load_dwordx4 v[148:151], v2, s[8:11], s74 offen offset:0 sc1
    buffer_load_dwordx4 v[152:155], v2, s[8:11], s74 offen offset:1024 sc1
    buffer_load_dwordx4 v[156:159], v2, s[8:11], s74 offen offset:2048 sc1
    buffer_load_dwordx4 v[160:163], v2, s[8:11], s74 offen offset:3072 sc1
    buffer_load_dwordx4 v[164:167], v2, s[8:11], s78 offen offset:0 sc1
    s_waitcnt vmcnt(42)
    s_barrier
    s_cmp_le_u32 s76, 3
    s_cselect_b32 s74, s75, s77
    s_add_u32 m0, 90112, 0
    s_add_u32 s78, s74, 141312
    buffer_load_dwordx4 v2, s[8:11], s78 offen sc1 lds
    s_add_u32 m0, 91136, 0
    s_add_u32 s78, s74, 142336
    buffer_load_dwordx4 v2, s[8:11], s78 offen sc1 lds
    s_cmp_le_u32 s76, 4
    s_cselect_b32 s74, s75, s77
    s_add_u32 m0, 92160, 0
    s_add_u32 s78, s74, 143360
    buffer_load_dwordx4 v2, s[8:11], s78 offen sc1 lds
    s_add_u32 m0, 93184, 0
    s_add_u32 s78, s74, 144384
    buffer_load_dwordx4 v2, s[8:11], s78 offen sc1 lds
    s_add_u32 m0, 94208, 0
    s_add_u32 s78, s74, 145408
    buffer_load_dwordx4 v2, s[8:11], s78 offen sc1 lds
    s_add_u32 m0, 95232, 0
    s_add_u32 s78, s74, 146432
    buffer_load_dwordx4 v2, s[8:11], s78 offen sc1 lds
    s_add_u32 m0, 96256, 0
    s_add_u32 s78, s74, 147456
    buffer_load_dwordx4 v2, s[8:11], s78 offen sc1 lds
    s_cmp_le_u32 s76, 5
    s_cselect_b32 s74, s75, s77
    s_add_u32 m0, 97280, 0
    s_add_u32 s78, s74, 148480
    buffer_load_dwordx4 v2, s[8:11], s78 offen sc1 lds
    s_waitcnt vmcnt(37)
    s_barrier
    s_cmp_le_u32 s76, 1
    s_cselect_b32 s74, s75, s77
    s_add_u32 m0, 8192, 0
    s_add_u32 s78, s74, 8192
    buffer_load_dwordx4 v2, s[8:11], s78 offen sc1 lds
    s_add_u32 m0, 9216, 0
    s_add_u32 s78, s74, 9216
    buffer_load_dwordx4 v2, s[8:11], s78 offen sc1 lds
    s_cmp_le_u32 s76, 2
    s_cselect_b32 s74, s75, s77
    s_add_u32 m0, 10240, 0
    s_add_u32 s78, s74, 10240
    buffer_load_dwordx4 v2, s[8:11], s78 offen sc1 lds
    s_add_u32 m0, 11264, 0
    s_add_u32 s78, s74, 11264
    buffer_load_dwordx4 v2, s[8:11], s78 offen sc1 lds
    s_add_u32 m0, 12288, 0
    s_add_u32 s78, s74, 12288
    buffer_load_dwordx4 v2, s[8:11], s78 offen sc1 lds
    s_add_u32 m0, 13312, 0
    s_add_u32 s78, s74, 13312
    buffer_load_dwordx4 v2, s[8:11], s78 offen sc1 lds
    s_add_u32 m0, 14336, 0
    s_add_u32 s78, s74, 14336
    buffer_load_dwordx4 v2, s[8:11], s78 offen sc1 lds
    s_cmp_le_u32 s76, 3
    s_cselect_b32 s74, s75, s77
    s_add_u32 m0, 15360, 0
    s_add_u32 s78, s74, 15360
    buffer_load_dwordx4 v2, s[8:11], s78 offen sc1 lds
    s_cmp_le_i32 s71, 18
    s_cselect_b32 s74, s73, s72
    s_add_u32 s74, s74, 92160
    s_add_u32 s78, s74, 4096
    buffer_load_dwordx4 v[168:171], v2, s[8:11], s74 offen offset:0 sc1
    buffer_load_dwordx4 v[172:175], v2, s[8:11], s74 offen offset:1024 sc1
    buffer_load_dwordx4 v[176:179], v2, s[8:11], s74 offen offset:2048 sc1
    buffer_load_dwordx4 v[180:183], v2, s[8:11], s74 offen offset:3072 sc1
    buffer_load_dwordx4 v[184:187], v2, s[8:11], s78 offen offset:0 sc1
    s_barrier
    s_cmp_le_u32 s76, 4
    s_cselect_b32 s74, s75, s77
    s_add_u32 m0, 24576, 0
    s_add_u32 s78, s74, 24576
    buffer_load_dwordx4 v2, s[8:11], s78 offen sc1 lds
    s_cmp_le_u32 s76, 5
    s_cselect_b32 s74, s75, s77
    s_add_u32 m0, 25600, 0
    s_add_u32 s78, s74, 25600
    buffer_load_dwordx4 v2, s[8:11], s78 offen sc1 lds
    s_add_u32 m0, 26624, 0
    s_add_u32 s78, s74, 26624
    buffer_load_dwordx4 v2, s[8:11], s78 offen sc1 lds
    s_add_u32 m0, 27648, 0
    s_add_u32 s78, s74, 27648
    buffer_load_dwordx4 v2, s[8:11], s78 offen sc1 lds
    s_add_u32 m0, 28672, 0
    s_add_u32 s78, s74, 28672
    buffer_load_dwordx4 v2, s[8:11], s78 offen sc1 lds
    s_add_u32 m0, 29696, 0
    s_add_u32 s78, s74, 29696
    buffer_load_dwordx4 v2, s[8:11], s78 offen sc1 lds
    s_cmp_le_u32 s76, 6
    s_cselect_b32 s74, s75, s77
    s_add_u32 m0, 30720, 0
    s_add_u32 s78, s74, 30720
    buffer_load_dwordx4 v2, s[8:11], s78 offen sc1 lds
    s_add_u32 m0, 31744, 0
    s_add_u32 s78, s74, 31744
    buffer_load_dwordx4 v2, s[8:11], s78 offen sc1 lds
    s_cmp_le_i32 s71, 20
    s_cselect_b32 s74, s73, s72
    s_add_u32 s74, s74, 102400
    s_add_u32 s78, s74, 4096
    buffer_load_dwordx4 v[188:191], v2, s[8:11], s74 offen offset:0 sc1
    buffer_load_dwordx4 v[192:195], v2, s[8:11], s74 offen offset:1024 sc1
    buffer_load_dwordx4 v[196:199], v2, s[8:11], s74 offen offset:2048 sc1
    buffer_load_dwordx4 v[200:203], v2, s[8:11], s74 offen offset:3072 sc1
    buffer_load_dwordx4 v[204:207], v2, s[8:11], s78 offen offset:0 sc1
    s_cmp_le_i32 s71, 22
    s_cselect_b32 s74, s73, s72
    s_add_u32 s74, s74, 112640
    s_add_u32 s78, s74, 4096
    buffer_load_dwordx4 v[208:211], v2, s[8:11], s74 offen offset:0 sc1
    buffer_load_dwordx4 v[212:215], v2, s[8:11], s74 offen offset:1024 sc1
    buffer_load_dwordx4 v[216:219], v2, s[8:11], s74 offen offset:2048 sc1
    buffer_load_dwordx4 v[220:223], v2, s[8:11], s74 offen offset:3072 sc1
    buffer_load_dwordx4 v[224:227], v2, s[8:11], s78 offen offset:0 sc1
    s_branch L_p2_help
L_ffn_xl:
    s_sub_u32 s56, s48, 2
    v_lshrrev_b32 v2, 3, v0
    v_lshrrev_b32 v3, 4, v0
    s_lshl_b32 s57, s56, 2
    v_add_u32 v3, s57, v3
    v_and_b32 v12, 7, v0
    v_xor_b32 v3, v3, v12
    v_lshlrev_b32 v3, 4, v3
    v_mul_u32_u24 v2, 40960, v2
    v_add_u32 v2, v2, v3
    s_lshl_b32 s57, s56, 8
    s_lshl_b32 s58, s54, 1
    s_add_u32 s57, s57, s58
    s_mul_i32 s57, s57, 1280
    v_add_u32 v4, s57, v2
    v_add_u32 v5, 655360, v4
    v_add_u32 v6, 1310720, v4
    v_add_u32 v7, 1966080, v4
    v_add_u32 v8, 1280, v4
    v_add_u32 v9, 656640, v4
    v_add_u32 v10, 1312000, v4
    v_add_u32 v11, 1967360, v4
    s_lshl_b32 s57, s56, 10
    s_mul_i32 s64, s50, 43
    s_lshr_b32 s64, s64, 7
    s_mul_i32 s65, s64, 3
    s_sub_u32 s65, s50, s65
    s_and_b32 s58, s64, 1
    s_mul_i32 s58, s58, 5
    s_lshl_b32 s58, s58, 7
    s_lshr_b32 s59, s58, 7
    s_mov_b32 s6, 0x280000
    s_mov_b32 s7, 0x20000
    s_mov_b32 s23, 0x20000
    s_waitcnt lgkmcnt(0)
    s_mov_b32 s4, s28
    s_mov_b32 s5, s29
    s_add_u32 m0, s57, 98304
    s_nop 0
    buffer_load_dwordx4 v4, s[4:7], s58 offen  lds
    s_add_u32 m0, s57, 100352
    s_nop 0
    buffer_load_dwordx4 v5, s[4:7], s58 offen  lds
    s_add_u32 m0, s57, 102400
    s_nop 0
    buffer_load_dwordx4 v6, s[4:7], s58 offen  lds
    s_add_u32 m0, s57, 104448
    s_nop 0
    buffer_load_dwordx4 v7, s[4:7], s58 offen  lds
    s_add_u32 m0, s57, 106496
    s_nop 0
    buffer_load_dwordx4 v8, s[4:7], s58 offen  lds
    s_add_u32 m0, s57, 108544
    s_nop 0
    buffer_load_dwordx4 v9, s[4:7], s58 offen  lds
    s_add_u32 m0, s57, 110592
    s_nop 0
    buffer_load_dwordx4 v10, s[4:7], s58 offen  lds
    s_add_u32 m0, s57, 112640
    s_nop 0
    buffer_load_dwordx4 v11, s[4:7], s58 offen  lds
    s_add_u32 s58, s58, 128
    s_cmp_eq_u32 s58, 1280
    s_cselect_b32 s58, 0, s58
    s_barrier
    s_load_dwordx2 s[12:13], s[46:47], 0x18000
    s_lshr_b32 s51, s50, 2
    s_lshr_b32 s53, s49, 1
    s_lshl_b32 s53, s53, 3
    s_add_u32 s51, s51, s53
    s_and_b32 s52, s50, 3
    s_and_b32 s53, s49, 1
    s_lshl_b32 s53, s53, 2
    s_add_u32 s52, s52, s53
    s_mov_b32 s10, 0xc00000
    s_mov_b32 s11, 0x20000
    s_mov_b32 s18, 0x280000
    s_mov_b32 s19, 0x20000
    s_mov_b32 s8, s46
    s_mov_b32 s9, s47
    s_mov_b32 s16, s42
    s_mov_b32 s17, s43
    s_mov_b32 s76, 0
    s_mul_i32 s77, s52, 245760
    s_mul_i32 s53, s76, 5120
    s_add_u32 s77, s77, s53
    s_add_u32 s77, s77, 0x100000
    s_sub_u32 s75, s77, 122880
    s_sub_u32 s76, 24, s76
    s_lshr_b32 s53, s48, 1
    s_mul_i32 s72, s53, 122880
    s_and_b32 s53, s48, 1
    s_sub_i32 s71, s76, s53
    s_mul_i32 s53, s53, 5120
    s_add_u32 s72, s72, s53
    s_add_u32 s73, s72, s75
    s_add_u32 s72, s72, s77
    v_lshlrev_b32 v2, 4, v0
    v_lshrrev_b32 v80, 4, v0
    v_lshlrev_b32 v80, 5, v80
    v_bfe_u32 v1, v0, 1, 3
    v_add_u32 v80, v80, v1
    s_lshr_b32 s53, s64, 1
    s_lshl_b32 s53, s53, 3
    v_add_u32 v80, s53, v80
    v_mul_u32_u24 v80, 3072, v80
    v_and_b32 v1, 1, v0
    v_lshl_add_u32 v80, v1, 7, v80
    v_and_b32 v81, 15, v0
    v_lshlrev_b32 v81, 5, v81
    v_lshrrev_b32 v1, 4, v0
    v_lshl_add_u32 v81, v1, 9, v81
    s_lshl_b32 s53, s54, 1
    s_add_u32 s53, s53, s56
    v_add_u32 v81, s53, v81
    v_mul_u32_u24 v81, 1280, v81
    s_cmp_eq_u32 s56, 0
    s_cselect_b32 s20, s36, s38
    s_cselect_b32 s21, s37, s39
    s_mov_b32 s22, 0x1e0000
    s_mul_i32 s66, s59, 196608
    s_lshl_b32 s67, s55, 8
    s_add_u32 s66, s66, s67
    s_and_b32 s41, s48, 1
    s_lshr_b32 s42, s48, 1
    s_lshl_b32 s38, s51, 9
    s_add_u32 s38, s38, 0x80000
    s_lshl_b32 s43, s41, 1
    s_add_u32 s44, s43, s42
    s_sub_u32 s43, s43, s42
    s_add_u32 s43, s43, 1
    v_and_b32 v217, 15, v0
    v_lshrrev_b32 v218, 4, v0
    s_lshl_b32 s39, s44, 9
    s_add_u32 s39, s39, s51
    s_mul_i32 s39, s39, 1280
    s_mul_i32 s53, s52, 160
    s_add_u32 s39, s39, s53
    s_mul_i32 s40, s48, 3072
    s_add_u32 s40, s40, 151552
    v_add_u32 v219, 0, v0
    v_min_u32 v219, 159, v219
    v_mul_u32_u24 v220, 205, v219
    v_lshrrev_b32 v220, 11, v220
    v_mul_u32_u24 v220, 40800, v220
    v_lshl_add_u32 v228, v219, 4, v220
    v_add_u32 v219, 64, v0
    v_min_u32 v219, 159, v219
    v_mul_u32_u24 v220, 205, v219
    v_lshrrev_b32 v220, 11, v220
    v_mul_u32_u24 v220, 40800, v220
    v_lshl_add_u32 v229, v219, 4, v220
    v_add_u32 v219, 128, v0
    v_min_u32 v219, 159, v219
    v_mul_u32_u24 v220, 205, v219
    v_lshrrev_b32 v220, 11, v220
    v_mul_u32_u24 v220, 40800, v220
    v_lshl_add_u32 v230, v219, 4, v220
    v_mul_u32_u24 v219, 160, v217
    v_and_b32 v220, 1, v218
    v_lshl_add_u32 v219, v220, 4, v219
    v_add_u32 v231, s40, v219
    s_lshr_b32 s45, s52, 2
    s_lshl_b32 s47, s45, 31
    s_or_b32 s47, s47, 0x3a000000
    s_mul_i32 s46, s45, 640
    s_lshl_b32 s45, s45, 1
    s_sub_u32 s45, 1, s45
    s_mul_i32 s53, s52, 80
    v_mul_u32_u24 v222, 163840, v218
    v_and_b32 v227, 7, v0
    v_bfe_u32 v219, v0, 3, 1
    v_lshl_add_u32 v227, v227, 1, v219
    v_add_u32 v219, s53, v227
    v_add_u32 v219, 0, v219
    v_mul_lo_u32 v219, v219, s45
    v_add_u32 v219, s46, v219
    v_and_b32 v220, 1, v219
    v_mul_u32_u24 v220, 81920, v220
    v_add_u32 v220, v220, v222
    v_lshrrev_b32 v221, 1, v219
    v_cmp_eq_u32 vcc, 160, v221
    s_nop 1
    v_cndmask_b32 v221, v221, 0, vcc
    v_lshl_add_u32 v248, v221, 4, v220
    v_cmp_eq_u32 vcc, 0, v219
    v_mov_b32 v221, 0x7ffffff0
    s_nop 0
    v_cndmask_b32 v248, v248, v221, vcc
    v_add_u32 v219, s53, v227
    v_add_u32 v219, 16, v219
    v_mul_lo_u32 v219, v219, s45
    v_add_u32 v219, s46, v219
    v_and_b32 v220, 1, v219
    v_mul_u32_u24 v220, 81920, v220
    v_add_u32 v220, v220, v222
    v_lshrrev_b32 v221, 1, v219
    v_cmp_eq_u32 vcc, 160, v221
    s_nop 1
    v_cndmask_b32 v221, v221, 0, vcc
    v_lshl_add_u32 v249, v221, 4, v220
    v_add_u32 v219, s53, v227
    v_add_u32 v219, 32, v219
    v_mul_lo_u32 v219, v219, s45
    v_add_u32 v219, s46, v219
    v_and_b32 v220, 1, v219
    v_mul_u32_u24 v220, 81920, v220
    v_add_u32 v220, v220, v222
    v_lshrrev_b32 v221, 1, v219
    v_cmp_eq_u32 vcc, 160, v221
    s_nop 1
    v_cndmask_b32 v221, v221, 0, vcc
    v_lshl_add_u32 v250, v221, 4, v220
    v_add_u32 v219, s53, v227
    v_add_u32 v219, 48, v219
    v_mul_lo_u32 v219, v219, s45
    v_add_u32 v219, s46, v219
    v_and_b32 v220, 1, v219
    v_mul_u32_u24 v220, 81920, v220
    v_add_u32 v220, v220, v222
    v_lshrrev_b32 v221, 1, v219
    v_cmp_eq_u32 vcc, 160, v221
    s_nop 1
    v_cndmask_b32 v221, v221, 0, vcc
    v_lshl_add_u32 v251, v221, 4, v220
    v_add_u32 v219, s53, v227
    v_add_u32 v219, 64, v219
    v_mul_lo_u32 v219, v219, s45
    v_add_u32 v219, s46, v219
    v_and_b32 v220, 1, v219
    v_mul_u32_u24 v220, 81920, v220
    v_add_u32 v220, v220, v222
    v_lshrrev_b32 v221, 1, v219
    v_cmp_eq_u32 vcc, 160, v221
    s_nop 1
    v_cndmask_b32 v221, v221, 0, vcc
    v_lshl_add_u32 v252, v221, 4, v220
    s_mul_i32 s45, s45, s51
    s_and_b32 s45, s45, 31
    s_mul_i32 s36, s45, 2560
    s_mul_i32 s37, s42, 1310720
    s_add_u32 s36, s36, s37
    s_add_u32 s36, s36, 0x300000
    s_add_u32 s37, s36, 655360
    s_lshr_b32 s45, s45, 3
    s_lshl_b32 s53, s44, 9
    s_add_u32 s53, s53, s51
    v_lshl_add_u32 v219, v217, 5, s53
    s_lshl_b32 s53, s43, 9
    s_add_u32 s53, s53, s51
    v_lshl_add_u32 v220, v217, 5, s53
    s_sub_u32 s53, 4, s45
    s_and_b32 s53, s53, 3
    s_lshl_b32 s46, s42, 5
    s_add_u32 s53, s53, s46
    v_lshl_add_u32 v221, v218, 2, s53
    v_add_u32 v222, 16, v221
    v_mul_u32_u24 v223, v219, v221
    v_and_b32 v223, 2047, v223
    v_cvt_f32_u32 v223, v223
    v_mul_f32 v223, s47, v223
    v_sin_f32 v224, v223
    v_cos_f32 v223, v223
    v_mul_u32_u24 v225, v219, v222
    v_and_b32 v225, 2047, v225
    v_cvt_f32_u32 v225, v225
    v_mul_f32 v225, s47, v225
    v_sin_f32 v226, v225
    v_cos_f32 v225, v225
    s_nop 0
    v_cvt_pk_bf16_f32 v232, v223, v224
    v_cvt_pk_bf16_f32 v236, v225, v226
    v_mul_u32_u24 v223, v220, v221
    v_and_b32 v223, 2047, v223
    v_cvt_f32_u32 v223, v223
    v_mul_f32 v223, s47, v223
    v_sin_f32 v224, v223
    v_cos_f32 v223, v223
    v_mul_u32_u24 v225, v220, v222
    v_and_b32 v225, 2047, v225
    v_cvt_f32_u32 v225, v225
    v_mul_f32 v225, s47, v225
    v_sin_f32 v226, v225
    v_cos_f32 v225, v225
    s_nop 0
    v_cvt_pk_bf16_f32 v240, v223, v224
    v_cvt_pk_bf16_f32 v244, v225, v226
    s_sub_u32 s53, 5, s45
    s_and_b32 s53, s53, 3
    s_lshl_b32 s46, s42, 5
    s_add_u32 s53, s53, s46
    v_lshl_add_u32 v221, v218, 2, s53
    v_add_u32 v222, 16, v221
    v_mul_u32_u24 v223, v219, v221
    v_and_b32 v223, 2047, v223
    v_cvt_f32_u32 v223, v223
    v_mul_f32 v223, s47, v223
    v_sin_f32 v224, v223
    v_cos_f32 v223, v223
    v_mul_u32_u24 v225, v219, v222
    v_and_b32 v225, 2047, v225
    v_cvt_f32_u32 v225, v225
    v_mul_f32 v225, s47, v225
    v_sin_f32 v226, v225
    v_cos_f32 v225, v225
    s_nop 0
    v_cvt_pk_bf16_f32 v233, v223, v224
    v_cvt_pk_bf16_f32 v237, v225, v226
    v_mul_u32_u24 v223, v220, v221
    v_and_b32 v223, 2047, v223
    v_cvt_f32_u32 v223, v223
    v_mul_f32 v223, s47, v223
    v_sin_f32 v224, v223
    v_cos_f32 v223, v223
    v_mul_u32_u24 v225, v220, v222
    v_and_b32 v225, 2047, v225
    v_cvt_f32_u32 v225, v225
    v_mul_f32 v225, s47, v225
    v_sin_f32 v226, v225
    v_cos_f32 v225, v225
    s_nop 0
    v_cvt_pk_bf16_f32 v241, v223, v224
    v_cvt_pk_bf16_f32 v245, v225, v226
    s_sub_u32 s53, 6, s45
    s_and_b32 s53, s53, 3
    s_lshl_b32 s46, s42, 5
    s_add_u32 s53, s53, s46
    v_lshl_add_u32 v221, v218, 2, s53
    v_add_u32 v222, 16, v221
    v_mul_u32_u24 v223, v219, v221
    v_and_b32 v223, 2047, v223
    v_cvt_f32_u32 v223, v223
    v_mul_f32 v223, s47, v223
    v_sin_f32 v224, v223
    v_cos_f32 v223, v223
    v_mul_u32_u24 v225, v219, v222
    v_and_b32 v225, 2047, v225
    v_cvt_f32_u32 v225, v225
    v_mul_f32 v225, s47, v225
    v_sin_f32 v226, v225
    v_cos_f32 v225, v225
    s_nop 0
    v_cvt_pk_bf16_f32 v234, v223, v224
    v_cvt_pk_bf16_f32 v238, v225, v226
    v_mul_u32_u24 v223, v220, v221
    v_and_b32 v223, 2047, v223
    v_cvt_f32_u32 v223, v223
    v_mul_f32 v223, s47, v223
    v_sin_f32 v224, v223
    v_cos_f32 v223, v223
    v_mul_u32_u24 v225, v220, v222
    v_and_b32 v225, 2047, v225
    v_cvt_f32_u32 v225, v225
    v_mul_f32 v225, s47, v225
    v_sin_f32 v226, v225
    v_cos_f32 v225, v225
    s_nop 0
    v_cvt_pk_bf16_f32 v242, v223, v224
    v_cvt_pk_bf16_f32 v246, v225, v226
    s_sub_u32 s53, 7, s45
    s_and_b32 s53, s53, 3
    s_lshl_b32 s46, s42, 5
    s_add_u32 s53, s53, s46
    v_lshl_add_u32 v221, v218, 2, s53
    v_add_u32 v222, 16, v221
    v_mul_u32_u24 v223, v219, v221
    v_and_b32 v223, 2047, v223
    v_cvt_f32_u32 v223, v223
    v_mul_f32 v223, s47, v223
    v_sin_f32 v224, v223
    v_cos_f32 v223, v223
    v_mul_u32_u24 v225, v219, v222
    v_and_b32 v225, 2047, v225
    v_cvt_f32_u32 v225, v225
    v_mul_f32 v225, s47, v225
    v_sin_f32 v226, v225
    v_cos_f32 v225, v225
    s_nop 0
    v_cvt_pk_bf16_f32 v235, v223, v224
    v_cvt_pk_bf16_f32 v239, v225, v226
    v_mul_u32_u24 v223, v220, v221
    v_and_b32 v223, 2047, v223
    v_cvt_f32_u32 v223, v223
    v_mul_f32 v223, s47, v223
    v_sin_f32 v224, v223
    v_cos_f32 v223, v223
    v_mul_u32_u24 v225, v220, v222
    v_and_b32 v225, 2047, v225
    v_cvt_f32_u32 v225, v225
    v_mul_f32 v225, s47, v225
    v_sin_f32 v226, v225
    v_cos_f32 v225, v225
    s_nop 0
    v_cvt_pk_bf16_f32 v243, v223, v224
    v_cvt_pk_bf16_f32 v247, v225, v226
    s_waitcnt lgkmcnt(0)
    s_add_u32 s12, s12, 1
    s_add_u32 s13, s13, 1
    s_cmp_eq_u32 s56, 0
    s_cbranch_scc0 L_ffn_xl3
    v_lshrrev_b32 v12, 4, v0
    v_bfe_u32 v13, v0, 2, 2
    v_lshl_add_u32 v14, v12, 3, v13
    v_lshlrev_b32 v14, 7, v14
    v_and_b32 v13, 3, v0
    v_lshl_add_u32 v14, v13, 3, v14
    v_bfe_u32 v13, v0, 3, 1
    v_bfe_u32 v15, v0, 4, 1
    v_lshl_add_u32 v13, v15, 1, v13
    s_and_b32 s60, s54, 2
    v_xor_b32 v13, s60, v13
    v_lshl_add_u32 v14, v13, 5, v14
    s_lshr_b32 s60, s54, 2
    s_lshl_b32 s60, s60, 12
    v_add_u32 v16, s60, v14
    v_xor_b32 v17, 32, v16
    v_add_u32 v18, 49152, v16
    v_add_u32 v19, 49152, v17
    v_mov_b32 v20, 0x3f803f80
    v_mov_b32 v21, 0x3f803f80
    v_mov_b32 v22, 0x3f803f80
    v_mov_b32 v23, 0x3f803f80
    v_mov_b32 v24, 0
    v_mov_b32 v25, 0
    v_mov_b32 v26, 0
    v_mov_b32 v27, 0
    v_mov_b32 v28, 0
    v_mov_b32 v29, 0
    v_mov_b32 v30, 0
    v_mov_b32 v31, 0
    s_and_b32 s61, s54, 1
    s_mul_i32 s61, s61, 24576
    s_lshr_b32 s62, s54, 3
    s_mul_i32 s62, s62, 12288
    s_add_u32 s61, s61, s62
    s_lshl_b32 s62, s55, 10
    s_add_u32 s61, s61, s62
    s_bfe_u32 s62, s54, 0x20001
    s_lshl_b32 s62, s62, 8
    s_add_u32 s61, s61, s62
    s_add_u32 s61, s61, 0x28000
    v_lshlrev_b32 v56, 5, v12
    v_and_b32 v13, 1, v0
    v_lshl_add_u32 v56, v13, 4, v56
    s_lshl_b32 s62, s55, 4
    s_add_u32 s62, s62, s54
    s_lshl_b32 s62, s62, 7
    s_add_u32 s62, s62, 0x8000
    v_mov_b32 v57, s62
    v_and_b32 v12, 15, v0
    v_lshlrev_b32 v12, 5, v12
    v_lshrrev_b32 v13, 4, v0
    v_lshl_add_u32 v12, v13, 9, v12
    s_lshl_b32 s60, s54, 1
    v_add_u32 v12, s60, v12
    v_lshlrev_b32 v12, 4, v12
    v_add_u32 v12, 0x20000, v12
    v_lshlrev_b32 v13, 4, v0
    v_add_u32 v13, 147456, v13
    v_lshlrev_b32 v14, 7, v0
    v_add_u32 v14, 0x8000, v14
    v_add_u32 v15, 8192, v14
    v_add_u32 v58, 16384, v14
    s_waitcnt vmcnt(0)
    s_barrier
    s_add_u32 m0, s57, 114688
    s_nop 0
    buffer_load_dwordx4 v4, s[4:7], s58 offen  lds
    s_add_u32 m0, s57, 116736
    s_nop 0
    buffer_load_dwordx4 v5, s[4:7], s58 offen  lds
    s_add_u32 m0, s57, 118784
    s_nop 0
    buffer_load_dwordx4 v6, s[4:7], s58 offen  lds
    s_add_u32 m0, s57, 120832
    s_nop 0
    buffer_load_dwordx4 v7, s[4:7], s58 offen  lds
    s_add_u32 m0, s57, 122880
    s_nop 0
    buffer_load_dwordx4 v8, s[4:7], s58 offen  lds
    s_add_u32 m0, s57, 124928
    s_nop 0
    buffer_load_dwordx4 v9, s[4:7], s58 offen  lds
    s_add_u32 m0, s57, 126976
    s_nop 0
    buffer_load_dwordx4 v10, s[4:7], s58 offen  lds
    s_add_u32 m0, s57, 129024
    s_nop 0
    buffer_load_dwordx4 v11, s[4:7], s58 offen  lds
    s_add_u32 s58, s58, 128
    s_cmp_eq_u32 s58, 1280
    s_cselect_b32 s58, 0, s58
    ds_read_b64_tr_b16 v[40:41], v16 offset:0
    ds_read_b64_tr_b16 v[42:43], v16 offset:512
    ds_read_b64_tr_b16 v[44:45], v17 offset:0
    ds_read_b64_tr_b16 v[46:47], v17 offset:512
    s_waitcnt lgkmcnt(0)
    v_mfma_f32_16x16x32_bf16 v[24:27], v[40:43], v[20:23], v[24:27]
    v_mfma_f32_16x16x32_bf16 v[28:31], v[44:47], v[20:23], v[28:31]
    s_barrier
    s_add_u32 m0, s57, 131072
    s_nop 0
    buffer_load_dwordx4 v4, s[4:7], s58 offen  lds
    s_add_u32 m0, s57, 133120
    s_nop 0
    buffer_load_dwordx4 v5, s[4:7], s58 offen  lds
    s_add_u32 m0, s57, 135168
    s_nop 0
    buffer_load_dwordx4 v6, s[4:7], s58 offen  lds
    s_add_u32 m0, s57, 137216
    s_nop 0
    buffer_load_dwordx4 v7, s[4:7], s58 offen  lds
    s_add_u32 m0, s57, 139264
    s_nop 0
    buffer_load_dwordx4 v8, s[4:7], s58 offen  lds
    s_add_u32 m0, s57, 141312
    s_nop 0
    buffer_load_dwordx4 v9, s[4:7], s58 offen  lds
    s_add_u32 m0, s57, 143360
    s_nop 0
    buffer_load_dwordx4 v10, s[4:7], s58 offen  lds
    s_add_u32 m0, s57, 145408
    s_nop 0
    buffer_load_dwordx4 v11, s[4:7], s58 offen  lds
    s_add_u32 s58, s58, 128
    s_cmp_eq_u32 s58, 1280
    s_cselect_b32 s58, 0, s58
    ds_read_b64_tr_b16 v[40:41], v16 offset:16384
    ds_read_b64_tr_b16 v[42:43], v16 offset:16896
    ds_read_b64_tr_b16 v[44:45], v17 offset:16384
    ds_read_b64_tr_b16 v[46:47], v17 offset:16896
    s_waitcnt lgkmcnt(0)
    v_mfma_f32_16x16x32_bf16 v[24:27], v[40:43], v[20:23], v[24:27]
    v_mfma_f32_16x16x32_bf16 v[28:31], v[44:47], v[20:23], v[28:31]
    s_waitcnt vmcnt(8)
    s_barrier
    ds_read_b64_tr_b16 v[40:41], v16 offset:32768
    ds_read_b64_tr_b16 v[42:43], v16 offset:33280
    ds_read_b64_tr_b16 v[44:45], v17 offset:32768
    ds_read_b64_tr_b16 v[46:47], v17 offset:33280
    s_waitcnt lgkmcnt(0)
    v_mfma_f32_16x16x32_bf16 v[24:27], v[40:43], v[20:23], v[24:27]
    v_mfma_f32_16x16x32_bf16 v[28:31], v[44:47], v[20:23], v[28:31]
    s_barrier
    s_add_u32 m0, s57, 98304
    s_nop 0
    buffer_load_dwordx4 v4, s[4:7], s58 offen  lds
    s_add_u32 m0, s57, 100352
    s_nop 0
    buffer_load_dwordx4 v5, s[4:7], s58 offen  lds
    s_add_u32 m0, s57, 102400
    s_nop 0
    buffer_load_dwordx4 v6, s[4:7], s58 offen  lds
    s_add_u32 m0, s57, 104448
    s_nop 0
    buffer_load_dwordx4 v7, s[4:7], s58 offen  lds
    s_add_u32 m0, s57, 106496
    s_nop 0
    buffer_load_dwordx4 v8, s[4:7], s58 offen  lds
    s_add_u32 m0, s57, 108544
    s_nop 0
    buffer_load_dwordx4 v9, s[4:7], s58 offen  lds
    s_add_u32 m0, s57, 110592
    s_nop 0
    buffer_load_dwordx4 v10, s[4:7], s58 offen  lds
    s_add_u32 m0, s57, 112640
    s_nop 0
    buffer_load_dwordx4 v11, s[4:7], s58 offen  lds
    s_add_u32 s58, s58, 128
    s_cmp_eq_u32 s58, 1280
    s_cselect_b32 s58, 0, s58
    ds_read_b64_tr_b16 v[40:41], v18 offset:0
    ds_read_b64_tr_b16 v[42:43], v18 offset:512
    ds_read_b64_tr_b16 v[44:45], v19 offset:0
    ds_read_b64_tr_b16 v[46:47], v19 offset:512
    s_waitcnt lgkmcnt(0)
    v_mfma_f32_16x16x32_bf16 v[24:27], v[40:43], v[20:23], v[24:27]
    v_mfma_f32_16x16x32_bf16 v[28:31], v[44:47], v[20:23], v[28:31]
    s_waitcnt vmcnt(8)
    s_barrier
    s_add_u32 m0, s57, 114688
    s_nop 0
    buffer_load_dwordx4 v4, s[4:7], s58 offen  lds
    s_add_u32 m0, s57, 116736
    s_nop 0
    buffer_load_dwordx4 v5, s[4:7], s58 offen  lds
    s_add_u32 m0, s57, 118784
    s_nop 0
    buffer_load_dwordx4 v6, s[4:7], s58 offen  lds
    s_add_u32 m0, s57, 120832
    s_nop 0
    buffer_load_dwordx4 v7, s[4:7], s58 offen  lds
    s_add_u32 m0, s57, 122880
    s_nop 0
    buffer_load_dwordx4 v8, s[4:7], s58 offen  lds
    s_add_u32 m0, s57, 124928
    s_nop 0
    buffer_load_dwordx4 v9, s[4:7], s58 offen  lds
    s_add_u32 m0, s57, 126976
    s_nop 0
    buffer_load_dwordx4 v10, s[4:7], s58 offen  lds
    s_add_u32 m0, s57, 129024
    s_nop 0
    buffer_load_dwordx4 v11, s[4:7], s58 offen  lds
    s_add_u32 s58, s58, 128
    s_cmp_eq_u32 s58, 1280
    s_cselect_b32 s58, 0, s58
    ds_read_b64_tr_b16 v[40:41], v18 offset:16384
    ds_read_b64_tr_b16 v[42:43], v18 offset:16896
    ds_read_b64_tr_b16 v[44:45], v19 offset:16384
    ds_read_b64_tr_b16 v[46:47], v19 offset:16896
    s_waitcnt lgkmcnt(0)
    v_mfma_f32_16x16x32_bf16 v[24:27], v[40:43], v[20:23], v[24:27]
    v_mfma_f32_16x16x32_bf16 v[28:31], v[44:47], v[20:23], v[28:31]
    s_barrier
    ds_read_b64_tr_b16 v[40:41], v18 offset:32768
    ds_read_b64_tr_b16 v[42:43], v18 offset:33280
    ds_read_b64_tr_b16 v[44:45], v19 offset:32768
    ds_read_b64_tr_b16 v[46:47], v19 offset:33280
    s_waitcnt lgkmcnt(0)
    v_mfma_f32_16x16x32_bf16 v[24:27], v[40:43], v[20:23], v[24:27]
    v_mfma_f32_16x16x32_bf16 v[28:31], v[44:47], v[20:23], v[28:31]
    s_waitcnt vmcnt(8)
    s_barrier
    v_mov_b32 v60, s12
    v_mov_b32 v61, s13
    s_mov_b64 exec, 1
    buffer_store_dwordx2 v[60:61], v57, s[8:11], 0 offen sc1
    s_mov_b64 exec, -1
    s_add_u32 m0, s57, 131072
    s_nop 0
    buffer_load_dwordx4 v4, s[4:7], s58 offen  lds
    s_add_u32 m0, s57, 133120
    s_nop 0
    buffer_load_dwordx4 v5, s[4:7], s58 offen  lds
    s_add_u32 m0, s57, 135168
    s_nop 0
    buffer_load_dwordx4 v6, s[4:7], s58 offen  lds
    s_add_u32 m0, s57, 137216
    s_nop 0
    buffer_load_dwordx4 v7, s[4:7], s58 offen  lds
    s_add_u32 m0, s57, 139264
    s_nop 0
    buffer_load_dwordx4 v8, s[4:7], s58 offen  lds
    s_add_u32 m0, s57, 141312
    s_nop 0
    buffer_load_dwordx4 v9, s[4:7], s58 offen  lds
    s_add_u32 m0, s57, 143360
    s_nop 0
    buffer_load_dwordx4 v10, s[4:7], s58 offen  lds
    s_add_u32 m0, s57, 145408
    s_nop 0
    buffer_load_dwordx4 v11, s[4:7], s58 offen  lds
    s_add_u32 s58, s58, 128
    s_cmp_eq_u32 s58, 1280
    s_cselect_b32 s58, 0, s58
    ds_read_b64_tr_b16 v[40:41], v16 offset:0
    ds_read_b64_tr_b16 v[42:43], v16 offset:512
    ds_read_b64_tr_b16 v[44:45], v17 offset:0
    ds_read_b64_tr_b16 v[46:47], v17 offset:512
    s_waitcnt lgkmcnt(0)
    v_mfma_f32_16x16x32_bf16 v[24:27], v[40:43], v[20:23], v[24:27]
    v_mfma_f32_16x16x32_bf16 v[28:31], v[44:47], v[20:23], v[28:31]
    s_barrier
    ds_read_b64_tr_b16 v[40:41], v16 offset:16384
    ds_read_b64_tr_b16 v[42:43], v16 offset:16896
    ds_read_b64_tr_b16 v[44:45], v17 offset:16384
    ds_read_b64_tr_b16 v[46:47], v17 offset:16896
    s_waitcnt lgkmcnt(0)
    v_mfma_f32_16x16x32_bf16 v[24:27], v[40:43], v[20:23], v[24:27]
    v_mfma_f32_16x16x32_bf16 v[28:31], v[44:47], v[20:23], v[28:31]
    s_waitcnt vmcnt(9)
    s_barrier
    s_add_u32 m0, s57, 98304
    s_nop 0
    buffer_load_dwordx4 v4, s[4:7], s58 offen  lds
    s_add_u32 m0, s57, 100352
    s_nop 0
    buffer_load_dwordx4 v5, s[4:7], s58 offen  lds
    s_add_u32 m0, s57, 102400
    s_nop 0
    buffer_load_dwordx4 v6, s[4:7], s58 offen  lds
    s_add_u32 m0, s57, 104448
    s_nop 0
    buffer_load_dwordx4 v7, s[4:7], s58 offen  lds
    s_add_u32 m0, s57, 106496
    s_nop 0
    buffer_load_dwordx4 v8, s[4:7], s58 offen  lds
    s_add_u32 m0, s57, 108544
    s_nop 0
    buffer_load_dwordx4 v9, s[4:7], s58 offen  lds
    s_add_u32 m0, s57, 110592
    s_nop 0
    buffer_load_dwordx4 v10, s[4:7], s58 offen  lds
    s_add_u32 m0, s57, 112640
    s_nop 0
    buffer_load_dwordx4 v11, s[4:7], s58 offen  lds
    s_add_u32 s58, s58, 128
    s_cmp_eq_u32 s58, 1280
    s_cselect_b32 s58, 0, s58
    ds_read_b64_tr_b16 v[40:41], v16 offset:32768
    ds_read_b64_tr_b16 v[42:43], v16 offset:33280
    ds_read_b64_tr_b16 v[44:45], v17 offset:32768
    ds_read_b64_tr_b16 v[46:47], v17 offset:33280
    s_waitcnt lgkmcnt(0)
    v_mfma_f32_16x16x32_bf16 v[24:27], v[40:43], v[20:23], v[24:27]
    v_mfma_f32_16x16x32_bf16 v[28:31], v[44:47], v[20:23], v[28:31]
    s_barrier
    ds_read_b64_tr_b16 v[40:41], v18 offset:0
    ds_read_b64_tr_b16 v[42:43], v18 offset:512
    ds_read_b64_tr_b16 v[44:45], v19 offset:0
    ds_read_b64_tr_b16 v[46:47], v19 offset:512
    s_waitcnt lgkmcnt(0)
    v_mfma_f32_16x16x32_bf16 v[24:27], v[40:43], v[20:23], v[24:27]
    v_mfma_f32_16x16x32_bf16 v[28:31], v[44:47], v[20:23], v[28:31]
    s_nop 5
    s_waitcnt vmcnt(8)
    s_barrier
    v_and_b32 v1, 1, v0
    v_cmp_eq_u32 vcc, 1, v1
    v_mov_b32 v34, s12
    v_mov_b32 v35, s13
    v_mov_b32 v38, s12
    v_mov_b32 v39, s13
    v_cndmask_b32 v32, v24, v26, vcc
    v_cndmask_b32 v33, v25, v27, vcc
    v_cndmask_b32 v36, v28, v30, vcc
    v_cndmask_b32 v37, v29, v31, vcc
    s_mov_b32 exec_lo, 0x00030003
    s_mov_b32 exec_hi, 0x00030003
    buffer_store_dwordx4 v[32:35], v56, s[8:11], s61 offen offset:0 sc1
    buffer_store_dwordx4 v[36:39], v56, s[8:11], s61 offen offset:128 sc1
    s_mov_b64 exec, -1
    s_add_u32 m0, s57, 114688
    s_nop 0
    buffer_load_dwordx4 v4, s[4:7], s58 offen  lds
    s_add_u32 m0, s57, 116736
    s_nop 0
    buffer_load_dwordx4 v5, s[4:7], s58 offen  lds
    s_add_u32 m0, s57, 118784
    s_nop 0
    buffer_load_dwordx4 v6, s[4:7], s58 offen  lds
    s_add_u32 m0, s57, 120832
    s_nop 0
    buffer_load_dwordx4 v7, s[4:7], s58 offen  lds
    s_add_u32 m0, s57, 122880
    s_nop 0
    buffer_load_dwordx4 v8, s[4:7], s58 offen  lds
    s_add_u32 m0, s57, 124928
    s_nop 0
    buffer_load_dwordx4 v9, s[4:7], s58 offen  lds
    s_add_u32 m0, s57, 126976
    s_nop 0
    buffer_load_dwordx4 v10, s[4:7], s58 offen  lds
    s_add_u32 m0, s57, 129024
    s_nop 0
    buffer_load_dwordx4 v11, s[4:7], s58 offen  lds
    s_add_u32 s58, s58, 128
    s_cmp_eq_u32 s58, 1280
    s_cselect_b32 s58, 0, s58
    s_barrier
    buffer_load_dwordx2 v[72:73], v14, s[8:11], 0 offen sc1
    buffer_load_dwordx2 v[74:75], v15, s[8:11], 0 offen sc1
    buffer_load_dwordx2 v[76:77], v58, s[8:11], 0 offen sc1
    s_waitcnt vmcnt(13)
    s_barrier
    s_add_u32 m0, s57, 131072
    s_nop 0
    buffer_load_dwordx4 v4, s[4:7], s58 offen  lds
    s_add_u32 m0, s57, 133120
    s_nop 0
    buffer_load_dwordx4 v5, s[4:7], s58 offen  lds
    s_add_u32 m0, s57, 135168
    s_nop 0
    buffer_load_dwordx4 v6, s[4:7], s58 offen  lds
    s_add_u32 m0, s57, 137216
    s_nop 0
    buffer_load_dwordx4 v7, s[4:7], s58 offen  lds
    s_add_u32 m0, s57, 139264
    s_nop 0
    buffer_load_dwordx4 v8, s[4:7], s58 offen  lds
    s_add_u32 m0, s57, 141312
    s_nop 0
    buffer_load_dwordx4 v9, s[4:7], s58 offen  lds
    s_add_u32 m0, s57, 143360
    s_nop 0
    buffer_load_dwordx4 v10, s[4:7], s58 offen  lds
    s_add_u32 m0, s57, 145408
    s_nop 0
    buffer_load_dwordx4 v11, s[4:7], s58 offen  lds
    s_add_u32 s58, s58, 128
    s_cmp_eq_u32 s58, 1280
    s_cselect_b32 s58, 0, s58
    s_barrier
    s_waitcnt vmcnt(8)
    s_mov_b32 s53, 0
    s_branch L_xl_sw_c
L_xl_sw:
    buffer_load_dwordx2 v[72:73], v14, s[8:11], 0 offen sc1
    buffer_load_dwordx2 v[74:75], v15, s[8:11], 0 offen sc1
    buffer_load_dwordx2 v[76:77], v58, s[8:11], 0 offen sc1
    s_add_u32 s53, s53, 1
    s_cmp_gt_u32 s53, 0x100000
    s_cbranch_scc1 L_xl_sw_x
    s_waitcnt vmcnt(0)
L_xl_sw_c:
    v_cmp_ne_u64 vcc, s[12:13], v[72:73]
    v_cmp_ne_u64 s[68:69], s[12:13], v[74:75]
    s_nop 0
    s_or_b64 vcc, vcc, s[68:69]
    v_cmp_ne_u64 s[68:69], s[12:13], v[76:77]
    s_nop 0
    s_or_b64 vcc, vcc, s[68:69]
    s_cbranch_vccz L_xl_sw_x
    s_sleep 8
    s_branch L_xl_sw
L_xl_sw_x:
    s_barrier
    s_add_u32 m0, s57, 98304
    s_nop 0
    buffer_load_dwordx4 v4, s[4:7], s58 offen  lds
    s_add_u32 m0, s57, 100352
    s_nop 0
    buffer_load_dwordx4 v5, s[4:7], s58 offen  lds
    s_add_u32 m0, s57, 102400
    s_nop 0
    buffer_load_dwordx4 v6, s[4:7], s58 offen  lds
    s_add_u32 m0, s57, 104448
    s_nop 0
    buffer_load_dwordx4 v7, s[4:7], s58 offen  lds
    s_add_u32 m0, s57, 106496
    s_nop 0
    buffer_load_dwordx4 v8, s[4:7], s58 offen  lds
    s_add_u32 m0, s57, 108544
    s_nop 0
    buffer_load_dwordx4 v9, s[4:7], s58 offen  lds
    s_add_u32 m0, s57, 110592
    s_nop 0
    buffer_load_dwordx4 v10, s[4:7], s58 offen  lds
    s_add_u32 m0, s57, 112640
    s_nop 0
    buffer_load_dwordx4 v11, s[4:7], s58 offen  lds
    s_add_u32 s58, s58, 128
    s_cmp_eq_u32 s58, 1280
    s_cselect_b32 s58, 0, s58
    s_cmp_le_i32 s71, 14
    s_cselect_b32 s74, s73, s72
    s_add_u32 s74, s74, 71680
    s_add_u32 s78, s74, 4096
    buffer_load_dwordx4 v[128:131], v2, s[8:11], s74 offen offset:0 sc1
    buffer_load_dwordx4 v[132:135], v2, s[8:11], s74 offen offset:1024 sc1
    buffer_load_dwordx4 v[136:139], v2, s[8:11], s74 offen offset:2048 sc1
    buffer_load_dwordx4 v[140:143], v2, s[8:11], s74 offen offset:3072 sc1
    buffer_load_dwordx4 v[144:147], v2, s[8:11], s78 offen offset:0 sc1
    s_barrier
    buffer_load_dwordx4 v[64:67], v12, s[8:11], 0 offen sc1
    buffer_load_dwordx4 v[68:71], v12, s[8:11], 0 offen offset:16 sc1
    s_waitcnt vmcnt(15)
    s_barrier
    s_cmp_le_u32 s76, 8
    s_cselect_b32 s74, s75, s77
    s_add_u32 m0, 114688, 0
    s_add_u32 s78, s74, 165888
    buffer_load_dwordx4 v2, s[8:11], s78 offen sc1 lds
    s_add_u32 m0, 115712, 0
    s_add_u32 s78, s74, 166912
    buffer_load_dwordx4 v2, s[8:11], s78 offen sc1 lds
    s_add_u32 m0, 116736, 0
    s_add_u32 s78, s74, 167936
    buffer_load_dwordx4 v2, s[8:11], s78 offen sc1 lds
    s_cmp_le_u32 s76, 9
    s_cselect_b32 s74, s75, s77
    s_add_u32 m0, 117760, 0
    s_add_u32 s78, s74, 168960
    buffer_load_dwordx4 v2, s[8:11], s78 offen sc1 lds
    s_add_u32 m0, 118784, 0
    s_add_u32 s78, s74, 169984
    buffer_load_dwordx4 v2, s[8:11], s78 offen sc1 lds
    s_add_u32 m0, 119808, 0
    s_add_u32 s78, s74, 171008
    buffer_load_dwordx4 v2, s[8:11], s78 offen sc1 lds
    s_add_u32 m0, 120832, 0
    s_add_u32 s78, s74, 172032
    buffer_load_dwordx4 v2, s[8:11], s78 offen sc1 lds
    s_add_u32 m0, 121856, 0
    s_add_u32 s78, s74, 173056
    buffer_load_dwordx4 v2, s[8:11], s78 offen sc1 lds
    s_barrier
    s_waitcnt vmcnt(8)
    s_mov_b32 s53, 0
L_xl_rs2:
    v_cmp_ne_u64 vcc, s[12:13], v[66:67]
    v_cmp_ne_u64 s[68:69], s[12:13], v[70:71]
    s_nop 0
    s_or_b64 vcc, vcc, s[68:69]
    s_cbranch_vccz L_xl_rx2
    s_add_u32 s53, s53, 1
    s_cmp_gt_u32 s53, 0x100000
    s_cbranch_scc1 L_xl_rx2
    s_sleep 2
    buffer_load_dwordx4 v[64:67], v12, s[8:11], 0 offen sc1
    buffer_load_dwordx4 v[68:71], v12, s[8:11], 0 offen offset:16 sc1
    s_waitcnt vmcnt(0)
    s_branch L_xl_rs2
L_xl_rx2:
    v_rsq_f32 v67, v65
    v_mov_b32 v66, v65
    v_mul_f32 v65, 0xbfb8aa3b, v67
    v_rsq_f32 v71, v69
    v_mov_b32 v70, v69
    v_mul_f32 v69, 0xbfb8aa3b, v71
    ds_write_b128 v13, v[64:67]
    ds_write_b128 v13, v[68:71] offset:1024
    s_cmp_le_i32 s71, 16
    s_cselect_b32 s74, s73, s72
    s_add_u32 s74, s74, 81920
    s_add_u32 s78, s74, 4096
    buffer_load_dwordx4 v[148:151], v2, s[8:11], s74 offen offset:0 sc1
    buffer_load_dwordx4 v[152:155], v2, s[8:11], s74 offen offset:1024 sc1
    buffer_load_dwordx4 v[156:159], v2, s[8:11], s74 offen offset:2048 sc1
    buffer_load_dwordx4 v[160:163], v2, s[8:11], s74 offen offset:3072 sc1
    buffer_load_dwordx4 v[164:167], v2, s[8:11], s78 offen offset:0 sc1
    s_barrier
    s_cmp_le_u32 s76, 11
    s_cselect_b32 s74, s75, s77
    s_add_u32 m0, 131072, 0
    s_add_u32 s78, s74, 182272
    buffer_load_dwordx4 v2, s[8:11], s78 offen sc1 lds
    s_add_u32 m0, 132096, 0
    s_add_u32 s78, s74, 183296
    buffer_load_dwordx4 v2, s[8:11], s78 offen sc1 lds
    s_cmp_le_u32 s76, 12
    s_cselect_b32 s74, s75, s77
    s_add_u32 m0, 133120, 0
    s_add_u32 s78, s74, 184320
    buffer_load_dwordx4 v2, s[8:11], s78 offen sc1 lds
    s_add_u32 m0, 134144, 0
    s_add_u32 s78, s74, 185344
    buffer_load_dwordx4 v2, s[8:11], s78 offen sc1 lds
    s_add_u32 m0, 135168, 0
    s_add_u32 s78, s74, 186368
    buffer_load_dwordx4 v2, s[8:11], s78 offen sc1 lds
    s_add_u32 m0, 136192, 0
    s_add_u32 s78, s74, 187392
    buffer_load_dwordx4 v2, s[8:11], s78 offen sc1 lds
    s_barrier
    s_cmp_le_i32 s71, 18
    s_cselect_b32 s74, s73, s72
    s_add_u32 s74, s74, 92160
    s_add_u32 s78, s74, 4096
    buffer_load_dwordx4 v[168:171], v2, s[8:11], s74 offen offset:0 sc1
    buffer_load_dwordx4 v[172:175], v2, s[8:11], s74 offen offset:1024 sc1
    buffer_load_dwordx4 v[176:179], v2, s[8:11], s74 offen offset:2048 sc1
    buffer_load_dwordx4 v[180:183], v2, s[8:11], s74 offen offset:3072 sc1
    buffer_load_dwordx4 v[184:187], v2, s[8:11], s78 offen offset:0 sc1
    s_waitcnt lgkmcnt(0)
    s_barrier
    s_cmp_le_u32 s76, 5
    s_cselect_b32 s74, s75, s77
    s_add_u32 m0, 98304, 0
    s_add_u32 s78, s74, 149504
    buffer_load_dwordx4 v2, s[8:11], s78 offen sc1 lds
    s_add_u32 m0, 99328, 0
    s_add_u32 s78, s74, 150528
    buffer_load_dwordx4 v2, s[8:11], s78 offen sc1 lds
    s_add_u32 m0, 100352, 0
    s_add_u32 s78, s74, 151552
    buffer_load_dwordx4 v2, s[8:11], s78 offen sc1 lds
    s_add_u32 m0, 101376, 0
    s_add_u32 s78, s74, 152576
    buffer_load_dwordx4 v2, s[8:11], s78 offen sc1 lds
    s_cmp_le_u32 s76, 6
    s_cselect_b32 s74, s75, s77
    s_add_u32 m0, 102400, 0
    s_add_u32 s78, s74, 153600
    buffer_load_dwordx4 v2, s[8:11], s78 offen sc1 lds
    s_add_u32 m0, 103424, 0
    s_add_u32 s78, s74, 154624
    buffer_load_dwordx4 v2, s[8:11], s78 offen sc1 lds
    s_add_u32 m0, 104448, 0
    s_add_u32 s78, s74, 155648
    buffer_load_dwordx4 v2, s[8:11], s78 offen sc1 lds
    s_add_u32 m0, 105472, 0
    s_add_u32 s78, s74, 156672
    buffer_load_dwordx4 v2, s[8:11], s78 offen sc1 lds
    s_cmp_le_i32 s71, 20
    s_cselect_b32 s74, s73, s72
    s_add_u32 s74, s74, 102400
    s_add_u32 s78, s74, 4096
    buffer_load_dwordx4 v[188:191], v2, s[8:11], s74 offen offset:0 sc1
    buffer_load_dwordx4 v[192:195], v2, s[8:11], s74 offen offset:1024 sc1
    buffer_load_dwordx4 v[196:199], v2, s[8:11], s74 offen offset:2048 sc1
    buffer_load_dwordx4 v[200:203], v2, s[8:11], s74 offen offset:3072 sc1
    buffer_load_dwordx4 v[204:207], v2, s[8:11], s78 offen offset:0 sc1
    s_cmp_le_i32 s71, 22
    s_cselect_b32 s74, s73, s72
    s_add_u32 s74, s74, 112640
    s_add_u32 s78, s74, 4096
    buffer_load_dwordx4 v[208:211], v2, s[8:11], s74 offen offset:0 sc1
    buffer_load_dwordx4 v[212:215], v2, s[8:11], s74 offen offset:1024 sc1
    buffer_load_dwordx4 v[216:219], v2, s[8:11], s74 offen offset:2048 sc1
    buffer_load_dwordx4 v[220:223], v2, s[8:11], s74 offen offset:3072 sc1
    buffer_load_dwordx4 v[224:227], v2, s[8:11], s78 offen offset:0 sc1
    s_branch L_p2_help
L_ffn_xl3:
    v_mov_b32 v12, 150528
    v_mov_b32 v13, 0
    ds_write_b32 v12, v13
    v_lshrrev_b32 v13, 5, v0
    v_mul_u32_u24 v13, 12288, v13
    v_and_b32 v12, 31, v0
    v_lshl_add_u32 v12, v12, 5, v13
    s_lshl_b32 s60, s55, 10
    s_add_u32 s60, s60, 0x28000
    v_add_u32 v12, s60, v12
    v_lshlrev_b32 v13, 4, v0
    v_add_u32 v13, 149504, v13
    s_mov_b32 s28, 24576
    s_mov_b32 s29, 49152
    s_mov_b32 s30, 73728
    s_mov_b32 s31, 98304
    s_mov_b32 s32, 122880
    s_mov_b32 s33, 147456
    s_mov_b32 s34, 172032
    s_waitcnt vmcnt(0)
    s_barrier
    s_add_u32 m0, s57, 114688
    s_nop 0
    buffer_load_dwordx4 v4, s[4:7], s58 offen  lds
    s_add_u32 m0, s57, 116736
    s_nop 0
    buffer_load_dwordx4 v5, s[4:7], s58 offen  lds
    s_add_u32 m0, s57, 118784
    s_nop 0
    buffer_load_dwordx4 v6, s[4:7], s58 offen  lds
    s_add_u32 m0, s57, 120832
    s_nop 0
    buffer_load_dwordx4 v7, s[4:7], s58 offen  lds
    s_add_u32 m0, s57, 122880
    s_nop 0
    buffer_load_dwordx4 v8, s[4:7], s58 offen  lds
    s_add_u32 m0, s57, 124928
    s_nop 0
    buffer_load_dwordx4 v9, s[4:7], s58 offen  lds
    s_add_u32 m0, s57, 126976
    s_nop 0
    buffer_load_dwordx4 v10, s[4:7], s58 offen  lds
    s_add_u32 m0, s57, 129024
    s_nop 0
    buffer_load_dwordx4 v11, s[4:7], s58 offen  lds
    s_add_u32 s58, s58, 128
    s_cmp_eq_u32 s58, 1280
    s_cselect_b32 s58, 0, s58
    s_barrier
    s_waitcnt vmcnt(0)
    s_barrier
    s_add_u32 m0, s57, 131072
    s_nop 0
    buffer_load_dwordx4 v4, s[4:7], s58 offen  lds
    s_add_u32 m0, s57, 133120
    s_nop 0
    buffer_load_dwordx4 v5, s[4:7], s58 offen  lds
    s_add_u32 m0, s57, 135168
    s_nop 0
    buffer_load_dwordx4 v6, s[4:7], s58 offen  lds
    s_add_u32 m0, s57, 137216
    s_nop 0
    buffer_load_dwordx4 v7, s[4:7], s58 offen  lds
    s_add_u32 m0, s57, 139264
    s_nop 0
    buffer_load_dwordx4 v8, s[4:7], s58 offen  lds
    s_add_u32 m0, s57, 141312
    s_nop 0
    buffer_load_dwordx4 v9, s[4:7], s58 offen  lds
    s_add_u32 m0, s57, 143360
    s_nop 0
    buffer_load_dwordx4 v10, s[4:7], s58 offen  lds
    s_add_u32 m0, s57, 145408
    s_nop 0
    buffer_load_dwordx4 v11, s[4:7], s58 offen  lds
    s_add_u32 s58, s58, 128
    s_cmp_eq_u32 s58, 1280
    s_cselect_b32 s58, 0, s58
    s_barrier
    s_waitcnt vmcnt(0)
    s_barrier
    s_add_u32 m0, s57, 98304
    s_nop 0
    buffer_load_dwordx4 v4, s[4:7], s58 offen  lds
    s_add_u32 m0, s57, 100352
    s_nop 0
    buffer_load_dwordx4 v5, s[4:7], s58 offen  lds
    s_add_u32 m0, s57, 102400
    s_nop 0
    buffer_load_dwordx4 v6, s[4:7], s58 offen  lds
    s_add_u32 m0, s57, 104448
    s_nop 0
    buffer_load_dwordx4 v7, s[4:7], s58 offen  lds
    s_add_u32 m0, s57, 106496
    s_nop 0
    buffer_load_dwordx4 v8, s[4:7], s58 offen  lds
    s_add_u32 m0, s57, 108544
    s_nop 0
    buffer_load_dwordx4 v9, s[4:7], s58 offen  lds
    s_add_u32 m0, s57, 110592
    s_nop 0
    buffer_load_dwordx4 v10, s[4:7], s58 offen  lds
    s_add_u32 m0, s57, 112640
    s_nop 0
    buffer_load_dwordx4 v11, s[4:7], s58 offen  lds
    s_add_u32 s58, s58, 128
    s_cmp_eq_u32 s58, 1280
    s_cselect_b32 s58, 0, s58
    s_barrier
    s_add_u32 m0, s57, 114688
    s_nop 0
    buffer_load_dwordx4 v4, s[4:7], s58 offen  lds
    s_add_u32 m0, s57, 116736
    s_nop 0
    buffer_load_dwordx4 v5, s[4:7], s58 offen  lds
    s_add_u32 m0, s57, 118784
    s_nop 0
    buffer_load_dwordx4 v6, s[4:7], s58 offen  lds
    s_add_u32 m0, s57, 120832
    s_nop 0
    buffer_load_dwordx4 v7, s[4:7], s58 offen  lds
    s_add_u32 m0, s57, 122880
    s_nop 0
    buffer_load_dwordx4 v8, s[4:7], s58 offen  lds
    s_add_u32 m0, s57, 124928
    s_nop 0
    buffer_load_dwordx4 v9, s[4:7], s58 offen  lds
    s_add_u32 m0, s57, 126976
    s_nop 0
    buffer_load_dwordx4 v10, s[4:7], s58 offen  lds
    s_add_u32 m0, s57, 129024
    s_nop 0
    buffer_load_dwordx4 v11, s[4:7], s58 offen  lds
    s_add_u32 s58, s58, 128
    s_cmp_eq_u32 s58, 1280
    s_cselect_b32 s58, 0, s58
    s_waitcnt vmcnt(8)
    s_barrier
    s_barrier
    s_add_u32 m0, s57, 131072
    s_nop 0
    buffer_load_dwordx4 v4, s[4:7], s58 offen  lds
    s_add_u32 m0, s57, 133120
    s_nop 0
    buffer_load_dwordx4 v5, s[4:7], s58 offen  lds
    s_add_u32 m0, s57, 135168
    s_nop 0
    buffer_load_dwordx4 v6, s[4:7], s58 offen  lds
    s_add_u32 m0, s57, 137216
    s_nop 0
    buffer_load_dwordx4 v7, s[4:7], s58 offen  lds
    s_add_u32 m0, s57, 139264
    s_nop 0
    buffer_load_dwordx4 v8, s[4:7], s58 offen  lds
    s_add_u32 m0, s57, 141312
    s_nop 0
    buffer_load_dwordx4 v9, s[4:7], s58 offen  lds
    s_add_u32 m0, s57, 143360
    s_nop 0
    buffer_load_dwordx4 v10, s[4:7], s58 offen  lds
    s_add_u32 m0, s57, 145408
    s_nop 0
    buffer_load_dwordx4 v11, s[4:7], s58 offen  lds
    s_add_u32 s58, s58, 128
    s_cmp_eq_u32 s58, 1280
    s_cselect_b32 s58, 0, s58
    s_waitcnt vmcnt(8)
    s_barrier
    s_barrier
    s_add_u32 m0, s57, 98304
    s_nop 0
    buffer_load_dwordx4 v4, s[4:7], s58 offen  lds
    s_add_u32 m0, s57, 100352
    s_nop 0
    buffer_load_dwordx4 v5, s[4:7], s58 offen  lds
    s_add_u32 m0, s57, 102400
    s_nop 0
    buffer_load_dwordx4 v6, s[4:7], s58 offen  lds
    s_add_u32 m0, s57, 104448
    s_nop 0
    buffer_load_dwordx4 v7, s[4:7], s58 offen  lds
    s_add_u32 m0, s57, 106496
    s_nop 0
    buffer_load_dwordx4 v8, s[4:7], s58 offen  lds
    s_add_u32 m0, s57, 108544
    s_nop 0
    buffer_load_dwordx4 v9, s[4:7], s58 offen  lds
    s_add_u32 m0, s57, 110592
    s_nop 0
    buffer_load_dwordx4 v10, s[4:7], s58 offen  lds
    s_add_u32 m0, s57, 112640
    s_nop 0
    buffer_load_dwordx4 v11, s[4:7], s58 offen  lds
    s_add_u32 s58, s58, 128
    s_cmp_eq_u32 s58, 1280
    s_cselect_b32 s58, 0, s58
    s_waitcnt vmcnt(8)
    s_barrier
    s_barrier
    s_add_u32 m0, s57, 114688
    s_nop 0
    buffer_load_dwordx4 v4, s[4:7], s58 offen  lds
    s_add_u32 m0, s57, 116736
    s_nop 0
    buffer_load_dwordx4 v5, s[4:7], s58 offen  lds
    s_add_u32 m0, s57, 118784
    s_nop 0
    buffer_load_dwordx4 v6, s[4:7], s58 offen  lds
    s_add_u32 m0, s57, 120832
    s_nop 0
    buffer_load_dwordx4 v7, s[4:7], s58 offen  lds
    s_add_u32 m0, s57, 122880
    s_nop 0
    buffer_load_dwordx4 v8, s[4:7], s58 offen  lds
    s_add_u32 m0, s57, 124928
    s_nop 0
    buffer_load_dwordx4 v9, s[4:7], s58 offen  lds
    s_add_u32 m0, s57, 126976
    s_nop 0
    buffer_load_dwordx4 v10, s[4:7], s58 offen  lds
    s_add_u32 m0, s57, 129024
    s_nop 0
    buffer_load_dwordx4 v11, s[4:7], s58 offen  lds
    s_add_u32 s58, s58, 128
    s_cmp_eq_u32 s58, 1280
    s_cselect_b32 s58, 0, s58
    s_waitcnt vmcnt(8)
    s_barrier
    s_barrier
    s_add_u32 m0, s57, 131072
    s_nop 0
    buffer_load_dwordx4 v4, s[4:7], s58 offen  lds
    s_add_u32 m0, s57, 133120
    s_nop 0
    buffer_load_dwordx4 v5, s[4:7], s58 offen  lds
    s_add_u32 m0, s57, 135168
    s_nop 0
    buffer_load_dwordx4 v6, s[4:7], s58 offen  lds
    s_add_u32 m0, s57, 137216
    s_nop 0
    buffer_load_dwordx4 v7, s[4:7], s58 offen  lds
    s_add_u32 m0, s57, 139264
    s_nop 0
    buffer_load_dwordx4 v8, s[4:7], s58 offen  lds
    s_add_u32 m0, s57, 141312
    s_nop 0
    buffer_load_dwordx4 v9, s[4:7], s58 offen  lds
    s_add_u32 m0, s57, 143360
    s_nop 0
    buffer_load_dwordx4 v10, s[4:7], s58 offen  lds
    s_add_u32 m0, s57, 145408
    s_nop 0
    buffer_load_dwordx4 v11, s[4:7], s58 offen  lds
    s_add_u32 s58, s58, 128
    s_cmp_eq_u32 s58, 1280
    s_cselect_b32 s58, 0, s58
    s_waitcnt vmcnt(8)
    s_barrier
    s_cmp_le_i32 s71, 14
    s_cselect_b32 s74, s73, s72
    s_add_u32 s74, s74, 71680
    s_add_u32 s78, s74, 4096
    buffer_load_dwordx4 v[128:131], v2, s[8:11], s74 offen offset:0 sc1
    buffer_load_dwordx4 v[132:135], v2, s[8:11], s74 offen offset:1024 sc1
    buffer_load_dwordx4 v[136:139], v2, s[8:11], s74 offen offset:2048 sc1
    buffer_load_dwordx4 v[140:143], v2, s[8:11], s74 offen offset:3072 sc1
    buffer_load_dwordx4 v[144:147], v2, s[8:11], s78 offen offset:0 sc1
    s_barrier
    buffer_load_dwordx4 v[16:19], v12, s[8:11], 0 offen offset:0 sc1
    buffer_load_dwordx4 v[20:23], v12, s[8:11], 0 offen offset:16 sc1
    buffer_load_dwordx4 v[24:27], v12, s[8:11], s28 offen offset:0 sc1
    buffer_load_dwordx4 v[28:31], v12, s[8:11], s28 offen offset:16 sc1
    s_add_u32 m0, s57, 98304
    s_nop 0
    buffer_load_dwordx4 v4, s[4:7], s58 offen  lds
    s_add_u32 m0, s57, 100352
    s_nop 0
    buffer_load_dwordx4 v5, s[4:7], s58 offen  lds
    s_add_u32 m0, s57, 102400
    s_nop 0
    buffer_load_dwordx4 v6, s[4:7], s58 offen  lds
    s_add_u32 m0, s57, 104448
    s_nop 0
    buffer_load_dwordx4 v7, s[4:7], s58 offen  lds
    s_add_u32 m0, s57, 106496
    s_nop 0
    buffer_load_dwordx4 v8, s[4:7], s58 offen  lds
    s_add_u32 m0, s57, 108544
    s_nop 0
    buffer_load_dwordx4 v9, s[4:7], s58 offen  lds
    s_add_u32 m0, s57, 110592
    s_nop 0
    buffer_load_dwordx4 v10, s[4:7], s58 offen  lds
    s_add_u32 m0, s57, 112640
    s_nop 0
    buffer_load_dwordx4 v11, s[4:7], s58 offen  lds
    s_add_u32 s58, s58, 128
    s_cmp_eq_u32 s58, 1280
    s_cselect_b32 s58, 0, s58
    s_waitcnt vmcnt(17)
    s_barrier
    s_cmp_le_u32 s76, 10
    s_cselect_b32 s74, s75, s77
    s_add_u32 m0, 122880, 0
    s_add_u32 s78, s74, 174080
    buffer_load_dwordx4 v2, s[8:11], s78 offen sc1 lds
    s_add_u32 m0, 123904, 0
    s_add_u32 s78, s74, 175104
    buffer_load_dwordx4 v2, s[8:11], s78 offen sc1 lds
    s_add_u32 m0, 124928, 0
    s_add_u32 s78, s74, 176128
    buffer_load_dwordx4 v2, s[8:11], s78 offen sc1 lds
    s_add_u32 m0, 125952, 0
    s_add_u32 s78, s74, 177152
    buffer_load_dwordx4 v2, s[8:11], s78 offen sc1 lds
    s_add_u32 m0, 126976, 0
    s_add_u32 s78, s74, 178176
    buffer_load_dwordx4 v2, s[8:11], s78 offen sc1 lds
    s_cmp_le_u32 s76, 11
    s_cselect_b32 s74, s75, s77
    s_add_u32 m0, 128000, 0
    s_add_u32 s78, s74, 179200
    buffer_load_dwordx4 v2, s[8:11], s78 offen sc1 lds
    s_add_u32 m0, 129024, 0
    s_add_u32 s78, s74, 180224
    buffer_load_dwordx4 v2, s[8:11], s78 offen sc1 lds
    s_add_u32 m0, 130048, 0
    s_add_u32 s78, s74, 181248
    buffer_load_dwordx4 v2, s[8:11], s78 offen sc1 lds
    s_barrier
    s_waitcnt vmcnt(16)
    s_mov_b32 s53, 0
L_xl_rs3:
    v_cmp_ne_u64 vcc, s[12:13], v[18:19]
    v_cmp_ne_u64 s[68:69], s[12:13], v[22:23]
    s_nop 0
    s_or_b64 vcc, vcc, s[68:69]
    v_cmp_ne_u64 s[68:69], s[12:13], v[26:27]
    s_nop 0
    s_or_b64 vcc, vcc, s[68:69]
    v_cmp_ne_u64 s[68:69], s[12:13], v[30:31]
    s_nop 0
    s_or_b64 vcc, vcc, s[68:69]
    s_cbranch_vccz L_xl_rx3
    s_add_u32 s53, s53, 1
    s_cmp_gt_u32 s53, 0x100000
    s_cbranch_scc1 L_xl_rx3
    s_sleep 2
    buffer_load_dwordx4 v[16:19], v12, s[8:11], 0 offen offset:0 sc1
    buffer_load_dwordx4 v[20:23], v12, s[8:11], 0 offen offset:16 sc1
    buffer_load_dwordx4 v[24:27], v12, s[8:11], s28 offen offset:0 sc1
    buffer_load_dwordx4 v[28:31], v12, s[8:11], s28 offen offset:16 sc1
    s_waitcnt vmcnt(0)
    s_branch L_xl_rs3
L_xl_rx3:
    v_add_f32 v16, v16, v24
    v_add_f32 v17, v17, v25
    v_add_f32 v20, v20, v28
    v_add_f32 v21, v21, v29
    v_mov_b32 v18, v20
    v_mov_b32 v19, v21
    ds_write_b128 v13, v[16:19]
    s_cmp_le_i32 s71, 16
    s_cselect_b32 s74, s73, s72
    s_add_u32 s74, s74, 81920
    s_add_u32 s78, s74, 4096
    buffer_load_dwordx4 v[148:151], v2, s[8:11], s74 offen offset:0 sc1
    buffer_load_dwordx4 v[152:155], v2, s[8:11], s74 offen offset:1024 sc1
    buffer_load_dwordx4 v[156:159], v2, s[8:11], s74 offen offset:2048 sc1
    buffer_load_dwordx4 v[160:163], v2, s[8:11], s74 offen offset:3072 sc1
    buffer_load_dwordx4 v[164:167], v2, s[8:11], s78 offen offset:0 sc1
    s_waitcnt vmcnt(13)
    s_barrier
    s_cmp_le_u32 s76, 12
    s_cselect_b32 s74, s75, s77
    s_add_u32 m0, 137216, 0
    s_add_u32 s78, s74, 188416
    buffer_load_dwordx4 v2, s[8:11], s78 offen sc1 lds
    s_cmp_le_u32 s76, 13
    s_cselect_b32 s74, s75, s77
    s_add_u32 m0, 138240, 0
    s_add_u32 s78, s74, 189440
    buffer_load_dwordx4 v2, s[8:11], s78 offen sc1 lds
    s_add_u32 m0, 139264, 0
    s_add_u32 s78, s74, 190464
    buffer_load_dwordx4 v2, s[8:11], s78 offen sc1 lds
    s_add_u32 m0, 140288, 0
    s_add_u32 s78, s74, 191488
    buffer_load_dwordx4 v2, s[8:11], s78 offen sc1 lds
    s_add_u32 m0, 141312, 0
    s_add_u32 s78, s74, 192512
    buffer_load_dwordx4 v2, s[8:11], s78 offen sc1 lds
    s_add_u32 m0, 142336, 0
    s_add_u32 s78, s74, 193536
    buffer_load_dwordx4 v2, s[8:11], s78 offen sc1 lds
    s_barrier
    s_cmp_le_i32 s71, 18
    s_cselect_b32 s74, s73, s72
    s_add_u32 s74, s74, 92160
    s_add_u32 s78, s74, 4096
    buffer_load_dwordx4 v[168:171], v2, s[8:11], s74 offen offset:0 sc1
    buffer_load_dwordx4 v[172:175], v2, s[8:11], s74 offen offset:1024 sc1
    buffer_load_dwordx4 v[176:179], v2, s[8:11], s74 offen offset:2048 sc1
    buffer_load_dwordx4 v[180:183], v2, s[8:11], s74 offen offset:3072 sc1
    buffer_load_dwordx4 v[184:187], v2, s[8:11], s78 offen offset:0 sc1
    s_waitcnt lgkmcnt(0)
    s_barrier
    s_cmp_le_u32 s76, 6
    s_cselect_b32 s74, s75, s77
    s_add_u32 m0, 106496, 0
    s_add_u32 s78, s74, 157696
    buffer_load_dwordx4 v2, s[8:11], s78 offen sc1 lds
    s_cmp_le_u32 s76, 7
    s_cselect_b32 s74, s75, s77
    s_add_u32 m0, 107520, 0
    s_add_u32 s78, s74, 158720
    buffer_load_dwordx4 v2, s[8:11], s78 offen sc1 lds
    s_add_u32 m0, 108544, 0
    s_add_u32 s78, s74, 159744
    buffer_load_dwordx4 v2, s[8:11], s78 offen sc1 lds
    s_add_u32 m0, 109568, 0
    s_add_u32 s78, s74, 160768
    buffer_load_dwordx4 v2, s[8:11], s78 offen sc1 lds
    s_add_u32 m0, 110592, 0
    s_add_u32 s78, s74, 161792
    buffer_load_dwordx4 v2, s[8:11], s78 offen sc1 lds
    s_add_u32 m0, 111616, 0
    s_add_u32 s78, s74, 162816
    buffer_load_dwordx4 v2, s[8:11], s78 offen sc1 lds
    s_cmp_le_u32 s76, 8
    s_cselect_b32 s74, s75, s77
    s_add_u32 m0, 112640, 0
    s_add_u32 s78, s74, 163840
    buffer_load_dwordx4 v2, s[8:11], s78 offen sc1 lds
    s_add_u32 m0, 113664, 0
    s_add_u32 s78, s74, 164864
    buffer_load_dwordx4 v2, s[8:11], s78 offen sc1 lds
    s_cmp_le_i32 s71, 20
    s_cselect_b32 s74, s73, s72
    s_add_u32 s74, s74, 102400
    s_add_u32 s78, s74, 4096
    buffer_load_dwordx4 v[188:191], v2, s[8:11], s74 offen offset:0 sc1
    buffer_load_dwordx4 v[192:195], v2, s[8:11], s74 offen offset:1024 sc1
    buffer_load_dwordx4 v[196:199], v2, s[8:11], s74 offen offset:2048 sc1
    buffer_load_dwordx4 v[200:203], v2, s[8:11], s74 offen offset:3072 sc1
    buffer_load_dwordx4 v[204:207], v2, s[8:11], s78 offen offset:0 sc1
    s_cmp_le_i32 s71, 22
    s_cselect_b32 s74, s73, s72
    s_add_u32 s74, s74, 112640
    s_add_u32 s78, s74, 4096
    buffer_load_dwordx4 v[208:211], v2, s[8:11], s74 offen offset:0 sc1
    buffer_load_dwordx4 v[212:215], v2, s[8:11], s74 offen offset:1024 sc1
    buffer_load_dwordx4 v[216:219], v2, s[8:11], s74 offen offset:2048 sc1
    buffer_load_dwordx4 v[220:223], v2, s[8:11], s74 offen offset:3072 sc1
    buffer_load_dwordx4 v[224:227], v2, s[8:11], s78 offen offset:0 sc1
    s_branch L_p2_help
L_dft_ld:
    s_setprio 2
    v_lshrrev_b32 v2, 3, v0
    v_lshrrev_b32 v3, 4, v0
    v_and_b32 v4, 7, v0
    v_mul_u32_u24 v5, 81920, v2
    v_lshl_add_u32 v5, v4, 4, v5
    s_lshl_b32 s66, s54, 2
    s_add_u32 s66, s66, s48
    s_and_b32 s63, s15, 3
    s_add_u32 s53, s63, 0
    s_and_b32 s68, s53, 3
    s_lshl_b32 s53, s68, 9
    s_add_u32 s53, s53, s66
    s_mul_i32 s56, s53, 1280
    s_add_u32 s53, s63, 1
    s_and_b32 s69, s53, 3
    s_lshl_b32 s53, s69, 9
    s_add_u32 s53, s53, s66
    s_mul_i32 s57, s53, 1280
    s_add_u32 s53, s63, 2
    s_and_b32 s70, s53, 3
    s_lshl_b32 s53, s70, 9
    s_add_u32 s53, s53, s66
    s_mul_i32 s58, s53, 1280
    s_add_u32 s53, s63, 3
    s_and_b32 s71, s53, 3
    s_lshl_b32 s53, s71, 9
    s_add_u32 s53, s53, s66
    s_mul_i32 s59, s53, 1280
    s_and_b32 s74, s54, 3
    s_lshl_b32 s75, s14, 1
    s_add_u32 s74, s74, s75
    s_cmp_ge_u32 s74, 5
    s_cselect_b32 s75, 5, 0
    s_sub_u32 s74, s74, s75
    s_lshl_b32 s74, s74, 7
    s_mov_b32 s75, s74
    v_add_u32 v208, s74, v5
    s_add_u32 s74, s74, 128
    s_cmp_eq_u32 s74, 640
    s_cselect_b32 s74, 0, s74
    v_add_u32 v209, s74, v5
    s_add_u32 s74, s74, 128
    s_cmp_eq_u32 s74, 640
    s_cselect_b32 s74, 0, s74
    v_add_u32 v210, s74, v5
    s_add_u32 s74, s74, 128
    s_cmp_eq_u32 s74, 640
    s_cselect_b32 s74, 0, s74
    v_add_u32 v211, s74, v5
    s_add_u32 s74, s74, 128
    s_cmp_eq_u32 s74, 640
    s_cselect_b32 s74, 0, s74
    v_add_u32 v212, s74, v5
    s_mov_b32 s6, 0x280000
    s_mov_b32 s7, 0x20000
    s_mov_b32 s23, 0x20000
    s_waitcnt lgkmcnt(0)
    s_mov_b32 s4, s28
    s_mov_b32 s5, s29
    buffer_load_dwordx4 v[32:35], v208, s[4:7], s56 offen
    buffer_load_dwordx4 v[36:39], v208, s[4:7], s56 offen offset:640
    buffer_load_dwordx4 v[40:43], v208, s[4:7], s57 offen
    buffer_load_dwordx4 v[44:47], v208, s[4:7], s57 offen offset:640
    buffer_load_dwordx4 v[48:51], v208, s[4:7], s58 offen
    buffer_load_dwordx4 v[52:55], v208, s[4:7], s58 offen offset:640
    buffer_load_dwordx4 v[56:59], v208, s[4:7], s59 offen
    buffer_load_dwordx4 v[60:63], v208, s[4:7], s59 offen offset:640
    s_load_dwordx2 s[12:13], s[46:47], 0x18000
    s_lshr_b32 s51, s50, 2
    s_lshr_b32 s53, s49, 1
    s_lshl_b32 s53, s53, 3
    s_add_u32 s51, s51, s53
    s_and_b32 s52, s50, 3
    s_and_b32 s53, s49, 1
    s_lshl_b32 s53, s53, 2
    s_add_u32 s52, s52, s53
    s_mov_b32 s10, 0xc00000
    s_mov_b32 s11, 0x20000
    s_mov_b32 s18, 0x280000
    s_mov_b32 s19, 0x20000
    s_mov_b32 s8, s46
    s_mov_b32 s9, s47
    s_mov_b32 s16, s42
    s_mov_b32 s17, s43
    s_cmp_lt_u32 s48, 2
    s_cselect_b32 s20, s32, s34
    s_cselect_b32 s21, s33, s35
    s_mov_b32 s22, 0xc8000
    v_xor_b32 v3, v3, v4
    v_lshlrev_b32 v3, 4, v3
    v_mul_u32_u24 v6, 2560, v2
    v_add_u32 v6, v6, v3
    v_xor_b32 v7, 64, v6
    s_or_b32 s60, s55, s48
    s_or_b32 s60, s60, s14
    s_cmp_eq_u32 s60, 0
    s_cselect_b32 s60, 409600, 0
    v_cmp_gt_u32 vcc, 8, v0
    v_mov_b32 v8, s60
    s_nop 0
    v_cndmask_b32 v8, 0, v8, vcc
    v_add_u32 v8, v8, v6
    s_and_b32 s60, s48, 1
    s_mul_i32 s60, s60, 96
    s_lshl_b32 s61, s14, 7
    s_add_u32 s60, s60, s61
    s_add_u32 s60, s60, s55
    s_mul_i32 s60, s60, 1280
    s_mul_i32 s61, s48, 6144
    s_add_u32 s76, s60, s75
    s_add_u32 m0, s61, 32768
    s_add_u32 s62, s76, 0
    buffer_load_dwordx4 v8, s[20:23], s62 offen lds
    s_add_u32 m0, s61, 33792
    s_add_u32 s62, s76, 20480
    buffer_load_dwordx4 v7, s[20:23], s62 offen lds
    s_add_u32 m0, s61, 34816
    s_add_u32 s62, s76, 40960
    buffer_load_dwordx4 v6, s[20:23], s62 offen lds
    s_add_u32 m0, s61, 35840
    s_add_u32 s62, s76, 61440
    buffer_load_dwordx4 v7, s[20:23], s62 offen lds
    s_add_u32 m0, s61, 36864
    s_add_u32 s62, s76, 81920
    buffer_load_dwordx4 v6, s[20:23], s62 offen lds
    s_add_u32 m0, s61, 37888
    s_add_u32 s62, s76, 102400
    buffer_load_dwordx4 v7, s[20:23], s62 offen lds
    buffer_load_dwordx4 v[96:99], v210, s[4:7], s56 offen
    buffer_load_dwordx4 v[100:103], v210, s[4:7], s56 offen offset:640
    buffer_load_dwordx4 v[128:131], v211, s[4:7], s56 offen
    buffer_load_dwordx4 v[132:135], v211, s[4:7], s56 offen offset:640
    buffer_load_dwordx4 v[160:163], v212, s[4:7], s56 offen
    buffer_load_dwordx4 v[164:167], v212, s[4:7], s56 offen offset:640
    s_lshl_b32 s53, s48, 12
    s_add_u32 s53, s53, 0
    v_lshl_add_u32 v9, v2, 7, v3
    v_add_u32 v9, s53, v9
    s_and_b32 s53, s68, 1
    s_lshl_b32 s53, s53, 6
    v_xor_b32 v213, s53, v9
    s_lshl_b32 s53, s68, 10
    v_add_u32 v213, s53, v213
    s_and_b32 s53, s69, 1
    s_lshl_b32 s53, s53, 6
    v_xor_b32 v214, s53, v9
    s_lshl_b32 s53, s69, 10
    v_add_u32 v214, s53, v214
    s_and_b32 s53, s70, 1
    s_lshl_b32 s53, s53, 6
    v_xor_b32 v215, s53, v9
    s_lshl_b32 s53, s70, 10
    v_add_u32 v215, s53, v215
    s_and_b32 s53, s71, 1
    s_lshl_b32 s53, s53, 6
    v_xor_b32 v216, s53, v9
    s_lshl_b32 s53, s71, 10
    v_add_u32 v216, s53, v216
    s_cmp_eq_u32 s55, 0
    s_cselect_b32 s53, 1.0, -1.0
    v_mov_b32 v12, s53
    s_cselect_b32 s78, 0x3d800000, 0
    s_mov_b32 s77, 0xffff0000
    v_mov_b32 v192, 0
    v_mov_b32 v193, 0
    v_mov_b32 v194, 0
    v_mov_b32 v195, 0
    v_mov_b32 v196, 0
    v_mov_b32 v197, 0
    v_mov_b32 v198, 0
    v_mov_b32 v199, 0
    v_lshlrev_b32 v4, 10, v2
    s_lshl_b32 s65, s66, 4
    s_add_u32 s65, s65, 0x20000
    s_lshl_b32 s64, s63, 13
    s_add_u32 s64, s64, s65
    v_and_b32 v3, 31, v0
    v_lshlrev_b32 v10, 10, v3
    s_lshl_b32 s53, s48, 7
    s_add_u32 s53, s53, 155648
    v_lshl_add_u32 v3, v3, 2, s53
    s_and_b32 s41, s48, 1
    s_lshr_b32 s42, s48, 1
    s_lshl_b32 s38, s51, 9
    s_add_u32 s38, s38, 0x80000
    s_lshl_b32 s43, s41, 1
    s_add_u32 s44, s43, s42
    s_sub_u32 s43, s43, s42
    s_add_u32 s43, s43, 1
    v_and_b32 v217, 15, v0
    v_lshrrev_b32 v218, 4, v0
    s_lshl_b32 s39, s44, 9
    s_add_u32 s39, s39, s51
    s_mul_i32 s39, s39, 1280
    s_mul_i32 s53, s52, 160
    s_add_u32 s39, s39, s53
    s_mul_i32 s40, s48, 3072
    s_add_u32 s40, s40, 151552
    v_add_u32 v219, 0, v0
    v_min_u32 v219, 159, v219
    v_mul_u32_u24 v220, 205, v219
    v_lshrrev_b32 v220, 11, v220
    v_mul_u32_u24 v220, 40800, v220
    v_lshl_add_u32 v228, v219, 4, v220
    v_add_u32 v219, 64, v0
    v_min_u32 v219, 159, v219
    v_mul_u32_u24 v220, 205, v219
    v_lshrrev_b32 v220, 11, v220
    v_mul_u32_u24 v220, 40800, v220
    v_lshl_add_u32 v229, v219, 4, v220
    v_add_u32 v219, 128, v0
    v_min_u32 v219, 159, v219
    v_mul_u32_u24 v220, 205, v219
    v_lshrrev_b32 v220, 11, v220
    v_mul_u32_u24 v220, 40800, v220
    v_lshl_add_u32 v230, v219, 4, v220
    v_mul_u32_u24 v219, 160, v217
    v_and_b32 v220, 1, v218
    v_lshl_add_u32 v219, v220, 4, v219
    v_add_u32 v231, s40, v219
    s_lshr_b32 s45, s52, 2
    s_lshl_b32 s47, s45, 31
    s_or_b32 s47, s47, 0x3a000000
    s_mul_i32 s46, s45, 640
    s_lshl_b32 s45, s45, 1
    s_sub_u32 s45, 1, s45
    s_mul_i32 s53, s52, 80
    v_mul_u32_u24 v222, 163840, v218
    v_and_b32 v227, 7, v0
    v_bfe_u32 v219, v0, 3, 1
    v_lshl_add_u32 v227, v227, 1, v219
    v_add_u32 v219, s53, v227
    v_add_u32 v219, 0, v219
    v_mul_lo_u32 v219, v219, s45
    v_add_u32 v219, s46, v219
    v_and_b32 v220, 1, v219
    v_mul_u32_u24 v220, 81920, v220
    v_add_u32 v220, v220, v222
    v_lshrrev_b32 v221, 1, v219
    v_cmp_eq_u32 vcc, 160, v221
    s_nop 1
    v_cndmask_b32 v221, v221, 0, vcc
    v_lshl_add_u32 v248, v221, 4, v220
    v_cmp_eq_u32 vcc, 0, v219
    v_mov_b32 v221, 0x7ffffff0
    s_nop 0
    v_cndmask_b32 v248, v248, v221, vcc
    v_add_u32 v219, s53, v227
    v_add_u32 v219, 16, v219
    v_mul_lo_u32 v219, v219, s45
    v_add_u32 v219, s46, v219
    v_and_b32 v220, 1, v219
    v_mul_u32_u24 v220, 81920, v220
    v_add_u32 v220, v220, v222
    v_lshrrev_b32 v221, 1, v219
    v_cmp_eq_u32 vcc, 160, v221
    s_nop 1
    v_cndmask_b32 v221, v221, 0, vcc
    v_lshl_add_u32 v249, v221, 4, v220
    v_add_u32 v219, s53, v227
    v_add_u32 v219, 32, v219
    v_mul_lo_u32 v219, v219, s45
    v_add_u32 v219, s46, v219
    v_and_b32 v220, 1, v219
    v_mul_u32_u24 v220, 81920, v220
    v_add_u32 v220, v220, v222
    v_lshrrev_b32 v221, 1, v219
    v_cmp_eq_u32 vcc, 160, v221
    s_nop 1
    v_cndmask_b32 v221, v221, 0, vcc
    v_lshl_add_u32 v250, v221, 4, v220
    v_add_u32 v219, s53, v227
    v_add_u32 v219, 48, v219
    v_mul_lo_u32 v219, v219, s45
    v_add_u32 v219, s46, v219
    v_and_b32 v220, 1, v219
    v_mul_u32_u24 v220, 81920, v220
    v_add_u32 v220, v220, v222
    v_lshrrev_b32 v221, 1, v219
    v_cmp_eq_u32 vcc, 160, v221
    s_nop 1
    v_cndmask_b32 v221, v221, 0, vcc
    v_lshl_add_u32 v251, v221, 4, v220
    v_add_u32 v219, s53, v227
    v_add_u32 v219, 64, v219
    v_mul_lo_u32 v219, v219, s45
    v_add_u32 v219, s46, v219
    v_and_b32 v220, 1, v219
    v_mul_u32_u24 v220, 81920, v220
    v_add_u32 v220, v220, v222
    v_lshrrev_b32 v221, 1, v219
    v_cmp_eq_u32 vcc, 160, v221
    s_nop 1
    v_cndmask_b32 v221, v221, 0, vcc
    v_lshl_add_u32 v252, v221, 4, v220
    s_mul_i32 s45, s45, s51
    s_and_b32 s45, s45, 31
    s_mul_i32 s36, s45, 2560
    s_mul_i32 s37, s42, 1310720
    s_add_u32 s36, s36, s37
    s_add_u32 s36, s36, 0x300000
    s_add_u32 s37, s36, 655360
    s_lshr_b32 s45, s45, 3
    s_lshl_b32 s53, s44, 9
    s_add_u32 s53, s53, s51
    v_lshl_add_u32 v219, v217, 5, s53
    s_lshl_b32 s53, s43, 9
    s_add_u32 s53, s53, s51
    v_lshl_add_u32 v220, v217, 5, s53
    s_sub_u32 s53, 4, s45
    s_and_b32 s53, s53, 3
    s_lshl_b32 s46, s42, 5
    s_add_u32 s53, s53, s46
    v_lshl_add_u32 v221, v218, 2, s53
    v_add_u32 v222, 16, v221
    v_mul_u32_u24 v223, v219, v221
    v_and_b32 v223, 2047, v223
    v_cvt_f32_u32 v223, v223
    v_mul_f32 v223, s47, v223
    v_sin_f32 v224, v223
    v_cos_f32 v223, v223
    v_mul_u32_u24 v225, v219, v222
    v_and_b32 v225, 2047, v225
    v_cvt_f32_u32 v225, v225
    v_mul_f32 v225, s47, v225
    v_sin_f32 v226, v225
    v_cos_f32 v225, v225
    s_nop 0
    v_cvt_pk_bf16_f32 v232, v223, v224
    v_cvt_pk_bf16_f32 v236, v225, v226
    v_mul_u32_u24 v223, v220, v221
    v_and_b32 v223, 2047, v223
    v_cvt_f32_u32 v223, v223
    v_mul_f32 v223, s47, v223
    v_sin_f32 v224, v223
    v_cos_f32 v223, v223
    v_mul_u32_u24 v225, v220, v222
    v_and_b32 v225, 2047, v225
    v_cvt_f32_u32 v225, v225
    v_mul_f32 v225, s47, v225
    v_sin_f32 v226, v225
    v_cos_f32 v225, v225
    s_nop 0
    v_cvt_pk_bf16_f32 v240, v223, v224
    v_cvt_pk_bf16_f32 v244, v225, v226
    s_sub_u32 s53, 5, s45
    s_and_b32 s53, s53, 3
    s_lshl_b32 s46, s42, 5
    s_add_u32 s53, s53, s46
    v_lshl_add_u32 v221, v218, 2, s53
    v_add_u32 v222, 16, v221
    v_mul_u32_u24 v223, v219, v221
    v_and_b32 v223, 2047, v223
    v_cvt_f32_u32 v223, v223
    v_mul_f32 v223, s47, v223
    v_sin_f32 v224, v223
    v_cos_f32 v223, v223
    v_mul_u32_u24 v225, v219, v222
    v_and_b32 v225, 2047, v225
    v_cvt_f32_u32 v225, v225
    v_mul_f32 v225, s47, v225
    v_sin_f32 v226, v225
    v_cos_f32 v225, v225
    s_nop 0
    v_cvt_pk_bf16_f32 v233, v223, v224
    v_cvt_pk_bf16_f32 v237, v225, v226
    v_mul_u32_u24 v223, v220, v221
    v_and_b32 v223, 2047, v223
    v_cvt_f32_u32 v223, v223
    v_mul_f32 v223, s47, v223
    v_sin_f32 v224, v223
    v_cos_f32 v223, v223
    v_mul_u32_u24 v225, v220, v222
    v_and_b32 v225, 2047, v225
    v_cvt_f32_u32 v225, v225
    v_mul_f32 v225, s47, v225
    v_sin_f32 v226, v225
    v_cos_f32 v225, v225
    s_nop 0
    v_cvt_pk_bf16_f32 v241, v223, v224
    v_cvt_pk_bf16_f32 v245, v225, v226
    s_sub_u32 s53, 6, s45
    s_and_b32 s53, s53, 3
    s_lshl_b32 s46, s42, 5
    s_add_u32 s53, s53, s46
    v_lshl_add_u32 v221, v218, 2, s53
    v_add_u32 v222, 16, v221
    v_mul_u32_u24 v223, v219, v221
    v_and_b32 v223, 2047, v223
    v_cvt_f32_u32 v223, v223
    v_mul_f32 v223, s47, v223
    v_sin_f32 v224, v223
    v_cos_f32 v223, v223
    v_mul_u32_u24 v225, v219, v222
    v_and_b32 v225, 2047, v225
    v_cvt_f32_u32 v225, v225
    v_mul_f32 v225, s47, v225
    v_sin_f32 v226, v225
    v_cos_f32 v225, v225
    s_nop 0
    v_cvt_pk_bf16_f32 v234, v223, v224
    v_cvt_pk_bf16_f32 v238, v225, v226
    v_mul_u32_u24 v223, v220, v221
    v_and_b32 v223, 2047, v223
    v_cvt_f32_u32 v223, v223
    v_mul_f32 v223, s47, v223
    v_sin_f32 v224, v223
    v_cos_f32 v223, v223
    v_mul_u32_u24 v225, v220, v222
    v_and_b32 v225, 2047, v225
    v_cvt_f32_u32 v225, v225
    v_mul_f32 v225, s47, v225
    v_sin_f32 v226, v225
    v_cos_f32 v225, v225
    s_nop 0
    v_cvt_pk_bf16_f32 v242, v223, v224
    v_cvt_pk_bf16_f32 v246, v225, v226
    s_sub_u32 s53, 7, s45
    s_and_b32 s53, s53, 3
    s_lshl_b32 s46, s42, 5
    s_add_u32 s53, s53, s46
    v_lshl_add_u32 v221, v218, 2, s53
    v_add_u32 v222, 16, v221
    v_mul_u32_u24 v223, v219, v221
    v_and_b32 v223, 2047, v223
    v_cvt_f32_u32 v223, v223
    v_mul_f32 v223, s47, v223
    v_sin_f32 v224, v223
    v_cos_f32 v223, v223
    v_mul_u32_u24 v225, v219, v222
    v_and_b32 v225, 2047, v225
    v_cvt_f32_u32 v225, v225
    v_mul_f32 v225, s47, v225
    v_sin_f32 v226, v225
    v_cos_f32 v225, v225
    s_nop 0
    v_cvt_pk_bf16_f32 v235, v223, v224
    v_cvt_pk_bf16_f32 v239, v225, v226
    v_mul_u32_u24 v223, v220, v221
    v_and_b32 v223, 2047, v223
    v_cvt_f32_u32 v223, v223
    v_mul_f32 v223, s47, v223
    v_sin_f32 v224, v223
    v_cos_f32 v223, v223
    v_mul_u32_u24 v225, v220, v222
    v_and_b32 v225, 2047, v225
    v_cvt_f32_u32 v225, v225
    v_mul_f32 v225, s47, v225
    v_sin_f32 v226, v225
    v_cos_f32 v225, v225
    s_nop 0
    v_cvt_pk_bf16_f32 v243, v223, v224
    v_cvt_pk_bf16_f32 v247, v225, v226
    s_waitcnt lgkmcnt(0)
    s_add_u32 s12, s12, 1
    s_add_u32 s13, s13, 1
    s_waitcnt vmcnt(12)
    v_lshlrev_b32 v16, 16, v32
    v_and_b32 v17, s77, v32
    v_lshlrev_b32 v24, 16, v36
    v_and_b32 v25, s77, v36
    v_lshlrev_b32 v18, 16, v33
    v_and_b32 v19, s77, v33
    v_lshlrev_b32 v26, 16, v37
    v_and_b32 v27, s77, v37
    v_lshlrev_b32 v20, 16, v34
    v_and_b32 v21, s77, v34
    v_lshlrev_b32 v28, 16, v38
    v_and_b32 v29, s77, v38
    v_lshlrev_b32 v22, 16, v35
    v_and_b32 v23, s77, v35
    v_lshlrev_b32 v30, 16, v39
    v_and_b32 v31, s77, v39
    v_add_f32 v192, v192, v16
    v_fmac_f32 v196, v16, v16
    v_add_f32 v193, v193, v17
    v_fmac_f32 v197, v17, v17
    v_add_f32 v194, v194, v18
    v_fmac_f32 v198, v18, v18
    v_add_f32 v195, v195, v19
    v_fmac_f32 v199, v19, v19
    v_add_f32 v192, v192, v20
    v_fmac_f32 v196, v20, v20
    v_add_f32 v193, v193, v21
    v_fmac_f32 v197, v21, v21
    v_add_f32 v194, v194, v22
    v_fmac_f32 v198, v22, v22
    v_add_f32 v195, v195, v23
    v_fmac_f32 v199, v23, v23
    v_add_f32 v192, v192, v24
    v_fmac_f32 v196, v24, v24
    v_add_f32 v193, v193, v25
    v_fmac_f32 v197, v25, v25
    v_add_f32 v194, v194, v26
    v_fmac_f32 v198, v26, v26
    v_add_f32 v195, v195, v27
    v_fmac_f32 v199, v27, v27
    v_add_f32 v192, v192, v28
    v_fmac_f32 v196, v28, v28
    v_add_f32 v193, v193, v29
    v_fmac_f32 v197, v29, v29
    v_add_f32 v194, v194, v30
    v_fmac_f32 v198, v30, v30
    v_add_f32 v195, v195, v31
    v_fmac_f32 v199, v31, v31
    v_add_f32 v204, v16, v17
    v_add_f32 v13, v24, v25
    v_add_f32 v204, v204, v13
    s_nop 1
    v_add_f32 v204, v204, v204 quad_perm:[1,0,3,2] row_mask:0xf bank_mask:0xf
    s_nop 1
    v_add_f32 v204, v204, v204 quad_perm:[2,3,0,1] row_mask:0xf bank_mask:0xf
    s_nop 1
    v_add_f32 v204, v204, v204 row_half_mirror row_mask:0xf bank_mask:0xf
    v_mul_f32 v204, s78, v204
    v_sub_f32 v16, v16, v204
    v_sub_f32 v17, v17, v204
    v_sub_f32 v18, v18, v204
    v_sub_f32 v19, v19, v204
    v_sub_f32 v20, v20, v204
    v_sub_f32 v21, v21, v204
    v_sub_f32 v22, v22, v204
    v_sub_f32 v23, v23, v204
    v_fmac_f32 v16, v12, v24
    v_fmac_f32 v17, v12, v25
    v_fmac_f32 v18, v12, v26
    v_fmac_f32 v19, v12, v27
    v_fmac_f32 v20, v12, v28
    v_fmac_f32 v21, v12, v29
    v_fmac_f32 v22, v12, v30
    v_fmac_f32 v23, v12, v31
    v_cvt_pk_bf16_f32 v32, v16, v17
    v_cvt_pk_bf16_f32 v33, v18, v19
    v_cvt_pk_bf16_f32 v34, v20, v21
    v_cvt_pk_bf16_f32 v35, v22, v23
    ds_write_b128 v213, v[32:35] offset:0
    v_lshlrev_b32 v16, 16, v40
    v_and_b32 v17, s77, v40
    v_lshlrev_b32 v24, 16, v44
    v_and_b32 v25, s77, v44
    v_lshlrev_b32 v18, 16, v41
    v_and_b32 v19, s77, v41
    v_lshlrev_b32 v26, 16, v45
    v_and_b32 v27, s77, v45
    v_lshlrev_b32 v20, 16, v42
    v_and_b32 v21, s77, v42
    v_lshlrev_b32 v28, 16, v46
    v_and_b32 v29, s77, v46
    v_lshlrev_b32 v22, 16, v43
    v_and_b32 v23, s77, v43
    v_lshlrev_b32 v30, 16, v47
    v_and_b32 v31, s77, v47
    v_add_f32 v205, v16, v17
    v_add_f32 v13, v24, v25
    v_add_f32 v205, v205, v13
    s_nop 1
    v_add_f32 v205, v205, v205 quad_perm:[1,0,3,2] row_mask:0xf bank_mask:0xf
    s_nop 1
    v_add_f32 v205, v205, v205 quad_perm:[2,3,0,1] row_mask:0xf bank_mask:0xf
    s_nop 1
    v_add_f32 v205, v205, v205 row_half_mirror row_mask:0xf bank_mask:0xf
    v_mul_f32 v205, s78, v205
    v_sub_f32 v16, v16, v205
    v_sub_f32 v17, v17, v205
    v_sub_f32 v18, v18, v205
    v_sub_f32 v19, v19, v205
    v_sub_f32 v20, v20, v205
    v_sub_f32 v21, v21, v205
    v_sub_f32 v22, v22, v205
    v_sub_f32 v23, v23, v205
    v_fmac_f32 v16, v12, v24
    v_fmac_f32 v17, v12, v25
    v_fmac_f32 v18, v12, v26
    v_fmac_f32 v19, v12, v27
    v_fmac_f32 v20, v12, v28
    v_fmac_f32 v21, v12, v29
    v_fmac_f32 v22, v12, v30
    v_fmac_f32 v23, v12, v31
    v_cvt_pk_bf16_f32 v40, v16, v17
    v_cvt_pk_bf16_f32 v41, v18, v19
    v_cvt_pk_bf16_f32 v42, v20, v21
    v_cvt_pk_bf16_f32 v43, v22, v23
    ds_write_b128 v214, v[40:43] offset:0
    v_lshlrev_b32 v16, 16, v48
    v_and_b32 v17, s77, v48
    v_lshlrev_b32 v24, 16, v52
    v_and_b32 v25, s77, v52
    v_lshlrev_b32 v18, 16, v49
    v_and_b32 v19, s77, v49
    v_lshlrev_b32 v26, 16, v53
    v_and_b32 v27, s77, v53
    v_lshlrev_b32 v20, 16, v50
    v_and_b32 v21, s77, v50
    v_lshlrev_b32 v28, 16, v54
    v_and_b32 v29, s77, v54
    v_lshlrev_b32 v22, 16, v51
    v_and_b32 v23, s77, v51
    v_lshlrev_b32 v30, 16, v55
    v_and_b32 v31, s77, v55
    v_add_f32 v206, v16, v17
    v_add_f32 v13, v24, v25
    v_add_f32 v206, v206, v13
    s_nop 1
    v_add_f32 v206, v206, v206 quad_perm:[1,0,3,2] row_mask:0xf bank_mask:0xf
    s_nop 1
    v_add_f32 v206, v206, v206 quad_perm:[2,3,0,1] row_mask:0xf bank_mask:0xf
    s_nop 1
    v_add_f32 v206, v206, v206 row_half_mirror row_mask:0xf bank_mask:0xf
    v_mul_f32 v206, s78, v206
    v_sub_f32 v16, v16, v206
    v_sub_f32 v17, v17, v206
    v_sub_f32 v18, v18, v206
    v_sub_f32 v19, v19, v206
    v_sub_f32 v20, v20, v206
    v_sub_f32 v21, v21, v206
    v_sub_f32 v22, v22, v206
    v_sub_f32 v23, v23, v206
    v_fmac_f32 v16, v12, v24
    v_fmac_f32 v17, v12, v25
    v_fmac_f32 v18, v12, v26
    v_fmac_f32 v19, v12, v27
    v_fmac_f32 v20, v12, v28
    v_fmac_f32 v21, v12, v29
    v_fmac_f32 v22, v12, v30
    v_fmac_f32 v23, v12, v31
    v_cvt_pk_bf16_f32 v48, v16, v17
    v_cvt_pk_bf16_f32 v49, v18, v19
    v_cvt_pk_bf16_f32 v50, v20, v21
    v_cvt_pk_bf16_f32 v51, v22, v23
    ds_write_b128 v215, v[48:51] offset:0
    v_lshlrev_b32 v16, 16, v56
    v_and_b32 v17, s77, v56
    v_lshlrev_b32 v24, 16, v60
    v_and_b32 v25, s77, v60
    v_lshlrev_b32 v18, 16, v57
    v_and_b32 v19, s77, v57
    v_lshlrev_b32 v26, 16, v61
    v_and_b32 v27, s77, v61
    v_lshlrev_b32 v20, 16, v58
    v_and_b32 v21, s77, v58
    v_lshlrev_b32 v28, 16, v62
    v_and_b32 v29, s77, v62
    v_lshlrev_b32 v22, 16, v59
    v_and_b32 v23, s77, v59
    v_lshlrev_b32 v30, 16, v63
    v_and_b32 v31, s77, v63
    v_add_f32 v207, v16, v17
    v_add_f32 v13, v24, v25
    v_add_f32 v207, v207, v13
    s_nop 1
    v_add_f32 v207, v207, v207 quad_perm:[1,0,3,2] row_mask:0xf bank_mask:0xf
    s_nop 1
    v_add_f32 v207, v207, v207 quad_perm:[2,3,0,1] row_mask:0xf bank_mask:0xf
    s_nop 1
    v_add_f32 v207, v207, v207 row_half_mirror row_mask:0xf bank_mask:0xf
    v_mul_f32 v207, s78, v207
    v_sub_f32 v16, v16, v207
    v_sub_f32 v17, v17, v207
    v_sub_f32 v18, v18, v207
    v_sub_f32 v19, v19, v207
    v_sub_f32 v20, v20, v207
    v_sub_f32 v21, v21, v207
    v_sub_f32 v22, v22, v207
    v_sub_f32 v23, v23, v207
    v_fmac_f32 v16, v12, v24
    v_fmac_f32 v17, v12, v25
    v_fmac_f32 v18, v12, v26
    v_fmac_f32 v19, v12, v27
    v_fmac_f32 v20, v12, v28
    v_fmac_f32 v21, v12, v29
    v_fmac_f32 v22, v12, v30
    v_fmac_f32 v23, v12, v31
    v_cvt_pk_bf16_f32 v56, v16, v17
    v_cvt_pk_bf16_f32 v57, v18, v19
    v_cvt_pk_bf16_f32 v58, v20, v21
    v_cvt_pk_bf16_f32 v59, v22, v23
    ds_write_b128 v216, v[56:59] offset:0
    s_waitcnt vmcnt(6) lgkmcnt(0)
    s_barrier
    s_waitcnt vmcnt(0)
    buffer_load_dwordx4 v[64:67], v209, s[4:7], s56 offen
    v_lshlrev_b32 v16, 16, v96
    v_and_b32 v17, s77, v96
    v_lshlrev_b32 v24, 16, v100
    v_and_b32 v25, s77, v100
    v_lshlrev_b32 v18, 16, v97
    v_and_b32 v19, s77, v97
    v_lshlrev_b32 v26, 16, v101
    v_and_b32 v27, s77, v101
    v_lshlrev_b32 v20, 16, v98
    v_and_b32 v21, s77, v98
    v_lshlrev_b32 v28, 16, v102
    buffer_load_dwordx4 v[68:71], v209, s[4:7], s56 offen offset:640
    v_and_b32 v29, s77, v102
    v_lshlrev_b32 v22, 16, v99
    v_and_b32 v23, s77, v99
    v_lshlrev_b32 v30, 16, v103
    v_and_b32 v31, s77, v103
    v_add_f32 v192, v192, v16
    v_fmac_f32 v196, v16, v16
    v_add_f32 v193, v193, v17
    v_fmac_f32 v197, v17, v17
    v_add_f32 v194, v194, v18
    v_fmac_f32 v198, v18, v18
    buffer_load_dwordx4 v[72:75], v209, s[4:7], s57 offen
    v_add_f32 v195, v195, v19
    v_fmac_f32 v199, v19, v19
    v_add_f32 v192, v192, v20
    v_fmac_f32 v196, v20, v20
    v_add_f32 v193, v193, v21
    v_fmac_f32 v197, v21, v21
    v_add_f32 v194, v194, v22
    v_fmac_f32 v198, v22, v22
    v_add_f32 v195, v195, v23
    v_fmac_f32 v199, v23, v23
    v_add_f32 v192, v192, v24
    buffer_load_dwordx4 v[76:79], v209, s[4:7], s57 offen offset:640
    v_fmac_f32 v196, v24, v24
    v_add_f32 v193, v193, v25
    v_fmac_f32 v197, v25, v25
    v_add_f32 v194, v194, v26
    v_fmac_f32 v198, v26, v26
    v_add_f32 v195, v195, v27
    v_fmac_f32 v199, v27, v27
    v_add_f32 v192, v192, v28
    v_fmac_f32 v196, v28, v28
    v_add_f32 v193, v193, v29
    v_fmac_f32 v197, v29, v29
    buffer_load_dwordx4 v[80:83], v209, s[4:7], s58 offen
    v_add_f32 v194, v194, v30
    v_fmac_f32 v198, v30, v30
    v_add_f32 v195, v195, v31
    v_fmac_f32 v199, v31, v31
    v_lshlrev_b32 v16, 16, v128
    v_and_b32 v17, s77, v128
    v_lshlrev_b32 v24, 16, v132
    v_and_b32 v25, s77, v132
    v_lshlrev_b32 v18, 16, v129
    v_and_b32 v19, s77, v129
    v_lshlrev_b32 v26, 16, v133
    buffer_load_dwordx4 v[84:87], v209, s[4:7], s58 offen offset:640
    v_and_b32 v27, s77, v133
    v_lshlrev_b32 v20, 16, v130
    v_and_b32 v21, s77, v130
    v_lshlrev_b32 v28, 16, v134
    v_and_b32 v29, s77, v134
    v_lshlrev_b32 v22, 16, v131
    v_and_b32 v23, s77, v131
    v_lshlrev_b32 v30, 16, v135
    v_and_b32 v31, s77, v135
    v_add_f32 v192, v192, v16
    v_fmac_f32 v196, v16, v16
    buffer_load_dwordx4 v[88:91], v209, s[4:7], s59 offen
    v_add_f32 v193, v193, v17
    v_fmac_f32 v197, v17, v17
    v_add_f32 v194, v194, v18
    v_fmac_f32 v198, v18, v18
    v_add_f32 v195, v195, v19
    v_fmac_f32 v199, v19, v19
    v_add_f32 v192, v192, v20
    v_fmac_f32 v196, v20, v20
    v_add_f32 v193, v193, v21
    v_fmac_f32 v197, v21, v21
    v_add_f32 v194, v194, v22
    buffer_load_dwordx4 v[92:95], v209, s[4:7], s59 offen offset:640
    v_fmac_f32 v198, v22, v22
    v_add_f32 v195, v195, v23
    v_fmac_f32 v199, v23, v23
    v_add_f32 v192, v192, v24
    v_fmac_f32 v196, v24, v24
    v_add_f32 v193, v193, v25
    v_fmac_f32 v197, v25, v25
    v_add_f32 v194, v194, v26
    v_fmac_f32 v198, v26, v26
    v_add_f32 v195, v195, v27
    v_fmac_f32 v199, v27, v27
    s_add_u32 s75, s75, 128
    s_cmp_eq_u32 s75, 640
    s_cselect_b32 s75, 0, s75
    s_add_u32 s76, s60, s75
    s_add_u32 m0, s61, 57344
    s_add_u32 s62, s76, 0
    buffer_load_dwordx4 v8, s[20:23], s62 offen lds
    v_add_f32 v192, v192, v28
    v_fmac_f32 v196, v28, v28
    v_add_f32 v193, v193, v29
    v_fmac_f32 v197, v29, v29
    v_add_f32 v194, v194, v30
    v_fmac_f32 v198, v30, v30
    v_add_f32 v195, v195, v31
    v_fmac_f32 v199, v31, v31
    v_lshlrev_b32 v16, 16, v160
    v_and_b32 v17, s77, v160
    v_lshlrev_b32 v24, 16, v164
    s_add_u32 m0, s61, 58368
    s_add_u32 s62, s76, 20480
    buffer_load_dwordx4 v7, s[20:23], s62 offen lds
    v_and_b32 v25, s77, v164
    v_lshlrev_b32 v18, 16, v161
    v_and_b32 v19, s77, v161
    v_lshlrev_b32 v26, 16, v165
    v_and_b32 v27, s77, v165
    v_lshlrev_b32 v20, 16, v162
    v_and_b32 v21, s77, v162
    v_lshlrev_b32 v28, 16, v166
    v_and_b32 v29, s77, v166
    v_lshlrev_b32 v22, 16, v163
    v_and_b32 v23, s77, v163
    s_add_u32 m0, s61, 59392
    s_add_u32 s62, s76, 40960
    buffer_load_dwordx4 v6, s[20:23], s62 offen lds
    v_lshlrev_b32 v30, 16, v167
    v_and_b32 v31, s77, v167
    v_add_f32 v192, v192, v16
    v_fmac_f32 v196, v16, v16
    v_add_f32 v193, v193, v17
    v_fmac_f32 v197, v17, v17
    v_add_f32 v194, v194, v18
    v_fmac_f32 v198, v18, v18
    v_add_f32 v195, v195, v19
    v_fmac_f32 v199, v19, v19
    v_add_f32 v192, v192, v20
    s_add_u32 m0, s61, 60416
    s_add_u32 s62, s76, 61440
    buffer_load_dwordx4 v7, s[20:23], s62 offen lds
    v_fmac_f32 v196, v20, v20
    v_add_f32 v193, v193, v21
    v_fmac_f32 v197, v21, v21
    v_add_f32 v194, v194, v22
    v_fmac_f32 v198, v22, v22
    v_add_f32 v195, v195, v23
    v_fmac_f32 v199, v23, v23
    v_add_f32 v192, v192, v24
    v_fmac_f32 v196, v24, v24
    v_add_f32 v193, v193, v25
    v_fmac_f32 v197, v25, v25
    s_add_u32 m0, s61, 61440
    s_add_u32 s62, s76, 81920
    buffer_load_dwordx4 v6, s[20:23], s62 offen lds
    v_add_f32 v194, v194, v26
    v_fmac_f32 v198, v26, v26
    v_add_f32 v195, v195, v27
    v_fmac_f32 v199, v27, v27
    v_add_f32 v192, v192, v28
    v_fmac_f32 v196, v28, v28
    v_add_f32 v193, v193, v29
    v_fmac_f32 v197, v29, v29
    v_add_f32 v194, v194, v30
    v_fmac_f32 v198, v30, v30
    v_add_f32 v195, v195, v31
    s_add_u32 m0, s61, 62464
    s_add_u32 s62, s76, 102400
    buffer_load_dwordx4 v7, s[20:23], s62 offen lds
    v_fmac_f32 v199, v31, v31
    s_waitcnt vmcnt(6)
    buffer_load_dwordx4 v[104:107], v210, s[4:7], s57 offen
    v_lshlrev_b32 v16, 16, v64
    v_and_b32 v17, s77, v64
    v_lshlrev_b32 v24, 16, v68
    v_and_b32 v25, s77, v68
    v_lshlrev_b32 v18, 16, v65
    v_and_b32 v19, s77, v65
    v_lshlrev_b32 v26, 16, v69
    v_and_b32 v27, s77, v69
    v_lshlrev_b32 v20, 16, v66
    v_and_b32 v21, s77, v66
    v_lshlrev_b32 v28, 16, v70
    v_and_b32 v29, s77, v70
    v_lshlrev_b32 v22, 16, v67
    v_and_b32 v23, s77, v67
    v_lshlrev_b32 v30, 16, v71
    buffer_load_dwordx4 v[108:111], v210, s[4:7], s57 offen offset:640
    v_and_b32 v31, s77, v71
    v_add_f32 v192, v192, v16
    v_fmac_f32 v196, v16, v16
    v_add_f32 v193, v193, v17
    v_fmac_f32 v197, v17, v17
    v_add_f32 v194, v194, v18
    v_fmac_f32 v198, v18, v18
    v_add_f32 v195, v195, v19
    v_fmac_f32 v199, v19, v19
    v_add_f32 v192, v192, v20
    v_fmac_f32 v196, v20, v20
    v_add_f32 v193, v193, v21
    v_fmac_f32 v197, v21, v21
    v_add_f32 v194, v194, v22
    v_fmac_f32 v198, v22, v22
    buffer_load_dwordx4 v[112:115], v210, s[4:7], s58 offen
    v_add_f32 v195, v195, v23
    v_fmac_f32 v199, v23, v23
    v_add_f32 v192, v192, v24
    v_fmac_f32 v196, v24, v24
    v_add_f32 v193, v193, v25
    v_fmac_f32 v197, v25, v25
    v_add_f32 v194, v194, v26
    v_fmac_f32 v198, v26, v26
    v_add_f32 v195, v195, v27
    v_fmac_f32 v199, v27, v27
    v_add_f32 v192, v192, v28
    v_fmac_f32 v196, v28, v28
    v_add_f32 v193, v193, v29
    v_fmac_f32 v197, v29, v29
    v_add_f32 v194, v194, v30
    buffer_load_dwordx4 v[116:119], v210, s[4:7], s58 offen offset:640
    v_fmac_f32 v198, v30, v30
    v_add_f32 v195, v195, v31
    v_fmac_f32 v199, v31, v31
    v_sub_f32 v16, v16, v204
    v_sub_f32 v17, v17, v204
    v_sub_f32 v18, v18, v204
    v_sub_f32 v19, v19, v204
    v_sub_f32 v20, v20, v204
    v_sub_f32 v21, v21, v204
    v_sub_f32 v22, v22, v204
    v_sub_f32 v23, v23, v204
    v_fmac_f32 v16, v12, v24
    v_fmac_f32 v17, v12, v25
    v_fmac_f32 v18, v12, v26
    v_fmac_f32 v19, v12, v27
    buffer_load_dwordx4 v[120:123], v210, s[4:7], s59 offen
    v_fmac_f32 v20, v12, v28
    v_fmac_f32 v21, v12, v29
    v_fmac_f32 v22, v12, v30
    v_fmac_f32 v23, v12, v31
    v_cvt_pk_bf16_f32 v64, v16, v17
    v_cvt_pk_bf16_f32 v65, v18, v19
    v_cvt_pk_bf16_f32 v66, v20, v21
    v_cvt_pk_bf16_f32 v67, v22, v23
    ds_write_b128 v213, v[64:67] offset:16384
    v_lshlrev_b32 v16, 16, v72
    v_and_b32 v17, s77, v72
    v_lshlrev_b32 v24, 16, v76
    v_and_b32 v25, s77, v76
    v_lshlrev_b32 v18, 16, v73
    v_and_b32 v19, s77, v73
    buffer_load_dwordx4 v[124:127], v210, s[4:7], s59 offen offset:640
    v_lshlrev_b32 v26, 16, v77
    v_and_b32 v27, s77, v77
    v_lshlrev_b32 v20, 16, v74
    v_and_b32 v21, s77, v74
    v_lshlrev_b32 v28, 16, v78
    v_and_b32 v29, s77, v78
    v_lshlrev_b32 v22, 16, v75
    v_and_b32 v23, s77, v75
    v_lshlrev_b32 v30, 16, v79
    v_and_b32 v31, s77, v79
    v_sub_f32 v16, v16, v205
    v_sub_f32 v17, v17, v205
    v_sub_f32 v18, v18, v205
    v_sub_f32 v19, v19, v205
    v_sub_f32 v20, v20, v205
    s_add_u32 s75, s75, 128
    s_cmp_eq_u32 s75, 640
    s_cselect_b32 s75, 0, s75
    s_add_u32 s76, s60, s75
    s_add_u32 m0, s61, 81920
    s_add_u32 s62, s76, 0
    buffer_load_dwordx4 v8, s[20:23], s62 offen lds
    v_sub_f32 v21, v21, v205
    v_sub_f32 v22, v22, v205
    v_sub_f32 v23, v23, v205
    v_fmac_f32 v16, v12, v24
    v_fmac_f32 v17, v12, v25
    v_fmac_f32 v18, v12, v26
    v_fmac_f32 v19, v12, v27
    v_fmac_f32 v20, v12, v28
    v_fmac_f32 v21, v12, v29
    v_fmac_f32 v22, v12, v30
    v_fmac_f32 v23, v12, v31
    v_cvt_pk_bf16_f32 v72, v16, v17
    v_cvt_pk_bf16_f32 v73, v18, v19
    v_cvt_pk_bf16_f32 v74, v20, v21
    v_cvt_pk_bf16_f32 v75, v22, v23
    s_add_u32 m0, s61, 82944
    s_add_u32 s62, s76, 20480
    buffer_load_dwordx4 v7, s[20:23], s62 offen lds
    ds_write_b128 v214, v[72:75] offset:16384
    v_lshlrev_b32 v16, 16, v80
    v_and_b32 v17, s77, v80
    v_lshlrev_b32 v24, 16, v84
    v_and_b32 v25, s77, v84
    v_lshlrev_b32 v18, 16, v81
    v_and_b32 v19, s77, v81
    v_lshlrev_b32 v26, 16, v85
    v_and_b32 v27, s77, v85
    v_lshlrev_b32 v20, 16, v82
    v_and_b32 v21, s77, v82
    v_lshlrev_b32 v28, 16, v86
    v_and_b32 v29, s77, v86
    v_lshlrev_b32 v22, 16, v83
    v_and_b32 v23, s77, v83
    s_add_u32 m0, s61, 83968
    s_add_u32 s62, s76, 40960
    buffer_load_dwordx4 v6, s[20:23], s62 offen lds
    v_lshlrev_b32 v30, 16, v87
    v_and_b32 v31, s77, v87
    v_sub_f32 v16, v16, v206
    v_sub_f32 v17, v17, v206
    v_sub_f32 v18, v18, v206
    v_sub_f32 v19, v19, v206
    v_sub_f32 v20, v20, v206
    v_sub_f32 v21, v21, v206
    v_sub_f32 v22, v22, v206
    v_sub_f32 v23, v23, v206
    v_fmac_f32 v16, v12, v24
    v_fmac_f32 v17, v12, v25
    v_fmac_f32 v18, v12, v26
    v_fmac_f32 v19, v12, v27
    v_fmac_f32 v20, v12, v28
    s_add_u32 m0, s61, 84992
    s_add_u32 s62, s76, 61440
    buffer_load_dwordx4 v7, s[20:23], s62 offen lds
    v_fmac_f32 v21, v12, v29
    v_fmac_f32 v22, v12, v30
    v_fmac_f32 v23, v12, v31
    v_cvt_pk_bf16_f32 v80, v16, v17
    v_cvt_pk_bf16_f32 v81, v18, v19
    v_cvt_pk_bf16_f32 v82, v20, v21
    v_cvt_pk_bf16_f32 v83, v22, v23
    ds_write_b128 v215, v[80:83] offset:16384
    v_lshlrev_b32 v16, 16, v88
    v_and_b32 v17, s77, v88
    v_lshlrev_b32 v24, 16, v92
    v_and_b32 v25, s77, v92
    v_lshlrev_b32 v18, 16, v89
    v_and_b32 v19, s77, v89
    v_lshlrev_b32 v26, 16, v93
    s_add_u32 m0, s61, 86016
    s_add_u32 s62, s76, 81920
    buffer_load_dwordx4 v6, s[20:23], s62 offen lds
    v_and_b32 v27, s77, v93
    v_lshlrev_b32 v20, 16, v90
    v_and_b32 v21, s77, v90
    v_lshlrev_b32 v28, 16, v94
    v_and_b32 v29, s77, v94
    v_lshlrev_b32 v22, 16, v91
    v_and_b32 v23, s77, v91
    v_lshlrev_b32 v30, 16, v95
    v_and_b32 v31, s77, v95
    v_sub_f32 v16, v16, v207
    v_sub_f32 v17, v17, v207
    v_sub_f32 v18, v18, v207
    v_sub_f32 v19, v19, v207
    v_sub_f32 v20, v20, v207
    v_sub_f32 v21, v21, v207
    s_add_u32 m0, s61, 87040
    s_add_u32 s62, s76, 102400
    buffer_load_dwordx4 v7, s[20:23], s62 offen lds
    v_sub_f32 v22, v22, v207
    v_sub_f32 v23, v23, v207
    v_fmac_f32 v16, v12, v24
    v_fmac_f32 v17, v12, v25
    v_fmac_f32 v18, v12, v26
    v_fmac_f32 v19, v12, v27
    v_fmac_f32 v20, v12, v28
    v_fmac_f32 v21, v12, v29
    v_fmac_f32 v22, v12, v30
    v_fmac_f32 v23, v12, v31
    v_cvt_pk_bf16_f32 v88, v16, v17
    v_cvt_pk_bf16_f32 v89, v18, v19
    v_cvt_pk_bf16_f32 v90, v20, v21
    v_cvt_pk_bf16_f32 v91, v22, v23
    ds_write_b128 v216, v[88:91] offset:16384
    v_add_f32 v192, v192, v193
    v_add_f32 v196, v196, v197
    v_add_f32 v194, v194, v195
    v_add_f32 v198, v198, v199
    v_add_f32 v192, v192, v194
    v_add_f32 v196, v196, v198
    s_nop 0
    v_add_f32 v192, v192, v192 quad_perm:[1,0,3,2] row_mask:0xf bank_mask:0xf
    v_add_f32 v196, v196, v196 quad_perm:[1,0,3,2] row_mask:0xf bank_mask:0xf
    s_nop 0
    v_add_f32 v192, v192, v192 quad_perm:[2,3,0,1] row_mask:0xf bank_mask:0xf
    v_add_f32 v196, v196, v196 quad_perm:[2,3,0,1] row_mask:0xf bank_mask:0xf
    s_nop 0
    v_add_f32 v192, v192, v192 row_half_mirror row_mask:0xf bank_mask:0xf
    v_add_f32 v196, v196, v196 row_half_mirror row_mask:0xf bank_mask:0xf
    v_mul_f32 v200, 0x3acccccd, v192
    v_mul_f32 v201, 0x3acccccd, v196
    v_fma_f32 v201, -v200, v200, v201
    v_max_f32 v201, 0, v201
    v_add_f32 v201, 0x3727c5ac, v201
    v_mov_b32 v202, s12
    v_mov_b32 v203, s13
    s_mov_b32 exec_lo, 0x01010101
    s_mov_b32 exec_hi, 0x01010101
    buffer_store_dwordx4 v[200:203], v4, s[8:11], s64 offen sc1
    s_mov_b64 exec, -1
    s_waitcnt vmcnt(13) lgkmcnt(0)
    s_barrier
    s_waitcnt vmcnt(7)
    buffer_load_dwordx4 v[136:139], v211, s[4:7], s57 offen
    v_lshlrev_b32 v16, 16, v96
    v_and_b32 v17, s77, v96
    v_lshlrev_b32 v24, 16, v100
    v_and_b32 v25, s77, v100
    v_lshlrev_b32 v18, 16, v97
    v_and_b32 v19, s77, v97
    v_lshlrev_b32 v26, 16, v101
    v_and_b32 v27, s77, v101
    v_lshlrev_b32 v20, 16, v98
    v_and_b32 v21, s77, v98
    v_lshlrev_b32 v28, 16, v102
    v_and_b32 v29, s77, v102
    v_lshlrev_b32 v22, 16, v99
    buffer_load_dwordx4 v[140:143], v211, s[4:7], s57 offen offset:640
    v_and_b32 v23, s77, v99
    v_lshlrev_b32 v30, 16, v103
    v_and_b32 v31, s77, v103
    v_sub_f32 v16, v16, v204
    v_sub_f32 v17, v17, v204
    v_sub_f32 v18, v18, v204
    v_sub_f32 v19, v19, v204
    v_sub_f32 v20, v20, v204
    v_sub_f32 v21, v21, v204
    v_sub_f32 v22, v22, v204
    v_sub_f32 v23, v23, v204
    v_fmac_f32 v16, v12, v24
    v_fmac_f32 v17, v12, v25
    buffer_load_dwordx4 v[144:147], v211, s[4:7], s58 offen
    v_fmac_f32 v18, v12, v26
    v_fmac_f32 v19, v12, v27
    v_fmac_f32 v20, v12, v28
    v_fmac_f32 v21, v12, v29
    v_fmac_f32 v22, v12, v30
    v_fmac_f32 v23, v12, v31
    v_cvt_pk_bf16_f32 v96, v16, v17
    v_cvt_pk_bf16_f32 v97, v18, v19
    v_cvt_pk_bf16_f32 v98, v20, v21
    v_cvt_pk_bf16_f32 v99, v22, v23
    ds_write_b128 v213, v[96:99] offset:0
    v_lshlrev_b32 v16, 16, v104
    v_and_b32 v17, s77, v104
    buffer_load_dwordx4 v[148:151], v211, s[4:7], s58 offen offset:640
    v_lshlrev_b32 v24, 16, v108
    v_and_b32 v25, s77, v108
    v_lshlrev_b32 v18, 16, v105
    v_and_b32 v19, s77, v105
    v_lshlrev_b32 v26, 16, v109
    v_and_b32 v27, s77, v109
    v_lshlrev_b32 v20, 16, v106
    v_and_b32 v21, s77, v106
    v_lshlrev_b32 v28, 16, v110
    v_and_b32 v29, s77, v110
    v_lshlrev_b32 v22, 16, v107
    v_and_b32 v23, s77, v107
    v_lshlrev_b32 v30, 16, v111
    buffer_load_dwordx4 v[152:155], v211, s[4:7], s59 offen
    v_and_b32 v31, s77, v111
    v_sub_f32 v16, v16, v205
    v_sub_f32 v17, v17, v205
    v_sub_f32 v18, v18, v205
    v_sub_f32 v19, v19, v205
    v_sub_f32 v20, v20, v205
    v_sub_f32 v21, v21, v205
    v_sub_f32 v22, v22, v205
    v_sub_f32 v23, v23, v205
    v_fmac_f32 v16, v12, v24
    v_fmac_f32 v17, v12, v25
    v_fmac_f32 v18, v12, v26
    v_fmac_f32 v19, v12, v27
    buffer_load_dwordx4 v[156:159], v211, s[4:7], s59 offen offset:640
    v_fmac_f32 v20, v12, v28
    v_fmac_f32 v21, v12, v29
    v_fmac_f32 v22, v12, v30
    v_fmac_f32 v23, v12, v31
    v_cvt_pk_bf16_f32 v104, v16, v17
    v_cvt_pk_bf16_f32 v105, v18, v19
    v_cvt_pk_bf16_f32 v106, v20, v21
    v_cvt_pk_bf16_f32 v107, v22, v23
    ds_write_b128 v214, v[104:107] offset:0
    v_lshlrev_b32 v16, 16, v112
    v_and_b32 v17, s77, v112
    v_lshlrev_b32 v24, 16, v116
    v_and_b32 v25, s77, v116
    s_add_u32 s75, s75, 128
    s_cmp_eq_u32 s75, 640
    s_cselect_b32 s75, 0, s75
    s_add_u32 s76, s60, s75
    s_add_u32 m0, s61, 106496
    s_add_u32 s62, s76, 0
    buffer_load_dwordx4 v8, s[20:23], s62 offen lds
    v_lshlrev_b32 v18, 16, v113
    v_and_b32 v19, s77, v113
    v_lshlrev_b32 v26, 16, v117
    v_and_b32 v27, s77, v117
    v_lshlrev_b32 v20, 16, v114
    v_and_b32 v21, s77, v114
    v_lshlrev_b32 v28, 16, v118
    v_and_b32 v29, s77, v118
    v_lshlrev_b32 v22, 16, v115
    v_and_b32 v23, s77, v115
    v_lshlrev_b32 v30, 16, v119
    v_and_b32 v31, s77, v119
    v_sub_f32 v16, v16, v206
    s_add_u32 m0, s61, 107520
    s_add_u32 s62, s76, 20480
    buffer_load_dwordx4 v7, s[20:23], s62 offen lds
    v_sub_f32 v17, v17, v206
    v_sub_f32 v18, v18, v206
    v_sub_f32 v19, v19, v206
    v_sub_f32 v20, v20, v206
    v_sub_f32 v21, v21, v206
    v_sub_f32 v22, v22, v206
    v_sub_f32 v23, v23, v206
    v_fmac_f32 v16, v12, v24
    v_fmac_f32 v17, v12, v25
    v_fmac_f32 v18, v12, v26
    v_fmac_f32 v19, v12, v27
    v_fmac_f32 v20, v12, v28
    v_fmac_f32 v21, v12, v29
    s_add_u32 m0, s61, 108544
    s_add_u32 s62, s76, 40960
    buffer_load_dwordx4 v6, s[20:23], s62 offen lds
    v_fmac_f32 v22, v12, v30
    v_fmac_f32 v23, v12, v31
    v_cvt_pk_bf16_f32 v112, v16, v17
    v_cvt_pk_bf16_f32 v113, v18, v19
    v_cvt_pk_bf16_f32 v114, v20, v21
    v_cvt_pk_bf16_f32 v115, v22, v23
    ds_write_b128 v215, v[112:115] offset:0
    v_lshlrev_b32 v16, 16, v120
    v_and_b32 v17, s77, v120
    v_lshlrev_b32 v24, 16, v124
    v_and_b32 v25, s77, v124
    v_lshlrev_b32 v18, 16, v121
    v_and_b32 v19, s77, v121
    s_add_u32 m0, s61, 109568
    s_add_u32 s62, s76, 61440
    buffer_load_dwordx4 v7, s[20:23], s62 offen lds
    v_lshlrev_b32 v26, 16, v125
    v_and_b32 v27, s77, v125
    v_lshlrev_b32 v20, 16, v122
    v_and_b32 v21, s77, v122
    v_lshlrev_b32 v28, 16, v126
    v_and_b32 v29, s77, v126
    v_lshlrev_b32 v22, 16, v123
    v_and_b32 v23, s77, v123
    v_lshlrev_b32 v30, 16, v127
    v_and_b32 v31, s77, v127
    v_sub_f32 v16, v16, v207
    v_sub_f32 v17, v17, v207
    v_sub_f32 v18, v18, v207
    s_add_u32 m0, s61, 110592
    s_add_u32 s62, s76, 81920
    buffer_load_dwordx4 v6, s[20:23], s62 offen lds
    v_sub_f32 v19, v19, v207
    v_sub_f32 v20, v20, v207
    v_sub_f32 v21, v21, v207
    v_sub_f32 v22, v22, v207
    v_sub_f32 v23, v23, v207
    v_fmac_f32 v16, v12, v24
    v_fmac_f32 v17, v12, v25
    v_fmac_f32 v18, v12, v26
    v_fmac_f32 v19, v12, v27
    v_fmac_f32 v20, v12, v28
    v_fmac_f32 v21, v12, v29
    v_fmac_f32 v22, v12, v30
    v_fmac_f32 v23, v12, v31
    s_add_u32 m0, s61, 111616
    s_add_u32 s62, s76, 102400
    buffer_load_dwordx4 v7, s[20:23], s62 offen lds
    v_cvt_pk_bf16_f32 v120, v16, v17
    v_cvt_pk_bf16_f32 v121, v18, v19
    v_cvt_pk_bf16_f32 v122, v20, v21
    v_cvt_pk_bf16_f32 v123, v22, v23
    ds_write_b128 v216, v[120:123] offset:0
    s_waitcnt vmcnt(13) lgkmcnt(0)
    s_barrier
    s_waitcnt vmcnt(6)
    s_add_u32 s75, s75, 128
    s_cmp_eq_u32 s75, 640
    s_cselect_b32 s75, 0, s75
    s_add_u32 s76, s60, s75
    s_add_u32 m0, s61, 131072
    s_add_u32 s62, s76, 0
    buffer_load_dwordx4 v8, s[20:23], s62 offen lds
    v_lshlrev_b32 v16, 16, v128
    v_and_b32 v17, s77, v128
    v_lshlrev_b32 v24, 16, v132
    v_and_b32 v25, s77, v132
    v_lshlrev_b32 v18, 16, v129
    v_and_b32 v19, s77, v129
    v_lshlrev_b32 v26, 16, v133
    v_and_b32 v27, s77, v133
    v_lshlrev_b32 v20, 16, v130
    v_and_b32 v21, s77, v130
    v_lshlrev_b32 v28, 16, v134
    v_and_b32 v29, s77, v134
    v_lshlrev_b32 v22, 16, v131
    s_add_u32 m0, s61, 132096
    s_add_u32 s62, s76, 20480
    buffer_load_dwordx4 v7, s[20:23], s62 offen lds
    v_and_b32 v23, s77, v131
    v_lshlrev_b32 v30, 16, v135
    v_and_b32 v31, s77, v135
    v_sub_f32 v16, v16, v204
    v_sub_f32 v17, v17, v204
    v_sub_f32 v18, v18, v204
    v_sub_f32 v19, v19, v204
    v_sub_f32 v20, v20, v204
    v_sub_f32 v21, v21, v204
    v_sub_f32 v22, v22, v204
    v_sub_f32 v23, v23, v204
    v_fmac_f32 v16, v12, v24
    v_fmac_f32 v17, v12, v25
    s_add_u32 m0, s61, 133120
    s_add_u32 s62, s76, 40960
    buffer_load_dwordx4 v6, s[20:23], s62 offen lds
    v_fmac_f32 v18, v12, v26
    v_fmac_f32 v19, v12, v27
    v_fmac_f32 v20, v12, v28
    v_fmac_f32 v21, v12, v29
    v_fmac_f32 v22, v12, v30
    v_fmac_f32 v23, v12, v31
    v_cvt_pk_bf16_f32 v128, v16, v17
    v_cvt_pk_bf16_f32 v129, v18, v19
    v_cvt_pk_bf16_f32 v130, v20, v21
    v_cvt_pk_bf16_f32 v131, v22, v23
    ds_write_b128 v213, v[128:131] offset:16384
    v_lshlrev_b32 v16, 16, v136
    v_and_b32 v17, s77, v136
    s_add_u32 m0, s61, 134144
    s_add_u32 s62, s76, 61440
    buffer_load_dwordx4 v7, s[20:23], s62 offen lds
    v_lshlrev_b32 v24, 16, v140
    v_and_b32 v25, s77, v140
    v_lshlrev_b32 v18, 16, v137
    v_and_b32 v19, s77, v137
    v_lshlrev_b32 v26, 16, v141
    v_and_b32 v27, s77, v141
    v_lshlrev_b32 v20, 16, v138
    v_and_b32 v21, s77, v138
    v_lshlrev_b32 v28, 16, v142
    v_and_b32 v29, s77, v142
    v_lshlrev_b32 v22, 16, v139
    v_and_b32 v23, s77, v139
    v_lshlrev_b32 v30, 16, v143
    s_add_u32 m0, s61, 135168
    s_add_u32 s62, s76, 81920
    buffer_load_dwordx4 v6, s[20:23], s62 offen lds
    v_and_b32 v31, s77, v143
    v_sub_f32 v16, v16, v205
    v_sub_f32 v17, v17, v205
    v_sub_f32 v18, v18, v205
    v_sub_f32 v19, v19, v205
    v_sub_f32 v20, v20, v205
    v_sub_f32 v21, v21, v205
    v_sub_f32 v22, v22, v205
    v_sub_f32 v23, v23, v205
    v_fmac_f32 v16, v12, v24
    v_fmac_f32 v17, v12, v25
    v_fmac_f32 v18, v12, v26
    v_fmac_f32 v19, v12, v27
    s_add_u32 m0, s61, 136192
    s_add_u32 s62, s76, 102400
    buffer_load_dwordx4 v7, s[20:23], s62 offen lds
    v_fmac_f32 v20, v12, v28
    v_fmac_f32 v21, v12, v29
    v_fmac_f32 v22, v12, v30
    v_fmac_f32 v23, v12, v31
    v_cvt_pk_bf16_f32 v136, v16, v17
    v_cvt_pk_bf16_f32 v137, v18, v19
    v_cvt_pk_bf16_f32 v138, v20, v21
    v_cvt_pk_bf16_f32 v139, v22, v23
    ds_write_b128 v214, v[136:139] offset:16384
    v_lshlrev_b32 v16, 16, v144
    v_and_b32 v17, s77, v144
    v_lshlrev_b32 v24, 16, v148
    v_and_b32 v25, s77, v148
    buffer_load_dwordx4 v[168:171], v212, s[4:7], s57 offen
    v_lshlrev_b32 v18, 16, v145
    v_and_b32 v19, s77, v145
    v_lshlrev_b32 v26, 16, v149
    v_and_b32 v27, s77, v149
    v_lshlrev_b32 v20, 16, v146
    v_and_b32 v21, s77, v146
    v_lshlrev_b32 v28, 16, v150
    v_and_b32 v29, s77, v150
    v_lshlrev_b32 v22, 16, v147
    v_and_b32 v23, s77, v147
    v_lshlrev_b32 v30, 16, v151
    v_and_b32 v31, s77, v151
    v_sub_f32 v16, v16, v206
    buffer_load_dwordx4 v[172:175], v212, s[4:7], s57 offen offset:640
    v_sub_f32 v17, v17, v206
    v_sub_f32 v18, v18, v206
    v_sub_f32 v19, v19, v206
    v_sub_f32 v20, v20, v206
    v_sub_f32 v21, v21, v206
    v_sub_f32 v22, v22, v206
    v_sub_f32 v23, v23, v206
    v_fmac_f32 v16, v12, v24
    v_fmac_f32 v17, v12, v25
    v_fmac_f32 v18, v12, v26
    v_fmac_f32 v19, v12, v27
    v_fmac_f32 v20, v12, v28
    v_fmac_f32 v21, v12, v29
    buffer_load_dwordx4 v[176:179], v212, s[4:7], s58 offen
    v_fmac_f32 v22, v12, v30
    v_fmac_f32 v23, v12, v31
    v_cvt_pk_bf16_f32 v144, v16, v17
    v_cvt_pk_bf16_f32 v145, v18, v19
    v_cvt_pk_bf16_f32 v146, v20, v21
    v_cvt_pk_bf16_f32 v147, v22, v23
    ds_write_b128 v215, v[144:147] offset:16384
    v_lshlrev_b32 v16, 16, v152
    v_and_b32 v17, s77, v152
    v_lshlrev_b32 v24, 16, v156
    v_and_b32 v25, s77, v156
    v_lshlrev_b32 v18, 16, v153
    v_and_b32 v19, s77, v153
    buffer_load_dwordx4 v[180:183], v212, s[4:7], s58 offen offset:640
    v_lshlrev_b32 v26, 16, v157
    v_and_b32 v27, s77, v157
    v_lshlrev_b32 v20, 16, v154
    v_and_b32 v21, s77, v154
    v_lshlrev_b32 v28, 16, v158
    v_and_b32 v29, s77, v158
    v_lshlrev_b32 v22, 16, v155
    v_and_b32 v23, s77, v155
    v_lshlrev_b32 v30, 16, v159
    v_and_b32 v31, s77, v159
    v_sub_f32 v16, v16, v207
    v_sub_f32 v17, v17, v207
    v_sub_f32 v18, v18, v207
    buffer_load_dwordx4 v[184:187], v212, s[4:7], s59 offen
    v_sub_f32 v19, v19, v207
    v_sub_f32 v20, v20, v207
    v_sub_f32 v21, v21, v207
    v_sub_f32 v22, v22, v207
    v_sub_f32 v23, v23, v207
    v_fmac_f32 v16, v12, v24
    v_fmac_f32 v17, v12, v25
    v_fmac_f32 v18, v12, v26
    v_fmac_f32 v19, v12, v27
    v_fmac_f32 v20, v12, v28
    v_fmac_f32 v21, v12, v29
    v_fmac_f32 v22, v12, v30
    v_fmac_f32 v23, v12, v31
    buffer_load_dwordx4 v[188:191], v212, s[4:7], s59 offen offset:640
    v_cvt_pk_bf16_f32 v152, v16, v17
    v_cvt_pk_bf16_f32 v153, v18, v19
    v_cvt_pk_bf16_f32 v154, v20, v21
    v_cvt_pk_bf16_f32 v155, v22, v23
    ds_write_b128 v216, v[152:155] offset:16384
    s_waitcnt vmcnt(12) lgkmcnt(0)
    s_barrier
    buffer_load_dwordx4 v[192:195], v10, s[8:11], s65 offen sc1
    s_waitcnt vmcnt(1)
    v_lshlrev_b32 v11, 7, v0
    v_add_u32 v11, 0x8000, v11
    v_add_u32 v13, 8192, v11
    v_add_u32 v14, 16384, v11
    s_cmp_eq_u32 s48, 1
    s_cbranch_scc0 L_dl_np
    buffer_load_dwordx2 v[196:197], v11, s[8:11], 0 offen sc1
    buffer_load_dwordx2 v[198:199], v13, s[8:11], 0 offen sc1
    buffer_load_dwordx2 v[200:201], v14, s[8:11], 0 offen sc1
L_dl_np:
    v_lshlrev_b32 v16, 16, v160
    v_and_b32 v17, s77, v160
    v_lshlrev_b32 v24, 16, v164
    v_and_b32 v25, s77, v164
    v_lshlrev_b32 v18, 16, v161
    v_and_b32 v19, s77, v161
    v_lshlrev_b32 v26, 16, v165
    v_and_b32 v27, s77, v165
    v_lshlrev_b32 v20, 16, v162
    v_and_b32 v21, s77, v162
    v_lshlrev_b32 v28, 16, v166
    v_and_b32 v29, s77, v166
    v_lshlrev_b32 v22, 16, v163
    v_and_b32 v23, s77, v163
    v_lshlrev_b32 v30, 16, v167
    v_and_b32 v31, s77, v167
    v_sub_f32 v16, v16, v204
    v_sub_f32 v17, v17, v204
    v_sub_f32 v18, v18, v204
    v_sub_f32 v19, v19, v204
    v_sub_f32 v20, v20, v204
    v_sub_f32 v21, v21, v204
    v_sub_f32 v22, v22, v204
    v_sub_f32 v23, v23, v204
    v_fmac_f32 v16, v12, v24
    v_fmac_f32 v17, v12, v25
    v_fmac_f32 v18, v12, v26
    v_fmac_f32 v19, v12, v27
    v_fmac_f32 v20, v12, v28
    v_fmac_f32 v21, v12, v29
    v_fmac_f32 v22, v12, v30
    v_fmac_f32 v23, v12, v31
    v_cvt_pk_bf16_f32 v160, v16, v17
    v_cvt_pk_bf16_f32 v161, v18, v19
    v_cvt_pk_bf16_f32 v162, v20, v21
    v_cvt_pk_bf16_f32 v163, v22, v23
    ds_write_b128 v213, v[160:163] offset:0
    v_lshlrev_b32 v16, 16, v168
    v_and_b32 v17, s77, v168
    v_lshlrev_b32 v24, 16, v172
    v_and_b32 v25, s77, v172
    v_lshlrev_b32 v18, 16, v169
    v_and_b32 v19, s77, v169
    v_lshlrev_b32 v26, 16, v173
    v_and_b32 v27, s77, v173
    v_lshlrev_b32 v20, 16, v170
    v_and_b32 v21, s77, v170
    v_lshlrev_b32 v28, 16, v174
    v_and_b32 v29, s77, v174
    v_lshlrev_b32 v22, 16, v171
    v_and_b32 v23, s77, v171
    v_lshlrev_b32 v30, 16, v175
    v_and_b32 v31, s77, v175
    v_sub_f32 v16, v16, v205
    v_sub_f32 v17, v17, v205
    v_sub_f32 v18, v18, v205
    v_sub_f32 v19, v19, v205
    v_sub_f32 v20, v20, v205
    v_sub_f32 v21, v21, v205
    v_sub_f32 v22, v22, v205
    v_sub_f32 v23, v23, v205
    v_fmac_f32 v16, v12, v24
    v_fmac_f32 v17, v12, v25
    v_fmac_f32 v18, v12, v26
    v_fmac_f32 v19, v12, v27
    v_fmac_f32 v20, v12, v28
    v_fmac_f32 v21, v12, v29
    v_fmac_f32 v22, v12, v30
    v_fmac_f32 v23, v12, v31
    v_cvt_pk_bf16_f32 v168, v16, v17
    v_cvt_pk_bf16_f32 v169, v18, v19
    v_cvt_pk_bf16_f32 v170, v20, v21
    v_cvt_pk_bf16_f32 v171, v22, v23
    ds_write_b128 v214, v[168:171] offset:0
    v_lshlrev_b32 v16, 16, v176
    v_and_b32 v17, s77, v176
    v_lshlrev_b32 v24, 16, v180
    v_and_b32 v25, s77, v180
    v_lshlrev_b32 v18, 16, v177
    v_and_b32 v19, s77, v177
    v_lshlrev_b32 v26, 16, v181
    v_and_b32 v27, s77, v181
    v_lshlrev_b32 v20, 16, v178
    v_and_b32 v21, s77, v178
    v_lshlrev_b32 v28, 16, v182
    v_and_b32 v29, s77, v182
    v_lshlrev_b32 v22, 16, v179
    v_and_b32 v23, s77, v179
    v_lshlrev_b32 v30, 16, v183
    v_and_b32 v31, s77, v183
    v_sub_f32 v16, v16, v206
    v_sub_f32 v17, v17, v206
    v_sub_f32 v18, v18, v206
    v_sub_f32 v19, v19, v206
    v_sub_f32 v20, v20, v206
    v_sub_f32 v21, v21, v206
    v_sub_f32 v22, v22, v206
    v_sub_f32 v23, v23, v206
    v_fmac_f32 v16, v12, v24
    v_fmac_f32 v17, v12, v25
    v_fmac_f32 v18, v12, v26
    v_fmac_f32 v19, v12, v27
    v_fmac_f32 v20, v12, v28
    v_fmac_f32 v21, v12, v29
    v_fmac_f32 v22, v12, v30
    v_fmac_f32 v23, v12, v31
    v_cvt_pk_bf16_f32 v176, v16, v17
    v_cvt_pk_bf16_f32 v177, v18, v19
    v_cvt_pk_bf16_f32 v178, v20, v21
    v_cvt_pk_bf16_f32 v179, v22, v23
    ds_write_b128 v215, v[176:179] offset:0
    v_lshlrev_b32 v16, 16, v184
    v_and_b32 v17, s77, v184
    v_lshlrev_b32 v24, 16, v188
    v_and_b32 v25, s77, v188
    v_lshlrev_b32 v18, 16, v185
    v_and_b32 v19, s77, v185
    v_lshlrev_b32 v26, 16, v189
    v_and_b32 v27, s77, v189
    v_lshlrev_b32 v20, 16, v186
    v_and_b32 v21, s77, v186
    v_lshlrev_b32 v28, 16, v190
    v_and_b32 v29, s77, v190
    v_lshlrev_b32 v22, 16, v187
    v_and_b32 v23, s77, v187
    v_lshlrev_b32 v30, 16, v191
    v_and_b32 v31, s77, v191
    v_sub_f32 v16, v16, v207
    v_sub_f32 v17, v17, v207
    v_sub_f32 v18, v18, v207
    v_sub_f32 v19, v19, v207
    v_sub_f32 v20, v20, v207
    v_sub_f32 v21, v21, v207
    v_sub_f32 v22, v22, v207
    v_sub_f32 v23, v23, v207
    v_fmac_f32 v16, v12, v24
    v_fmac_f32 v17, v12, v25
    v_fmac_f32 v18, v12, v26
    v_fmac_f32 v19, v12, v27
    v_fmac_f32 v20, v12, v28
    v_fmac_f32 v21, v12, v29
    v_fmac_f32 v22, v12, v30
    v_fmac_f32 v23, v12, v31
    v_cvt_pk_bf16_f32 v184, v16, v17
    v_cvt_pk_bf16_f32 v185, v18, v19
    v_cvt_pk_bf16_f32 v186, v20, v21
    v_cvt_pk_bf16_f32 v187, v22, v23
    ds_write_b128 v216, v[184:187] offset:0
    s_waitcnt lgkmcnt(0)
    s_barrier
    s_waitcnt vmcnt(0)
    s_cmp_eq_u32 s48, 1
    s_cbranch_scc0 L_dl_nq
    s_mov_b32 s53, 0
    s_branch L_dl_sp_c
L_dl_sp:
    buffer_load_dwordx2 v[196:197], v11, s[8:11], 0 offen sc1
    buffer_load_dwordx2 v[198:199], v13, s[8:11], 0 offen sc1
    buffer_load_dwordx2 v[200:201], v14, s[8:11], 0 offen sc1
    s_add_u32 s53, s53, 1
    s_cmp_gt_u32 s53, 0x100000
    s_cbranch_scc1 L_dl_sp_x
    s_waitcnt vmcnt(0)
L_dl_sp_c:
    v_cmp_ne_u64 vcc, s[12:13], v[196:197]
    v_cmp_ne_u64 s[68:69], s[12:13], v[198:199]
    s_nop 0
    s_or_b64 vcc, vcc, s[68:69]
    v_cmp_ne_u64 s[68:69], s[12:13], v[200:201]
    s_nop 0
    s_or_b64 vcc, vcc, s[68:69]
    s_cbranch_vccz L_dl_sp_x
    s_sleep 8
    s_branch L_dl_sp
L_dl_sp_x:
L_dl_nq:
    s_mov_b32 s53, 0
L_dl_rs:
    v_cmp_ne_u64 vcc, s[12:13], v[194:195]
    s_cbranch_vccz L_dl_rx
    s_add_u32 s53, s53, 1
    s_cmp_gt_u32 s53, 0x100000
    s_cbranch_scc1 L_dl_rx
    s_sleep 2
    buffer_load_dwordx4 v[192:195], v10, s[8:11], s65 offen sc1
    s_waitcnt vmcnt(0)
    s_branch L_dl_rs
L_dl_rx:
    v_rsq_f32 v192, v193
    s_nop 0
    ds_write_b32 v3, v192
    s_lshl_b32 s58, s48, 3
    v_lshrrev_b32 v7, 5, v0
    v_add_u32 v7, s58, v7
    v_and_b32 v6, 31, v0
    v_lshlrev_b32 v6, 4, v6
    v_mul_u32_u24 v5, 1552, v7
    v_add_u32 v5, v5, v6
    v_mul_u32_u24 v8, 2560, v7
    v_add_u32 v8, v8, v6
    s_lshr_b32 s59, s15, 1
    s_mul_i32 s57, s59, 81920
    s_lshl_b32 s59, s14, 10
    s_add_u32 s57, s57, s59
    s_add_u32 s60, s57, 0x300000
    s_add_u32 s61, s57, 0x301400
    s_add_u32 s62, s57, 0x302800
    s_add_u32 s63, s57, 0x303c00
    s_lshl_b32 s59, s15, 3
    s_add_u32 s58, s59, 0x80000
    v_lshl_add_u32 v6, v0, 9, s58
    v_cmp_gt_u32 vcc, 32, v0
    v_mov_b32 v7, 0x7ffffff0
    s_add_u32 s59, s59, 0x8000
    v_cndmask_b32 v6, v7, v6, vcc
    v_mov_b32 v7, s59
    s_mov_b32 s76, 0
    s_mul_i32 s77, s52, 245760
    s_mul_i32 s53, s76, 5120
    s_add_u32 s77, s77, s53
    s_add_u32 s77, s77, 0x100000
    s_sub_u32 s75, s77, 122880
    s_sub_u32 s76, 24, s76
    s_lshr_b32 s53, s48, 1
    s_mul_i32 s72, s53, 122880
    s_and_b32 s53, s48, 1
    s_sub_i32 s71, s76, s53
    s_mul_i32 s53, s53, 5120
    s_add_u32 s72, s72, s53
    s_add_u32 s73, s72, s75
    s_add_u32 s72, s72, s77
    v_lshlrev_b32 v2, 4, v0
    s_waitcnt lgkmcnt(0)
    s_barrier
    s_cmp_le_i32 s71, 14
    s_cselect_b32 s74, s73, s72
    s_add_u32 s74, s74, 71680
    s_add_u32 s78, s74, 4096
    buffer_load_dwordx4 v[128:131], v2, s[8:11], s74 offen offset:0 sc1
    buffer_load_dwordx4 v[132:135], v2, s[8:11], s74 offen offset:1024 sc1
    buffer_load_dwordx4 v[136:139], v2, s[8:11], s74 offen offset:2048 sc1
    buffer_load_dwordx4 v[140:143], v2, s[8:11], s74 offen offset:3072 sc1
    buffer_load_dwordx4 v[144:147], v2, s[8:11], s78 offen offset:0 sc1
    s_cmp_le_i32 s71, 16
    s_cselect_b32 s74, s73, s72
    s_add_u32 s74, s74, 81920
    s_add_u32 s78, s74, 4096
    buffer_load_dwordx4 v[148:151], v2, s[8:11], s74 offen offset:0 sc1
    buffer_load_dwordx4 v[152:155], v2, s[8:11], s74 offen offset:1024 sc1
    buffer_load_dwordx4 v[156:159], v2, s[8:11], s74 offen offset:2048 sc1
    buffer_load_dwordx4 v[160:163], v2, s[8:11], s74 offen offset:3072 sc1
    buffer_load_dwordx4 v[164:167], v2, s[8:11], s78 offen offset:0 sc1
    s_barrier
    s_cmp_eq_u32 s14, 0
    s_cbranch_scc0 L_dl_sk
    ds_read_b128 v[16:19], v5 offset:0
    ds_read_b128 v[20:23], v5 offset:3104
    ds_read_b128 v[24:27], v5 offset:6208
    ds_read_b128 v[28:31], v5 offset:9312
    s_waitcnt lgkmcnt(3)
    buffer_store_dwordx4 v[16:19], v8, s[8:11], s60 offen offset:0 sc1
    s_waitcnt lgkmcnt(2)
    buffer_store_dwordx4 v[20:23], v8, s[8:11], s61 offen offset:0 sc1
    s_waitcnt lgkmcnt(1)
    buffer_store_dwordx4 v[24:27], v8, s[8:11], s62 offen offset:0 sc1
    s_waitcnt lgkmcnt(0)
    buffer_store_dwordx4 v[28:31], v8, s[8:11], s63 offen offset:0 sc1
L_dl_sk:
    s_barrier
    ds_read_b128 v[32:35], v5 offset:512
    ds_read_b128 v[36:39], v5 offset:3616
    ds_read_b128 v[40:43], v5 offset:6720
    ds_read_b128 v[44:47], v5 offset:9824
    s_waitcnt lgkmcnt(3)
    buffer_store_dwordx4 v[32:35], v8, s[8:11], s60 offen offset:512 sc1
    s_waitcnt lgkmcnt(2)
    buffer_store_dwordx4 v[36:39], v8, s[8:11], s61 offen offset:512 sc1
    s_waitcnt lgkmcnt(1)
    buffer_store_dwordx4 v[40:43], v8, s[8:11], s62 offen offset:512 sc1
    s_waitcnt lgkmcnt(0)
    buffer_store_dwordx4 v[44:47], v8, s[8:11], s63 offen offset:512 sc1
    s_barrier
    ds_read_b128 v[48:51], v5 offset:1024
    ds_read_b128 v[52:55], v5 offset:4128
    ds_read_b128 v[56:59], v5 offset:7232
    ds_read_b128 v[60:63], v5 offset:10336
    s_waitcnt lgkmcnt(3)
    buffer_store_dwordx4 v[48:51], v8, s[8:11], s60 offen offset:1024 sc1
    s_waitcnt lgkmcnt(2)
    buffer_store_dwordx4 v[52:55], v8, s[8:11], s61 offen offset:1024 sc1
    s_waitcnt lgkmcnt(1)
    buffer_store_dwordx4 v[56:59], v8, s[8:11], s62 offen offset:1024 sc1
    s_waitcnt lgkmcnt(0)
    buffer_store_dwordx4 v[60:63], v8, s[8:11], s63 offen offset:1024 sc1
    s_waitcnt vmcnt(0)
    s_setprio 0
    s_barrier
    s_cmp_eq_u32 s48, 0
    s_cbranch_scc0 L_dl_nf2
    v_mov_b32 v12, s12
    v_mov_b32 v13, s13
    s_mov_b64 exec, -1
    buffer_store_dwordx2 v[12:13], v6, s[8:11], 0 offen sc1
    s_mov_b64 exec, -1
L_dl_nf2:
    s_add_u32 s64, s48, 0
    s_cmp_lt_u32 s64, 10
    s_cbranch_scc0 L_ds_l0
    s_cmp_ge_u32 s64, 14
    s_cselect_b32 s65, 51200, 0
    s_cselect_b32 s66, 14, 0
    s_sub_u32 s66, s64, s66
    s_mul_i32 s64, s64, 5120
    s_add_u32 s65, s65, s64
    s_cmp_le_u32 s76, s66
    s_cselect_b32 s66, s75, s77
    s_add_u32 s65, s65, s66
    s_add_u32 m0, s64, 0
    s_add_u32 s78, s65, 0
    buffer_load_dwordx4 v2, s[8:11], s78 offen offset:0 sc1 lds
    buffer_load_dwordx4 v2, s[8:11], s78 offen offset:1024 sc1 lds
    buffer_load_dwordx4 v2, s[8:11], s78 offen offset:2048 sc1 lds
    buffer_load_dwordx4 v2, s[8:11], s78 offen offset:3072 sc1 lds
    s_add_u32 m0, s64, 4096
    s_add_u32 s78, s65, 4096
    buffer_load_dwordx4 v2, s[8:11], s78 offen offset:0 sc1 lds
L_ds_l0:
    s_add_u32 s64, s48, 4
    s_cmp_lt_u32 s64, 10
    s_cbranch_scc0 L_ds_l1
    s_cmp_ge_u32 s64, 14
    s_cselect_b32 s65, 51200, 0
    s_cselect_b32 s66, 14, 0
    s_sub_u32 s66, s64, s66
    s_mul_i32 s64, s64, 5120
    s_add_u32 s65, s65, s64
    s_cmp_le_u32 s76, s66
    s_cselect_b32 s66, s75, s77
    s_add_u32 s65, s65, s66
    s_add_u32 m0, s64, 0
    s_add_u32 s78, s65, 0
    buffer_load_dwordx4 v2, s[8:11], s78 offen offset:0 sc1 lds
    buffer_load_dwordx4 v2, s[8:11], s78 offen offset:1024 sc1 lds
    buffer_load_dwordx4 v2, s[8:11], s78 offen offset:2048 sc1 lds
    buffer_load_dwordx4 v2, s[8:11], s78 offen offset:3072 sc1 lds
    s_add_u32 m0, s64, 4096
    s_add_u32 s78, s65, 4096
    buffer_load_dwordx4 v2, s[8:11], s78 offen offset:0 sc1 lds
L_ds_l1:
    s_add_u32 s64, s48, 8
    s_cmp_lt_u32 s64, 10
    s_cbranch_scc0 L_ds_l2
    s_cmp_ge_u32 s64, 14
    s_cselect_b32 s65, 51200, 0
    s_cselect_b32 s66, 14, 0
    s_sub_u32 s66, s64, s66
    s_mul_i32 s64, s64, 5120
    s_add_u32 s65, s65, s64
    s_cmp_le_u32 s76, s66
    s_cselect_b32 s66, s75, s77
    s_add_u32 s65, s65, s66
    s_add_u32 m0, s64, 0
    s_add_u32 s78, s65, 0
    buffer_load_dwordx4 v2, s[8:11], s78 offen offset:0 sc1 lds
    buffer_load_dwordx4 v2, s[8:11], s78 offen offset:1024 sc1 lds
    buffer_load_dwordx4 v2, s[8:11], s78 offen offset:2048 sc1 lds
    buffer_load_dwordx4 v2, s[8:11], s78 offen offset:3072 sc1 lds
    s_add_u32 m0, s64, 4096
    s_add_u32 s78, s65, 4096
    buffer_load_dwordx4 v2, s[8:11], s78 offen offset:0 sc1 lds
L_ds_l2:
    s_add_u32 s64, s48, 10
    s_cmp_lt_u32 s64, 28
    s_cbranch_scc0 L_ds_e0
    s_cmp_ge_u32 s64, 14
    s_cselect_b32 s65, 51200, 0
    s_cselect_b32 s66, 14, 0
    s_sub_u32 s66, s64, s66
    s_mul_i32 s64, s64, 5120
    s_add_u32 s65, s65, s64
    s_cmp_le_u32 s76, s66
    s_cselect_b32 s66, s75, s77
    s_add_u32 s65, s65, s66
    s_add_u32 m0, s64, 0
    s_add_u32 s78, s65, 0
    buffer_load_dwordx4 v2, s[8:11], s78 offen offset:0 sc1 lds
    buffer_load_dwordx4 v2, s[8:11], s78 offen offset:1024 sc1 lds
    buffer_load_dwordx4 v2, s[8:11], s78 offen offset:2048 sc1 lds
    buffer_load_dwordx4 v2, s[8:11], s78 offen offset:3072 sc1 lds
    s_add_u32 m0, s64, 4096
    s_add_u32 s78, s65, 4096
    buffer_load_dwordx4 v2, s[8:11], s78 offen offset:0 sc1 lds
L_ds_e0:
    s_add_u32 s64, s48, 14
    s_cmp_lt_u32 s64, 28
    s_cbranch_scc0 L_ds_e1
    s_cmp_ge_u32 s64, 14
    s_cselect_b32 s65, 51200, 0
    s_cselect_b32 s66, 14, 0
    s_sub_u32 s66, s64, s66
    s_mul_i32 s64, s64, 5120
    s_add_u32 s65, s65, s64
    s_cmp_le_u32 s76, s66
    s_cselect_b32 s66, s75, s77
    s_add_u32 s65, s65, s66
    s_add_u32 m0, s64, 0
    s_add_u32 s78, s65, 0
    buffer_load_dwordx4 v2, s[8:11], s78 offen offset:0 sc1 lds
    buffer_load_dwordx4 v2, s[8:11], s78 offen offset:1024 sc1 lds
    buffer_load_dwordx4 v2, s[8:11], s78 offen offset:2048 sc1 lds
    buffer_load_dwordx4 v2, s[8:11], s78 offen offset:3072 sc1 lds
    s_add_u32 m0, s64, 4096
    s_add_u32 s78, s65, 4096
    buffer_load_dwordx4 v2, s[8:11], s78 offen offset:0 sc1 lds
L_ds_e1:
    s_add_u32 s64, s48, 18
    s_cmp_lt_u32 s64, 28
    s_cbranch_scc0 L_ds_e2
    s_cmp_ge_u32 s64, 14
    s_cselect_b32 s65, 51200, 0
    s_cselect_b32 s66, 14, 0
    s_sub_u32 s66, s64, s66
    s_mul_i32 s64, s64, 5120
    s_add_u32 s65, s65, s64
    s_cmp_le_u32 s76, s66
    s_cselect_b32 s66, s75, s77
    s_add_u32 s65, s65, s66
    s_add_u32 m0, s64, 0
    s_add_u32 s78, s65, 0
    buffer_load_dwordx4 v2, s[8:11], s78 offen offset:0 sc1 lds
    buffer_load_dwordx4 v2, s[8:11], s78 offen offset:1024 sc1 lds
    buffer_load_dwordx4 v2, s[8:11], s78 offen offset:2048 sc1 lds
    buffer_load_dwordx4 v2, s[8:11], s78 offen offset:3072 sc1 lds
    s_add_u32 m0, s64, 4096
    s_add_u32 s78, s65, 4096
    buffer_load_dwordx4 v2, s[8:11], s78 offen offset:0 sc1 lds
L_ds_e2:
    s_add_u32 s64, s48, 22
    s_cmp_lt_u32 s64, 28
    s_cbranch_scc0 L_ds_e3
    s_cmp_ge_u32 s64, 14
    s_cselect_b32 s65, 51200, 0
    s_cselect_b32 s66, 14, 0
    s_sub_u32 s66, s64, s66
    s_mul_i32 s64, s64, 5120
    s_add_u32 s65, s65, s64
    s_cmp_le_u32 s76, s66
    s_cselect_b32 s66, s75, s77
    s_add_u32 s65, s65, s66
    s_add_u32 m0, s64, 0
    s_add_u32 s78, s65, 0
    buffer_load_dwordx4 v2, s[8:11], s78 offen offset:0 sc1 lds
    buffer_load_dwordx4 v2, s[8:11], s78 offen offset:1024 sc1 lds
    buffer_load_dwordx4 v2, s[8:11], s78 offen offset:2048 sc1 lds
    buffer_load_dwordx4 v2, s[8:11], s78 offen offset:3072 sc1 lds
    s_add_u32 m0, s64, 4096
    s_add_u32 s78, s65, 4096
    buffer_load_dwordx4 v2, s[8:11], s78 offen offset:0 sc1 lds
L_ds_e3:
    s_add_u32 s64, s48, 26
    s_cmp_lt_u32 s64, 28
    s_cbranch_scc0 L_ds_e4
    s_cmp_ge_u32 s64, 14
    s_cselect_b32 s65, 51200, 0
    s_cselect_b32 s66, 14, 0
    s_sub_u32 s66, s64, s66
    s_mul_i32 s64, s64, 5120
    s_add_u32 s65, s65, s64
    s_cmp_le_u32 s76, s66
    s_cselect_b32 s66, s75, s77
    s_add_u32 s65, s65, s66
    s_add_u32 m0, s64, 0
    s_add_u32 s78, s65, 0
    buffer_load_dwordx4 v2, s[8:11], s78 offen offset:0 sc1 lds
    buffer_load_dwordx4 v2, s[8:11], s78 offen offset:1024 sc1 lds
    buffer_load_dwordx4 v2, s[8:11], s78 offen offset:2048 sc1 lds
    buffer_load_dwordx4 v2, s[8:11], s78 offen offset:3072 sc1 lds
    s_add_u32 m0, s64, 4096
    s_add_u32 s78, s65, 4096
    buffer_load_dwordx4 v2, s[8:11], s78 offen offset:0 sc1 lds
L_ds_e4:
    s_cmp_le_i32 s71, 18
    s_cselect_b32 s74, s73, s72
    s_add_u32 s74, s74, 92160
    s_add_u32 s78, s74, 4096
    buffer_load_dwordx4 v[168:171], v2, s[8:11], s74 offen offset:0 sc1
    buffer_load_dwordx4 v[172:175], v2, s[8:11], s74 offen offset:1024 sc1
    buffer_load_dwordx4 v[176:179], v2, s[8:11], s74 offen offset:2048 sc1
    buffer_load_dwordx4 v[180:183], v2, s[8:11], s74 offen offset:3072 sc1
    buffer_load_dwordx4 v[184:187], v2, s[8:11], s78 offen offset:0 sc1
    s_cmp_le_i32 s71, 20
    s_cselect_b32 s74, s73, s72
    s_add_u32 s74, s74, 102400
    s_add_u32 s78, s74, 4096
    buffer_load_dwordx4 v[188:191], v2, s[8:11], s74 offen offset:0 sc1
    buffer_load_dwordx4 v[192:195], v2, s[8:11], s74 offen offset:1024 sc1
    buffer_load_dwordx4 v[196:199], v2, s[8:11], s74 offen offset:2048 sc1
    buffer_load_dwordx4 v[200:203], v2, s[8:11], s74 offen offset:3072 sc1
    buffer_load_dwordx4 v[204:207], v2, s[8:11], s78 offen offset:0 sc1
    s_cmp_le_i32 s71, 22
    s_cselect_b32 s74, s73, s72
    s_add_u32 s74, s74, 112640
    s_add_u32 s78, s74, 4096
    buffer_load_dwordx4 v[208:211], v2, s[8:11], s74 offen offset:0 sc1
    buffer_load_dwordx4 v[212:215], v2, s[8:11], s74 offen offset:1024 sc1
    buffer_load_dwordx4 v[216:219], v2, s[8:11], s74 offen offset:2048 sc1
    buffer_load_dwordx4 v[220:223], v2, s[8:11], s74 offen offset:3072 sc1
    buffer_load_dwordx4 v[224:227], v2, s[8:11], s78 offen offset:0 sc1
    s_branch L_p2_help
L_dft_cons:
    s_mov_b32 s6, 0x280000
    s_mov_b32 s7, 0x20000
    s_mov_b32 s23, 0x20000
    s_waitcnt lgkmcnt(0)
    s_mov_b32 s4, s28
    s_mov_b32 s5, s29
    s_load_dwordx2 s[12:13], s[46:47], 0x18000
    s_lshr_b32 s51, s50, 2
    s_lshr_b32 s53, s49, 1
    s_lshl_b32 s53, s53, 3
    s_add_u32 s51, s51, s53
    s_and_b32 s52, s50, 3
    s_and_b32 s53, s49, 1
    s_lshl_b32 s53, s53, 2
    s_add_u32 s52, s52, s53
    s_mov_b32 s10, 0xc00000
    s_mov_b32 s11, 0x20000
    s_mov_b32 s18, 0x280000
    s_mov_b32 s19, 0x20000
    s_mov_b32 s8, s46
    s_mov_b32 s9, s47
    s_mov_b32 s16, s42
    s_mov_b32 s17, s43
    s_sub_u32 s56, s48, 4
    s_setprio 1
    v_and_b32 v208, 31, v0
    v_lshrrev_b32 v209, 5, v0
    v_bfe_u32 v210, v0, 1, 3
    v_xor_b32 v210, v210, v209
    v_lshlrev_b32 v210, 4, v210
    v_lshl_add_u32 v210, v208, 7, v210
    s_lshl_b32 s57, s56, 12
    s_add_u32 s57, s57, 0
    v_xor_b32 v6, 0, v210
    v_add_u32 v2, s57, v6
    v_add_u32 v211, 32768, v6
    v_add_u32 v215, 81920, v6
    v_add_u32 v219, 131072, v6
    v_xor_b32 v6, 32, v210
    v_add_u32 v3, s57, v6
    v_add_u32 v212, 32768, v6
    v_add_u32 v216, 81920, v6
    v_add_u32 v220, 131072, v6
    v_xor_b32 v6, 64, v210
    v_add_u32 v4, s57, v6
    v_add_u32 v213, 32768, v6
    v_add_u32 v217, 81920, v6
    v_add_u32 v221, 131072, v6
    v_xor_b32 v6, 96, v210
    v_add_u32 v5, s57, v6
    v_add_u32 v214, 32768, v6
    v_add_u32 v218, 81920, v6
    v_add_u32 v222, 131072, v6
    v_lshlrev_b32 v7, 2, v209
    s_mov_b32 s62, 0x3d000000
    v_add_u32 v224, 0, v7
    v_mul_u32_u24 v224, v224, v208
    v_and_b32 v224, 31, v224
    v_cvt_f32_u32 v224, v224
    v_mul_f32 v224, s62, v224
    v_add_u32 v225, 1, v7
    v_mul_u32_u24 v225, v225, v208
    v_and_b32 v225, 31, v225
    v_cvt_f32_u32 v225, v225
    v_mul_f32 v225, s62, v225
    v_add_u32 v226, 2, v7
    v_mul_u32_u24 v226, v226, v208
    v_and_b32 v226, 31, v226
    v_cvt_f32_u32 v226, v226
    v_mul_f32 v226, s62, v226
    v_add_u32 v227, 3, v7
    v_mul_u32_u24 v227, v227, v208
    v_and_b32 v227, 31, v227
    v_cvt_f32_u32 v227, v227
    v_mul_f32 v227, s62, v227
    v_add_u32 v228, 8, v7
    v_mul_u32_u24 v228, v228, v208
    v_and_b32 v228, 31, v228
    v_cvt_f32_u32 v228, v228
    v_mul_f32 v228, s62, v228
    v_add_u32 v229, 9, v7
    v_mul_u32_u24 v229, v229, v208
    v_and_b32 v229, 31, v229
    v_cvt_f32_u32 v229, v229
    v_mul_f32 v229, s62, v229
    v_add_u32 v230, 10, v7
    v_mul_u32_u24 v230, v230, v208
    v_and_b32 v230, 31, v230
    v_cvt_f32_u32 v230, v230
    v_mul_f32 v230, s62, v230
    v_add_u32 v231, 11, v7
    v_mul_u32_u24 v231, v231, v208
    v_and_b32 v231, 31, v231
    v_cvt_f32_u32 v231, v231
    v_mul_f32 v231, s62, v231
    v_add_u32 v232, 16, v7
    v_mul_u32_u24 v232, v232, v208
    v_and_b32 v232, 31, v232
    v_cvt_f32_u32 v232, v232
    v_mul_f32 v232, s62, v232
    v_add_u32 v233, 17, v7
    v_mul_u32_u24 v233, v233, v208
    v_and_b32 v233, 31, v233
    v_cvt_f32_u32 v233, v233
    v_mul_f32 v233, s62, v233
    v_add_u32 v234, 18, v7
    v_mul_u32_u24 v234, v234, v208
    v_and_b32 v234, 31, v234
    v_cvt_f32_u32 v234, v234
    v_mul_f32 v234, s62, v234
    v_add_u32 v235, 19, v7
    v_mul_u32_u24 v235, v235, v208
    v_and_b32 v235, 31, v235
    v_cvt_f32_u32 v235, v235
    v_mul_f32 v235, s62, v235
    v_add_u32 v236, 24, v7
    v_mul_u32_u24 v236, v236, v208
    v_and_b32 v236, 31, v236
    v_cvt_f32_u32 v236, v236
    v_mul_f32 v236, s62, v236
    v_add_u32 v237, 25, v7
    v_mul_u32_u24 v237, v237, v208
    v_and_b32 v237, 31, v237
    v_cvt_f32_u32 v237, v237
    v_mul_f32 v237, s62, v237
    v_add_u32 v238, 26, v7
    v_mul_u32_u24 v238, v238, v208
    v_and_b32 v238, 31, v238
    v_cvt_f32_u32 v238, v238
    v_mul_f32 v238, s62, v238
    v_add_u32 v239, 27, v7
    v_mul_u32_u24 v239, v239, v208
    v_and_b32 v239, 31, v239
    v_cvt_f32_u32 v239, v239
    v_mul_f32 v239, s62, v239
    v_sin_f32 v240, v224
    v_cos_f32 v224, v224
    v_sin_f32 v241, v225
    v_cos_f32 v225, v225
    v_sin_f32 v242, v226
    v_cos_f32 v226, v226
    v_sin_f32 v243, v227
    v_cos_f32 v227, v227
    v_sin_f32 v244, v228
    v_cos_f32 v228, v228
    v_sin_f32 v245, v229
    v_cos_f32 v229, v229
    v_sin_f32 v246, v230
    v_cos_f32 v230, v230
    v_sin_f32 v247, v231
    v_cos_f32 v231, v231
    v_sin_f32 v248, v232
    v_cos_f32 v232, v232
    v_sin_f32 v249, v233
    v_cos_f32 v233, v233
    v_sin_f32 v250, v234
    v_cos_f32 v234, v234
    v_sin_f32 v251, v235
    v_cos_f32 v235, v235
    v_sin_f32 v252, v236
    v_cos_f32 v236, v236
    v_sin_f32 v253, v237
    v_cos_f32 v237, v237
    v_sin_f32 v254, v238
    v_cos_f32 v238, v238
    v_sin_f32 v255, v239
    v_cos_f32 v239, v239
    s_lshl_b32 s57, s56, 7
    s_add_u32 s57, s57, 155648
    v_lshl_add_u32 v160, v209, 4, s57
    v_mul_u32_u24 v161, 1552, v208
    v_lshl_add_u32 v161, v209, 6, v161
    v_lshrrev_b32 v6, 3, v208
    v_add_u32 v6, s56, v6
    v_and_b32 v6, 3, v6
    v_lshl_add_u32 v161, v6, 2, v161
    s_waitcnt lgkmcnt(0)
    s_add_u32 s12, s12, 1
    s_add_u32 s13, s13, 1
    s_barrier
    ds_read_b128 v[152:155], v2 offset:0
    ds_read_b128 v[104:107], v211 offset:0
    ds_read_b128 v[108:111], v211 offset:4096
    ds_read_b128 v[112:115], v211 offset:8192
    ds_read_b128 v[116:119], v211 offset:12288
    ds_read_b128 v[120:123], v211 offset:16384
    ds_read_b128 v[124:127], v211 offset:20480
.p2align 3
    s_waitcnt lgkmcnt(5)
    v_mfma_f32_32x32x16_bf16 v[8:23], v[152:155], v[104:107], 0
    ds_read_b128 v[156:159], v3 offset:0
    s_waitcnt lgkmcnt(5)
    v_mfma_f32_32x32x16_bf16 v[40:55], v[152:155], v[108:111], 0
    ds_read_b128 v[128:131], v212 offset:0
    s_waitcnt lgkmcnt(5)
    v_mfma_f32_32x32x16_bf16 v[72:87], v[152:155], v[112:115], 0
    ds_read_b128 v[132:135], v212 offset:4096
    s_waitcnt lgkmcnt(5)
    v_mfma_f32_32x32x16_bf16 v[24:39], v[152:155], v[116:119], 0
    ds_read_b128 v[136:139], v212 offset:8192
    s_waitcnt lgkmcnt(5)
    v_mfma_f32_32x32x16_bf16 v[56:71], v[152:155], v[120:123], 0
    ds_read_b128 v[140:143], v212 offset:12288
    s_waitcnt lgkmcnt(5)
    v_mfma_f32_32x32x16_bf16 v[88:103], v[152:155], v[124:127], 0
    ds_read_b128 v[144:147], v212 offset:16384
    ds_read_b128 v[148:151], v212 offset:20480
    s_waitcnt lgkmcnt(5)
    v_mfma_f32_32x32x16_bf16 v[8:23], v[156:159], v[128:131], v[8:23]
    ds_read_b128 v[152:155], v4 offset:0
    s_waitcnt lgkmcnt(5)
    v_mfma_f32_32x32x16_bf16 v[40:55], v[156:159], v[132:135], v[40:55]
    ds_read_b128 v[104:107], v213 offset:0
    s_waitcnt lgkmcnt(5)
    v_mfma_f32_32x32x16_bf16 v[72:87], v[156:159], v[136:139], v[72:87]
    ds_read_b128 v[108:111], v213 offset:4096
    s_waitcnt lgkmcnt(5)
    v_mfma_f32_32x32x16_bf16 v[24:39], v[156:159], v[140:143], v[24:39]
    ds_read_b128 v[112:115], v213 offset:8192
    s_waitcnt lgkmcnt(5)
    v_mfma_f32_32x32x16_bf16 v[56:71], v[156:159], v[144:147], v[56:71]
    ds_read_b128 v[116:119], v213 offset:12288
    s_waitcnt lgkmcnt(5)
    v_mfma_f32_32x32x16_bf16 v[88:103], v[156:159], v[148:151], v[88:103]
    ds_read_b128 v[120:123], v213 offset:16384
    ds_read_b128 v[124:127], v213 offset:20480
    s_waitcnt lgkmcnt(5)
    v_mfma_f32_32x32x16_bf16 v[8:23], v[152:155], v[104:107], v[8:23]
    ds_read_b128 v[156:159], v5 offset:0
    s_waitcnt lgkmcnt(5)
    v_mfma_f32_32x32x16_bf16 v[40:55], v[152:155], v[108:111], v[40:55]
    ds_read_b128 v[128:131], v214 offset:0
    s_waitcnt lgkmcnt(5)
    v_mfma_f32_32x32x16_bf16 v[72:87], v[152:155], v[112:115], v[72:87]
    ds_read_b128 v[132:135], v214 offset:4096
    s_waitcnt lgkmcnt(5)
    v_mfma_f32_32x32x16_bf16 v[24:39], v[152:155], v[116:119], v[24:39]
    ds_read_b128 v[136:139], v214 offset:8192
    s_waitcnt lgkmcnt(5)
    v_mfma_f32_32x32x16_bf16 v[56:71], v[152:155], v[120:123], v[56:71]
    ds_read_b128 v[140:143], v214 offset:12288
    s_waitcnt lgkmcnt(5)
    v_mfma_f32_32x32x16_bf16 v[88:103], v[152:155], v[124:127], v[88:103]
    ds_read_b128 v[144:147], v214 offset:16384
    ds_read_b128 v[148:151], v214 offset:20480
    s_waitcnt lgkmcnt(5)
    v_mfma_f32_32x32x16_bf16 v[8:23], v[156:159], v[128:131], v[8:23]
    s_waitcnt lgkmcnt(4)
    v_mfma_f32_32x32x16_bf16 v[40:55], v[156:159], v[132:135], v[40:55]
    s_waitcnt lgkmcnt(3)
    v_mfma_f32_32x32x16_bf16 v[72:87], v[156:159], v[136:139], v[72:87]
    s_waitcnt lgkmcnt(0)
    s_barrier
    ds_read_b128 v[152:155], v2 offset:16384
    ds_read_b128 v[104:107], v211 offset:24576
    ds_read_b128 v[108:111], v211 offset:28672
    ds_read_b128 v[112:115], v211 offset:32768
    ds_read_b128 v[116:119], v211 offset:36864
    ds_read_b128 v[120:123], v211 offset:40960
    ds_read_b128 v[124:127], v211 offset:45056
    v_mfma_f32_32x32x16_bf16 v[24:39], v[156:159], v[140:143], v[24:39]
    v_mfma_f32_32x32x16_bf16 v[56:71], v[156:159], v[144:147], v[56:71]
    v_mfma_f32_32x32x16_bf16 v[88:103], v[156:159], v[148:151], v[88:103]
    s_waitcnt lgkmcnt(5)
    v_mfma_f32_32x32x16_bf16 v[8:23], v[152:155], v[104:107], v[8:23]
    ds_read_b128 v[156:159], v3 offset:16384
    s_waitcnt lgkmcnt(5)
    v_mfma_f32_32x32x16_bf16 v[40:55], v[152:155], v[108:111], v[40:55]
    ds_read_b128 v[128:131], v212 offset:24576
    s_waitcnt lgkmcnt(5)
    v_mfma_f32_32x32x16_bf16 v[72:87], v[152:155], v[112:115], v[72:87]
    ds_read_b128 v[132:135], v212 offset:28672
    s_waitcnt lgkmcnt(5)
    v_mfma_f32_32x32x16_bf16 v[24:39], v[152:155], v[116:119], v[24:39]
    ds_read_b128 v[136:139], v212 offset:32768
    s_waitcnt lgkmcnt(5)
    v_mfma_f32_32x32x16_bf16 v[56:71], v[152:155], v[120:123], v[56:71]
    ds_read_b128 v[140:143], v212 offset:36864
    s_waitcnt lgkmcnt(5)
    v_mfma_f32_32x32x16_bf16 v[88:103], v[152:155], v[124:127], v[88:103]
    ds_read_b128 v[144:147], v212 offset:40960
    ds_read_b128 v[148:151], v212 offset:45056
    s_waitcnt lgkmcnt(5)
    v_mfma_f32_32x32x16_bf16 v[8:23], v[156:159], v[128:131], v[8:23]
    ds_read_b128 v[152:155], v4 offset:16384
    s_waitcnt lgkmcnt(5)
    v_mfma_f32_32x32x16_bf16 v[40:55], v[156:159], v[132:135], v[40:55]
    ds_read_b128 v[104:107], v213 offset:24576
    s_waitcnt lgkmcnt(5)
    v_mfma_f32_32x32x16_bf16 v[72:87], v[156:159], v[136:139], v[72:87]
    ds_read_b128 v[108:111], v213 offset:28672
    s_waitcnt lgkmcnt(5)
    v_mfma_f32_32x32x16_bf16 v[24:39], v[156:159], v[140:143], v[24:39]
    ds_read_b128 v[112:115], v213 offset:32768
    s_waitcnt lgkmcnt(5)
    v_mfma_f32_32x32x16_bf16 v[56:71], v[156:159], v[144:147], v[56:71]
    ds_read_b128 v[116:119], v213 offset:36864
    s_waitcnt lgkmcnt(5)
    v_mfma_f32_32x32x16_bf16 v[88:103], v[156:159], v[148:151], v[88:103]
    ds_read_b128 v[120:123], v213 offset:40960
    ds_read_b128 v[124:127], v213 offset:45056
    s_waitcnt lgkmcnt(5)
    v_mfma_f32_32x32x16_bf16 v[8:23], v[152:155], v[104:107], v[8:23]
    ds_read_b128 v[156:159], v5 offset:16384
    s_waitcnt lgkmcnt(5)
    v_mfma_f32_32x32x16_bf16 v[40:55], v[152:155], v[108:111], v[40:55]
    ds_read_b128 v[128:131], v214 offset:24576
    s_waitcnt lgkmcnt(5)
    v_mfma_f32_32x32x16_bf16 v[72:87], v[152:155], v[112:115], v[72:87]
    ds_read_b128 v[132:135], v214 offset:28672
    s_waitcnt lgkmcnt(5)
    v_mfma_f32_32x32x16_bf16 v[24:39], v[152:155], v[116:119], v[24:39]
    ds_read_b128 v[136:139], v214 offset:32768
    s_waitcnt lgkmcnt(5)
    v_mfma_f32_32x32x16_bf16 v[56:71], v[152:155], v[120:123], v[56:71]
    ds_read_b128 v[140:143], v214 offset:36864
    s_waitcnt lgkmcnt(5)
    v_mfma_f32_32x32x16_bf16 v[88:103], v[152:155], v[124:127], v[88:103]
    ds_read_b128 v[144:147], v214 offset:40960
    ds_read_b128 v[148:151], v214 offset:45056
    s_waitcnt lgkmcnt(5)
    v_mfma_f32_32x32x16_bf16 v[8:23], v[156:159], v[128:131], v[8:23]
    s_waitcnt lgkmcnt(4)
    v_mfma_f32_32x32x16_bf16 v[40:55], v[156:159], v[132:135], v[40:55]
    s_waitcnt lgkmcnt(3)
    v_mfma_f32_32x32x16_bf16 v[72:87], v[156:159], v[136:139], v[72:87]
    s_waitcnt lgkmcnt(0)
    s_barrier
    ds_read_b128 v[152:155], v2 offset:0
    ds_read_b128 v[104:107], v215 offset:0
    ds_read_b128 v[108:111], v215 offset:4096
    ds_read_b128 v[112:115], v215 offset:8192
    ds_read_b128 v[116:119], v215 offset:12288
    ds_read_b128 v[120:123], v215 offset:16384
    ds_read_b128 v[124:127], v215 offset:20480
    v_mfma_f32_32x32x16_bf16 v[24:39], v[156:159], v[140:143], v[24:39]
    v_mfma_f32_32x32x16_bf16 v[56:71], v[156:159], v[144:147], v[56:71]
    v_mfma_f32_32x32x16_bf16 v[88:103], v[156:159], v[148:151], v[88:103]
    s_waitcnt lgkmcnt(5)
    v_mfma_f32_32x32x16_bf16 v[8:23], v[152:155], v[104:107], v[8:23]
    ds_read_b128 v[156:159], v3 offset:0
    s_waitcnt lgkmcnt(5)
    v_mfma_f32_32x32x16_bf16 v[40:55], v[152:155], v[108:111], v[40:55]
    ds_read_b128 v[128:131], v216 offset:0
    s_waitcnt lgkmcnt(5)
    v_mfma_f32_32x32x16_bf16 v[72:87], v[152:155], v[112:115], v[72:87]
    ds_read_b128 v[132:135], v216 offset:4096
    s_waitcnt lgkmcnt(5)
    v_mfma_f32_32x32x16_bf16 v[24:39], v[152:155], v[116:119], v[24:39]
    ds_read_b128 v[136:139], v216 offset:8192
    s_waitcnt lgkmcnt(5)
    v_mfma_f32_32x32x16_bf16 v[56:71], v[152:155], v[120:123], v[56:71]
    ds_read_b128 v[140:143], v216 offset:12288
    s_waitcnt lgkmcnt(5)
    v_mfma_f32_32x32x16_bf16 v[88:103], v[152:155], v[124:127], v[88:103]
    ds_read_b128 v[144:147], v216 offset:16384
    ds_read_b128 v[148:151], v216 offset:20480
    s_waitcnt lgkmcnt(5)
    v_mfma_f32_32x32x16_bf16 v[8:23], v[156:159], v[128:131], v[8:23]
    ds_read_b128 v[152:155], v4 offset:0
    s_waitcnt lgkmcnt(5)
    v_mfma_f32_32x32x16_bf16 v[40:55], v[156:159], v[132:135], v[40:55]
    ds_read_b128 v[104:107], v217 offset:0
    s_waitcnt lgkmcnt(5)
    v_mfma_f32_32x32x16_bf16 v[72:87], v[156:159], v[136:139], v[72:87]
    ds_read_b128 v[108:111], v217 offset:4096
    s_waitcnt lgkmcnt(5)
    v_mfma_f32_32x32x16_bf16 v[24:39], v[156:159], v[140:143], v[24:39]
    ds_read_b128 v[112:115], v217 offset:8192
    s_waitcnt lgkmcnt(5)
    v_mfma_f32_32x32x16_bf16 v[56:71], v[156:159], v[144:147], v[56:71]
    ds_read_b128 v[116:119], v217 offset:12288
    s_waitcnt lgkmcnt(5)
    v_mfma_f32_32x32x16_bf16 v[88:103], v[156:159], v[148:151], v[88:103]
    ds_read_b128 v[120:123], v217 offset:16384
    ds_read_b128 v[124:127], v217 offset:20480
    s_waitcnt lgkmcnt(5)
    v_mfma_f32_32x32x16_bf16 v[8:23], v[152:155], v[104:107], v[8:23]
    ds_read_b128 v[156:159], v5 offset:0
    s_waitcnt lgkmcnt(5)
    v_mfma_f32_32x32x16_bf16 v[40:55], v[152:155], v[108:111], v[40:55]
    ds_read_b128 v[128:131], v218 offset:0
    s_waitcnt lgkmcnt(5)
    v_mfma_f32_32x32x16_bf16 v[72:87], v[152:155], v[112:115], v[72:87]
    ds_read_b128 v[132:135], v218 offset:4096
    s_waitcnt lgkmcnt(5)
    v_mfma_f32_32x32x16_bf16 v[24:39], v[152:155], v[116:119], v[24:39]
    ds_read_b128 v[136:139], v218 offset:8192
    s_waitcnt lgkmcnt(5)
    v_mfma_f32_32x32x16_bf16 v[56:71], v[152:155], v[120:123], v[56:71]
    ds_read_b128 v[140:143], v218 offset:12288
    s_waitcnt lgkmcnt(5)
    v_mfma_f32_32x32x16_bf16 v[88:103], v[152:155], v[124:127], v[88:103]
    ds_read_b128 v[144:147], v218 offset:16384
    ds_read_b128 v[148:151], v218 offset:20480
    s_waitcnt lgkmcnt(5)
    v_mfma_f32_32x32x16_bf16 v[8:23], v[156:159], v[128:131], v[8:23]
    s_waitcnt lgkmcnt(4)
    v_mfma_f32_32x32x16_bf16 v[40:55], v[156:159], v[132:135], v[40:55]
    s_waitcnt lgkmcnt(3)
    v_mfma_f32_32x32x16_bf16 v[72:87], v[156:159], v[136:139], v[72:87]
    s_waitcnt lgkmcnt(0)
    s_barrier
    ds_read_b128 v[152:155], v2 offset:16384
    ds_read_b128 v[104:107], v215 offset:24576
    ds_read_b128 v[108:111], v215 offset:28672
    ds_read_b128 v[112:115], v215 offset:32768
    ds_read_b128 v[116:119], v215 offset:36864
    ds_read_b128 v[120:123], v215 offset:40960
    ds_read_b128 v[124:127], v215 offset:45056
    v_mfma_f32_32x32x16_bf16 v[24:39], v[156:159], v[140:143], v[24:39]
    v_mfma_f32_32x32x16_bf16 v[56:71], v[156:159], v[144:147], v[56:71]
    v_mfma_f32_32x32x16_bf16 v[88:103], v[156:159], v[148:151], v[88:103]
    s_waitcnt lgkmcnt(5)
    v_mfma_f32_32x32x16_bf16 v[8:23], v[152:155], v[104:107], v[8:23]
    ds_read_b128 v[156:159], v3 offset:16384
    s_waitcnt lgkmcnt(5)
    v_mfma_f32_32x32x16_bf16 v[40:55], v[152:155], v[108:111], v[40:55]
    ds_read_b128 v[128:131], v216 offset:24576
    s_waitcnt lgkmcnt(5)
    v_mfma_f32_32x32x16_bf16 v[72:87], v[152:155], v[112:115], v[72:87]
    ds_read_b128 v[132:135], v216 offset:28672
    s_waitcnt lgkmcnt(5)
    v_mfma_f32_32x32x16_bf16 v[24:39], v[152:155], v[116:119], v[24:39]
    ds_read_b128 v[136:139], v216 offset:32768
    s_waitcnt lgkmcnt(5)
    v_mfma_f32_32x32x16_bf16 v[56:71], v[152:155], v[120:123], v[56:71]
    ds_read_b128 v[140:143], v216 offset:36864
    s_waitcnt lgkmcnt(5)
    v_mfma_f32_32x32x16_bf16 v[88:103], v[152:155], v[124:127], v[88:103]
    ds_read_b128 v[144:147], v216 offset:40960
    ds_read_b128 v[148:151], v216 offset:45056
    s_waitcnt lgkmcnt(5)
    v_mfma_f32_32x32x16_bf16 v[8:23], v[156:159], v[128:131], v[8:23]
    ds_read_b128 v[152:155], v4 offset:16384
    s_waitcnt lgkmcnt(5)
    v_mfma_f32_32x32x16_bf16 v[40:55], v[156:159], v[132:135], v[40:55]
    ds_read_b128 v[104:107], v217 offset:24576
    s_waitcnt lgkmcnt(5)
    v_mfma_f32_32x32x16_bf16 v[72:87], v[156:159], v[136:139], v[72:87]
    ds_read_b128 v[108:111], v217 offset:28672
    s_waitcnt lgkmcnt(5)
    v_mfma_f32_32x32x16_bf16 v[24:39], v[156:159], v[140:143], v[24:39]
    ds_read_b128 v[112:115], v217 offset:32768
    s_waitcnt lgkmcnt(5)
    v_mfma_f32_32x32x16_bf16 v[56:71], v[156:159], v[144:147], v[56:71]
    ds_read_b128 v[116:119], v217 offset:36864
    s_waitcnt lgkmcnt(5)
    v_mfma_f32_32x32x16_bf16 v[88:103], v[156:159], v[148:151], v[88:103]
    ds_read_b128 v[120:123], v217 offset:40960
    ds_read_b128 v[124:127], v217 offset:45056
    s_waitcnt lgkmcnt(5)
    v_mfma_f32_32x32x16_bf16 v[8:23], v[152:155], v[104:107], v[8:23]
    ds_read_b128 v[156:159], v5 offset:16384
    s_waitcnt lgkmcnt(5)
    v_mfma_f32_32x32x16_bf16 v[40:55], v[152:155], v[108:111], v[40:55]
    ds_read_b128 v[128:131], v218 offset:24576
    s_waitcnt lgkmcnt(5)
    v_mfma_f32_32x32x16_bf16 v[72:87], v[152:155], v[112:115], v[72:87]
    ds_read_b128 v[132:135], v218 offset:28672
    s_waitcnt lgkmcnt(5)
    v_mfma_f32_32x32x16_bf16 v[24:39], v[152:155], v[116:119], v[24:39]
    ds_read_b128 v[136:139], v218 offset:32768
    s_waitcnt lgkmcnt(5)
    v_mfma_f32_32x32x16_bf16 v[56:71], v[152:155], v[120:123], v[56:71]
    ds_read_b128 v[140:143], v218 offset:36864
    s_waitcnt lgkmcnt(5)
    v_mfma_f32_32x32x16_bf16 v[88:103], v[152:155], v[124:127], v[88:103]
    ds_read_b128 v[144:147], v218 offset:40960
    ds_read_b128 v[148:151], v218 offset:45056
    s_waitcnt lgkmcnt(5)
    v_mfma_f32_32x32x16_bf16 v[8:23], v[156:159], v[128:131], v[8:23]
    s_waitcnt lgkmcnt(4)
    v_mfma_f32_32x32x16_bf16 v[40:55], v[156:159], v[132:135], v[40:55]
    s_waitcnt lgkmcnt(3)
    v_mfma_f32_32x32x16_bf16 v[72:87], v[156:159], v[136:139], v[72:87]
    s_waitcnt lgkmcnt(0)
    s_barrier
    ds_read_b128 v[152:155], v2 offset:0
    ds_read_b128 v[104:107], v219 offset:0
    ds_read_b128 v[108:111], v219 offset:4096
    ds_read_b128 v[112:115], v219 offset:8192
    ds_read_b128 v[116:119], v219 offset:12288
    ds_read_b128 v[120:123], v219 offset:16384
    ds_read_b128 v[124:127], v219 offset:20480
    v_mfma_f32_32x32x16_bf16 v[24:39], v[156:159], v[140:143], v[24:39]
    v_mfma_f32_32x32x16_bf16 v[56:71], v[156:159], v[144:147], v[56:71]
    v_mfma_f32_32x32x16_bf16 v[88:103], v[156:159], v[148:151], v[88:103]
    s_waitcnt lgkmcnt(5)
    v_mfma_f32_32x32x16_bf16 v[8:23], v[152:155], v[104:107], v[8:23]
    ds_read_b128 v[156:159], v3 offset:0
    s_waitcnt lgkmcnt(5)
    v_mfma_f32_32x32x16_bf16 v[40:55], v[152:155], v[108:111], v[40:55]
    ds_read_b128 v[128:131], v220 offset:0
    s_waitcnt lgkmcnt(5)
    v_mfma_f32_32x32x16_bf16 v[72:87], v[152:155], v[112:115], v[72:87]
    ds_read_b128 v[132:135], v220 offset:4096
    s_waitcnt lgkmcnt(5)
    v_mfma_f32_32x32x16_bf16 v[24:39], v[152:155], v[116:119], v[24:39]
    ds_read_b128 v[136:139], v220 offset:8192
    s_waitcnt lgkmcnt(5)
    v_mfma_f32_32x32x16_bf16 v[56:71], v[152:155], v[120:123], v[56:71]
    ds_read_b128 v[140:143], v220 offset:12288
    s_waitcnt lgkmcnt(5)
    v_mfma_f32_32x32x16_bf16 v[88:103], v[152:155], v[124:127], v[88:103]
    ds_read_b128 v[144:147], v220 offset:16384
    ds_read_b128 v[148:151], v220 offset:20480
    s_waitcnt lgkmcnt(5)
    v_mfma_f32_32x32x16_bf16 v[8:23], v[156:159], v[128:131], v[8:23]
    ds_read_b128 v[152:155], v4 offset:0
    s_waitcnt lgkmcnt(5)
    v_mfma_f32_32x32x16_bf16 v[40:55], v[156:159], v[132:135], v[40:55]
    ds_read_b128 v[104:107], v221 offset:0
    s_waitcnt lgkmcnt(5)
    v_mfma_f32_32x32x16_bf16 v[72:87], v[156:159], v[136:139], v[72:87]
    ds_read_b128 v[108:111], v221 offset:4096
    s_waitcnt lgkmcnt(5)
    v_mfma_f32_32x32x16_bf16 v[24:39], v[156:159], v[140:143], v[24:39]
    ds_read_b128 v[112:115], v221 offset:8192
    s_waitcnt lgkmcnt(5)
    v_mfma_f32_32x32x16_bf16 v[56:71], v[156:159], v[144:147], v[56:71]
    ds_read_b128 v[116:119], v221 offset:12288
    s_waitcnt lgkmcnt(5)
    v_mfma_f32_32x32x16_bf16 v[88:103], v[156:159], v[148:151], v[88:103]
    ds_read_b128 v[120:123], v221 offset:16384
    ds_read_b128 v[124:127], v221 offset:20480
    s_waitcnt lgkmcnt(5)
    v_mfma_f32_32x32x16_bf16 v[8:23], v[152:155], v[104:107], v[8:23]
    ds_read_b128 v[156:159], v5 offset:0
    s_waitcnt lgkmcnt(5)
    v_mfma_f32_32x32x16_bf16 v[40:55], v[152:155], v[108:111], v[40:55]
    ds_read_b128 v[128:131], v222 offset:0
    s_waitcnt lgkmcnt(5)
    v_mfma_f32_32x32x16_bf16 v[72:87], v[152:155], v[112:115], v[72:87]
    ds_read_b128 v[132:135], v222 offset:4096
    s_waitcnt lgkmcnt(5)
    v_mfma_f32_32x32x16_bf16 v[24:39], v[152:155], v[116:119], v[24:39]
    ds_read_b128 v[136:139], v222 offset:8192
    s_waitcnt lgkmcnt(5)
    v_mfma_f32_32x32x16_bf16 v[56:71], v[152:155], v[120:123], v[56:71]
    ds_read_b128 v[140:143], v222 offset:12288
    s_waitcnt lgkmcnt(5)
    v_mfma_f32_32x32x16_bf16 v[88:103], v[152:155], v[124:127], v[88:103]
    ds_read_b128 v[144:147], v222 offset:16384
    ds_read_b128 v[148:151], v222 offset:20480
    s_waitcnt lgkmcnt(5)
    v_mfma_f32_32x32x16_bf16 v[8:23], v[156:159], v[128:131], v[8:23]
    s_waitcnt lgkmcnt(4)
    v_mfma_f32_32x32x16_bf16 v[40:55], v[156:159], v[132:135], v[40:55]
    s_waitcnt lgkmcnt(3)
    v_mfma_f32_32x32x16_bf16 v[72:87], v[156:159], v[136:139], v[72:87]
    s_waitcnt lgkmcnt(0)
    s_barrier
    ds_read_b128 v[168:171], v160 offset:0
    ds_read_b128 v[172:175], v160 offset:32
    ds_read_b128 v[176:179], v160 offset:64
    ds_read_b128 v[180:183], v160 offset:96
    v_mfma_f32_32x32x16_bf16 v[24:39], v[156:159], v[140:143], v[24:39]
    v_mfma_f32_32x32x16_bf16 v[56:71], v[156:159], v[144:147], v[56:71]
    v_mfma_f32_32x32x16_bf16 v[88:103], v[156:159], v[148:151], v[88:103]
L_dc_epi:
    s_waitcnt lgkmcnt(0)
    v_pk_mul_f32 v[224:225], v[224:225], v[168:169]
    v_pk_mul_f32 v[240:241], v[240:241], v[168:169]
    v_pk_mul_f32 v[226:227], v[226:227], v[170:171]
    v_pk_mul_f32 v[242:243], v[242:243], v[170:171]
    v_pk_mul_f32 v[228:229], v[228:229], v[172:173]
    v_pk_mul_f32 v[244:245], v[244:245], v[172:173]
    v_pk_mul_f32 v[230:231], v[230:231], v[174:175]
    v_pk_mul_f32 v[246:247], v[246:247], v[174:175]
    v_pk_mul_f32 v[232:233], v[232:233], v[176:177]
    v_pk_mul_f32 v[248:249], v[248:249], v[176:177]
    v_pk_mul_f32 v[234:235], v[234:235], v[178:179]
    v_pk_mul_f32 v[250:251], v[250:251], v[178:179]
    v_pk_mul_f32 v[236:237], v[236:237], v[180:181]
    v_pk_mul_f32 v[252:253], v[252:253], v[180:181]
    v_pk_mul_f32 v[238:239], v[238:239], v[182:183]
    v_pk_mul_f32 v[254:255], v[254:255], v[182:183]
    v_cvt_pk_bf16_f32 v184, v224, v225
    v_cvt_pk_bf16_f32 v192, v240, v241
    v_xor_b32 v200, 0x80008000, v192
    v_cvt_pk_bf16_f32 v185, v226, v227
    v_cvt_pk_bf16_f32 v193, v242, v243
    v_xor_b32 v201, 0x80008000, v193
    v_cvt_pk_bf16_f32 v186, v228, v229
    v_cvt_pk_bf16_f32 v194, v244, v245
    v_xor_b32 v202, 0x80008000, v194
    v_cvt_pk_bf16_f32 v187, v230, v231
    v_cvt_pk_bf16_f32 v195, v246, v247
    v_xor_b32 v203, 0x80008000, v195
    v_cvt_pk_bf16_f32 v188, v232, v233
    v_cvt_pk_bf16_f32 v196, v248, v249
    v_xor_b32 v204, 0x80008000, v196
    v_cvt_pk_bf16_f32 v189, v234, v235
    v_cvt_pk_bf16_f32 v197, v250, v251
    v_xor_b32 v205, 0x80008000, v197
    v_cvt_pk_bf16_f32 v190, v236, v237
    v_cvt_pk_bf16_f32 v198, v252, v253
    v_xor_b32 v206, 0x80008000, v198
    v_cvt_pk_bf16_f32 v191, v238, v239
    v_cvt_pk_bf16_f32 v199, v254, v255
    v_xor_b32 v207, 0x80008000, v199
    v_cvt_pk_bf16_f32 v104, v8, v9
    v_cvt_pk_bf16_f32 v112, v24, v25
    v_cvt_pk_bf16_f32 v105, v10, v11
    v_cvt_pk_bf16_f32 v113, v26, v27
    v_cvt_pk_bf16_f32 v106, v12, v13
    v_cvt_pk_bf16_f32 v114, v28, v29
    v_cvt_pk_bf16_f32 v107, v14, v15
    v_cvt_pk_bf16_f32 v115, v30, v31
    v_cvt_pk_bf16_f32 v108, v16, v17
    v_cvt_pk_bf16_f32 v116, v32, v33
    v_cvt_pk_bf16_f32 v109, v18, v19
    v_cvt_pk_bf16_f32 v117, v34, v35
    v_cvt_pk_bf16_f32 v110, v20, v21
    v_cvt_pk_bf16_f32 v118, v36, v37
    v_cvt_pk_bf16_f32 v111, v22, v23
    v_cvt_pk_bf16_f32 v119, v38, v39
    s_nop 1
    v_mfma_f32_32x32x16_bf16 v[8:23], v[104:107], v[184:187], 0
    v_cvt_pk_bf16_f32 v120, v40, v41
    v_cvt_pk_bf16_f32 v128, v56, v57
    v_mfma_f32_32x32x16_bf16 v[24:39], v[112:115], v[184:187], 0
    v_cvt_pk_bf16_f32 v121, v42, v43
    v_cvt_pk_bf16_f32 v129, v58, v59
    v_mfma_f32_32x32x16_bf16 v[8:23], v[108:111], v[188:191], v[8:23]
    v_cvt_pk_bf16_f32 v122, v44, v45
    v_cvt_pk_bf16_f32 v130, v60, v61
    v_mfma_f32_32x32x16_bf16 v[24:39], v[116:119], v[188:191], v[24:39]
    v_cvt_pk_bf16_f32 v123, v46, v47
    v_cvt_pk_bf16_f32 v131, v62, v63
    v_mfma_f32_32x32x16_bf16 v[8:23], v[112:115], v[192:195], v[8:23]
    v_cvt_pk_bf16_f32 v124, v48, v49
    v_cvt_pk_bf16_f32 v132, v64, v65
    v_mfma_f32_32x32x16_bf16 v[24:39], v[104:107], v[200:203], v[24:39]
    v_cvt_pk_bf16_f32 v125, v50, v51
    v_cvt_pk_bf16_f32 v133, v66, v67
    v_mfma_f32_32x32x16_bf16 v[8:23], v[116:119], v[196:199], v[8:23]
    v_cvt_pk_bf16_f32 v126, v52, v53
    v_cvt_pk_bf16_f32 v134, v68, v69
    v_mfma_f32_32x32x16_bf16 v[24:39], v[108:111], v[204:207], v[24:39]
    v_cvt_pk_bf16_f32 v127, v54, v55
    v_cvt_pk_bf16_f32 v135, v70, v71
    v_mfma_f32_32x32x16_bf16 v[40:55], v[120:123], v[184:187], 0
    v_cvt_pk_bf16_f32 v136, v72, v73
    v_cvt_pk_bf16_f32 v144, v88, v89
    v_cvt_pk_bf16_f32 v137, v74, v75
    v_cvt_pk_bf16_f32 v145, v90, v91
    v_cvt_pk_bf16_f32 v138, v76, v77
    v_cvt_pk_bf16_f32 v146, v92, v93
    v_mfma_f32_32x32x16_bf16 v[56:71], v[128:131], v[184:187], 0
    v_cvt_pk_bf16_f32 v139, v78, v79
    v_cvt_pk_bf16_f32 v147, v94, v95
    v_cvt_pk_bf16_f32 v140, v80, v81
    v_cvt_pk_bf16_f32 v148, v96, v97
    v_cvt_pk_bf16_f32 v141, v82, v83
    v_cvt_pk_bf16_f32 v149, v98, v99
    v_mfma_f32_32x32x16_bf16 v[40:55], v[124:127], v[188:191], v[40:55]
    v_cvt_pk_bf16_f32 v142, v84, v85
    v_cvt_pk_bf16_f32 v150, v100, v101
    v_cvt_pk_bf16_f32 v143, v86, v87
    v_cvt_pk_bf16_f32 v151, v102, v103
    v_cvt_pk_bf16_f32 v8, v8, v24
    ds_write_b32 v161, v8 offset:0
    v_mfma_f32_32x32x16_bf16 v[56:71], v[132:135], v[188:191], v[56:71]
    v_cvt_pk_bf16_f32 v9, v9, v25
    ds_write_b32 v161, v9 offset:16
    v_cvt_pk_bf16_f32 v10, v10, v26
    ds_write_b32 v161, v10 offset:32
    v_cvt_pk_bf16_f32 v11, v11, v27
    ds_write_b32 v161, v11 offset:48
    v_mfma_f32_32x32x16_bf16 v[40:55], v[128:131], v[192:195], v[40:55]
    v_cvt_pk_bf16_f32 v12, v12, v28
    ds_write_b32 v161, v12 offset:128
    v_cvt_pk_bf16_f32 v13, v13, v29
    ds_write_b32 v161, v13 offset:144
    v_cvt_pk_bf16_f32 v14, v14, v30
    ds_write_b32 v161, v14 offset:160
    v_mfma_f32_32x32x16_bf16 v[56:71], v[120:123], v[200:203], v[56:71]
    v_cvt_pk_bf16_f32 v15, v15, v31
    ds_write_b32 v161, v15 offset:176
    v_cvt_pk_bf16_f32 v16, v16, v32
    ds_write_b32 v161, v16 offset:256
    v_cvt_pk_bf16_f32 v17, v17, v33
    ds_write_b32 v161, v17 offset:272
    v_mfma_f32_32x32x16_bf16 v[40:55], v[132:135], v[196:199], v[40:55]
    v_cvt_pk_bf16_f32 v18, v18, v34
    ds_write_b32 v161, v18 offset:288
    v_cvt_pk_bf16_f32 v19, v19, v35
    ds_write_b32 v161, v19 offset:304
    v_cvt_pk_bf16_f32 v20, v20, v36
    ds_write_b32 v161, v20 offset:384
    v_mfma_f32_32x32x16_bf16 v[56:71], v[124:127], v[204:207], v[56:71]
    v_cvt_pk_bf16_f32 v21, v21, v37
    ds_write_b32 v161, v21 offset:400
    v_cvt_pk_bf16_f32 v22, v22, v38
    ds_write_b32 v161, v22 offset:416
    v_cvt_pk_bf16_f32 v23, v23, v39
    ds_write_b32 v161, v23 offset:432
    s_waitcnt lgkmcnt(0)
    s_barrier
    v_mfma_f32_32x32x16_bf16 v[72:87], v[136:139], v[184:187], 0
    s_nop 3
    v_cvt_pk_bf16_f32 v40, v40, v56
    ds_write_b32 v161, v40 offset:512
    v_cvt_pk_bf16_f32 v41, v41, v57
    ds_write_b32 v161, v41 offset:528
    v_mfma_f32_32x32x16_bf16 v[88:103], v[144:147], v[184:187], 0
    v_cvt_pk_bf16_f32 v42, v42, v58
    ds_write_b32 v161, v42 offset:544
    v_cvt_pk_bf16_f32 v43, v43, v59
    ds_write_b32 v161, v43 offset:560
    v_cvt_pk_bf16_f32 v44, v44, v60
    v_mfma_f32_32x32x16_bf16 v[72:87], v[140:143], v[188:191], v[72:87]
    ds_write_b32 v161, v44 offset:640
    v_cvt_pk_bf16_f32 v45, v45, v61
    ds_write_b32 v161, v45 offset:656
    v_cvt_pk_bf16_f32 v46, v46, v62
    ds_write_b32 v161, v46 offset:672
    v_mfma_f32_32x32x16_bf16 v[88:103], v[148:151], v[188:191], v[88:103]
    v_cvt_pk_bf16_f32 v47, v47, v63
    ds_write_b32 v161, v47 offset:688
    v_cvt_pk_bf16_f32 v48, v48, v64
    ds_write_b32 v161, v48 offset:768
    v_cvt_pk_bf16_f32 v49, v49, v65
    v_mfma_f32_32x32x16_bf16 v[72:87], v[144:147], v[192:195], v[72:87]
    ds_write_b32 v161, v49 offset:784
    v_cvt_pk_bf16_f32 v50, v50, v66
    ds_write_b32 v161, v50 offset:800
    v_cvt_pk_bf16_f32 v51, v51, v67
    ds_write_b32 v161, v51 offset:816
    v_mfma_f32_32x32x16_bf16 v[88:103], v[136:139], v[200:203], v[88:103]
    v_cvt_pk_bf16_f32 v52, v52, v68
    ds_write_b32 v161, v52 offset:896
    v_cvt_pk_bf16_f32 v53, v53, v69
    ds_write_b32 v161, v53 offset:912
    v_cvt_pk_bf16_f32 v54, v54, v70
    v_mfma_f32_32x32x16_bf16 v[72:87], v[148:151], v[196:199], v[72:87]
    ds_write_b32 v161, v54 offset:928
    v_cvt_pk_bf16_f32 v55, v55, v71
    ds_write_b32 v161, v55 offset:944
    v_mfma_f32_32x32x16_bf16 v[88:103], v[140:143], v[204:207], v[88:103]
    s_waitcnt lgkmcnt(0)
    s_barrier
    s_nop 11
    v_cvt_pk_bf16_f32 v72, v72, v88
    ds_write_b32 v161, v72 offset:1024
    v_cvt_pk_bf16_f32 v73, v73, v89
    ds_write_b32 v161, v73 offset:1040
    v_cvt_pk_bf16_f32 v74, v74, v90
    ds_write_b32 v161, v74 offset:1056
    v_cvt_pk_bf16_f32 v75, v75, v91
    ds_write_b32 v161, v75 offset:1072
    v_cvt_pk_bf16_f32 v76, v76, v92
    ds_write_b32 v161, v76 offset:1152
    v_cvt_pk_bf16_f32 v77, v77, v93
    ds_write_b32 v161, v77 offset:1168
    v_cvt_pk_bf16_f32 v78, v78, v94
    ds_write_b32 v161, v78 offset:1184
    v_cvt_pk_bf16_f32 v79, v79, v95
    ds_write_b32 v161, v79 offset:1200
    v_cvt_pk_bf16_f32 v80, v80, v96
    ds_write_b32 v161, v80 offset:1280
    v_cvt_pk_bf16_f32 v81, v81, v97
    ds_write_b32 v161, v81 offset:1296
    v_cvt_pk_bf16_f32 v82, v82, v98
    ds_write_b32 v161, v82 offset:1312
    v_cvt_pk_bf16_f32 v83, v83, v99
    ds_write_b32 v161, v83 offset:1328
    v_cvt_pk_bf16_f32 v84, v84, v100
    ds_write_b32 v161, v84 offset:1408
    v_cvt_pk_bf16_f32 v85, v85, v101
    ds_write_b32 v161, v85 offset:1424
    v_cvt_pk_bf16_f32 v86, v86, v102
    ds_write_b32 v161, v86 offset:1440
    v_cvt_pk_bf16_f32 v87, v87, v103
    ds_write_b32 v161, v87 offset:1456
    s_waitcnt lgkmcnt(0)
    s_barrier
    s_setprio 0
    s_waitcnt vmcnt(0)
    s_barrier
    s_branch L_p2_mfma
L_dc_end:
L_ffn_cons:
    s_mov_b32 s6, 0x280000
    s_mov_b32 s7, 0x20000
    s_mov_b32 s23, 0x20000
    s_waitcnt lgkmcnt(0)
    s_mov_b32 s4, s28
    s_mov_b32 s5, s29
    s_load_dwordx2 s[12:13], s[46:47], 0x18000
    s_lshr_b32 s51, s50, 2
    s_lshr_b32 s53, s49, 1
    s_lshl_b32 s53, s53, 3
    s_add_u32 s51, s51, s53
    s_and_b32 s52, s50, 3
    s_and_b32 s53, s49, 1
    s_lshl_b32 s53, s53, 2
    s_add_u32 s52, s52, s53
    s_mov_b32 s10, 0xc00000
    s_mov_b32 s11, 0x20000
    s_mov_b32 s18, 0x280000
    s_mov_b32 s19, 0x20000
    s_mov_b32 s8, s46
    s_mov_b32 s9, s47
    s_mov_b32 s16, s42
    s_mov_b32 s17, s43
    s_sub_u32 s56, s48, 4
    s_mul_i32 s57, s49, 24
    s_add_u32 s57, s57, s50
    s_and_b32 s58, s57, 1
    s_add_u32 s58, s58, 2
    s_cmp_lt_u32 s56, s58
    s_cselect_b32 s79, 1, 0
    s_cbranch_scc0 L_fc_nu
    s_mul_i32 s57, s57, 5
    s_lshr_b32 s57, s57, 1
    s_add_u32 s57, s57, s56
    s_mul_i32 s70, s57, 52429
    s_lshr_b32 s70, s70, 19
    s_mul_i32 s53, s70, 10
    s_sub_u32 s71, s57, s53
    s_mul_i32 s68, s70, 40960
    s_lshl_b32 s53, s71, 7
    s_add_u32 s68, s68, s53
    s_mov_b32 s72, s40
    s_mov_b32 s73, s41
    s_mov_b32 s74, 0x1e0000
    s_mov_b32 s75, 0x20000
    v_lshrrev_b32 v12, 3, v0
    v_bfe_u32 v13, v0, 4, 1
    v_bfe_u32 v14, v0, 1, 2
    v_xor_b32 v14, v14, v13
    v_and_b32 v13, 1, v0
    v_lshlrev_b32 v13, 4, v13
    v_lshl_add_u32 v14, v14, 5, v13
    v_mul_u32_u24 v12, 1280, v12
    v_add_u32 v8, v12, v14
    v_xor_b32 v14, 64, v14
    v_add_u32 v9, v12, v14
    v_add_u32 v9, 10240, v9
    v_add_u32 v10, 20480, v8
    v_add_u32 v11, 20480, v9
    s_lshl_b32 s67, s56, 12
    s_add_u32 s67, s67, 151552
L_fc_nu:
    s_barrier
    s_cmp_eq_u32 s79, 0
    s_cbranch_scc1 L_fc_nu2
    s_add_u32 m0, s67, 0
    s_nop 0
    buffer_load_dwordx4 v8, s[72:75], s68 offen nt lds
    s_add_u32 m0, s67, 1024
    s_nop 0
    buffer_load_dwordx4 v9, s[72:75], s68 offen nt lds
    s_add_u32 m0, s67, 2048
    s_nop 0
    buffer_load_dwordx4 v10, s[72:75], s68 offen nt lds
    s_add_u32 m0, s67, 3072
    s_nop 0
    buffer_load_dwordx4 v11, s[72:75], s68 offen nt lds
L_fc_nu2:
    s_cmp_eq_u32 s56, 0
    s_cbranch_scc0 L_fc_n0
    s_bitcmp0_b32 s49, 0
    s_cselect_b32 s24, s36, s38
    s_cselect_b32 s25, s37, s39
    s_mov_b32 s26, 0x1e0000
    s_mov_b32 s27, 0x20000
    s_mul_i32 s53, s50, 32
    v_min_u32 v1, 31, v0
    v_add_u32 v1, s53, v1
    v_mul_u32_u24 v254, 10923, v1
    v_lshrrev_b32 v254, 16, v254
    v_mul_u32_u24 v254, 2304, v254
    v_lshl_add_u32 v1, v1, 7, v254
    s_lshr_b32 s53, s49, 1
    s_mul_i32 s53, s53, 768
    s_add_u32 s53, s53, 196608
    buffer_load_dword v255, v1, s[24:27], s53 offen
L_fc_n0:
    s_cmp_eq_u32 s56, 1
    s_cbranch_scc0 L_fc_n1
    s_bitcmp0_b32 s49, 0
    s_cselect_b32 s24, s36, s38
    s_cselect_b32 s25, s37, s39
    s_mov_b32 s26, 0x1e0000
    s_mov_b32 s27, 0x20000
    s_mul_i32 s53, s50, 32
    v_min_u32 v1, 31, v0
    v_add_u32 v1, s53, v1
    v_mul_u32_u24 v254, 10923, v1
    v_lshrrev_b32 v254, 16, v254
    v_mul_u32_u24 v254, 2304, v254
    v_lshl_add_u32 v1, v1, 7, v254
    s_lshr_b32 s53, s49, 1
    s_mul_i32 s53, s53, 768
    s_add_u32 s53, s53, 1179648
    buffer_load_dword v255, v1, s[24:27], s53 offen
L_fc_n1:
    s_cmp_eq_u32 s56, 2
    s_cbranch_scc0 L_fc_n2
    s_bitcmp0_b32 s49, 0
    s_cselect_b32 s24, s36, s38
    s_cselect_b32 s25, s37, s39
    s_mov_b32 s26, 0x1e0000
    s_mov_b32 s27, 0x20000
    s_mul_i32 s53, s50, 32
    v_min_u32 v1, 31, v0
    v_add_u32 v1, s53, v1
    v_mul_u32_u24 v254, 10923, v1
    v_lshrrev_b32 v254, 16, v254
    v_mul_u32_u24 v254, 2304, v254
    v_lshl_add_u32 v1, v1, 7, v254
    s_lshr_b32 s53, s49, 1
    s_mul_i32 s53, s53, 768
    s_add_u32 s53, s53, 589824
    buffer_load_dword v255, v1, s[24:27], s53 offen
L_fc_n2:
    s_cmp_eq_u32 s56, 3
    s_cbranch_scc0 L_fc_n3
    s_bitcmp0_b32 s49, 0
    s_cselect_b32 s24, s36, s38
    s_cselect_b32 s25, s37, s39
    s_mov_b32 s26, 0x1e0000
    s_mov_b32 s27, 0x20000
    s_mul_i32 s53, s50, 32
    v_min_u32 v1, 31, v0
    v_add_u32 v1, s53, v1
    v_mul_u32_u24 v254, 10923, v1
    v_lshrrev_b32 v254, 16, v254
    v_mul_u32_u24 v254, 2304, v254
    v_lshl_add_u32 v1, v1, 7, v254
    s_lshr_b32 s53, s49, 1
    s_mul_i32 s53, s53, 768
    s_add_u32 s53, s53, 1572864
    buffer_load_dword v255, v1, s[24:27], s53 offen
L_fc_n3:
    s_setprio 1
    v_lshrrev_b32 v6, 4, v0
    v_bfe_u32 v7, v0, 2, 2
    v_lshl_add_u32 v8, v6, 3, v7
    v_lshlrev_b32 v8, 7, v8
    v_and_b32 v9, 3, v0
    v_lshl_add_u32 v8, v9, 3, v8
    v_bfe_u32 v9, v0, 3, 1
    v_bfe_u32 v10, v0, 4, 1
    v_lshl_add_u32 v9, v10, 1, v9
    s_and_b32 s57, s56, 1
    s_lshl_b32 s57, s57, 1
    v_xor_b32 v9, s57, v9
    v_lshl_add_u32 v8, v9, 5, v8
    s_lshr_b32 s57, s56, 1
    s_lshl_b32 s57, s57, 12
    v_add_u32 v2, s57, v8
    v_xor_b32 v3, 32, v2
    v_add_u32 v232, 49152, v2
    v_add_u32 v233, 49152, v3
    v_and_b32 v8, 15, v0
    v_lshrrev_b32 v9, 1, v8
    v_xor_b32 v9, v9, v6
    v_lshlrev_b32 v9, 4, v9
    v_lshl_add_u32 v9, v8, 7, v9
    v_add_u32 v4, 98304, v9
    v_xor_b32 v5, 64, v4
    v_lshlrev_b32 v234, 4, v8
    v_add_u32 v234, 147456, v234
    v_lshlrev_b32 v235, 4, v6
    s_lshl_b32 s57, s56, 7
    v_add_u32 v235, s57, v235
    v_add_u32 v235, 149504, v235
    v_lshlrev_b32 v236, 4, v0
    s_lshl_b32 s58, s54, 4
    s_add_u32 s58, s58, s55
    s_lshl_b32 s58, s58, 2
    s_add_u32 s58, s58, s56
    s_lshl_b32 s58, s58, 3
    v_mov_b32 v237, s58
    s_mul_i32 s57, s54, 393216
    s_lshl_b32 s58, s55, 2
    s_add_u32 s58, s58, s56
    s_lshl_b32 s58, s58, 10
    s_add_u32 s57, s57, s58
    s_add_u32 s57, s57, 0x5f4000
    s_waitcnt lgkmcnt(0)
    s_add_u32 s12, s12, 1
    s_add_u32 s13, s13, 1
    s_cmp_eq_u32 s79, 0
    s_cbranch_scc1 L_fc_nv
    v_lshrrev_b32 v16, 2, v0
    v_lshlrev_b32 v16, 7, v16
    v_and_b32 v1, 3, v0
    v_lshl_add_u32 v16, v1, 3, v16
    v_bfe_u32 v1, v0, 3, 1
    v_bfe_u32 v17, v0, 5, 1
    v_lshl_add_u32 v1, v17, 1, v1
    v_lshl_add_u32 v16, v1, 5, v16
    v_add_u32 v1, s67, v16
    v_xor_b32 v6, 32, v1
    v_xor_b32 v7, 64, v1
    v_xor_b32 v254, 96, v1
    s_lshl_b32 s63, s71, 2
    s_add_u32 s63, s63, 0
    s_mul_i32 s64, s63, 52
    s_lshr_b32 s64, s64, 8
    s_mul_i32 s65, s64, 5
    s_sub_u32 s65, s63, s65
    s_lshl_b32 s65, s65, 10
    s_mul_i32 s64, s64, 245760
    s_add_u32 s65, s65, s64
    s_mul_i32 s64, s70, 5120
    s_add_u32 s65, s65, s64
    s_add_u32 s72, s65, 0x100000
    s_lshl_b32 s63, s71, 2
    s_add_u32 s63, s63, 1
    s_mul_i32 s64, s63, 52
    s_lshr_b32 s64, s64, 8
    s_mul_i32 s65, s64, 5
    s_sub_u32 s65, s63, s65
    s_lshl_b32 s65, s65, 10
    s_mul_i32 s64, s64, 245760
    s_add_u32 s65, s65, s64
    s_mul_i32 s64, s70, 5120
    s_add_u32 s65, s65, s64
    s_add_u32 s73, s65, 0x100000
    s_lshl_b32 s63, s71, 2
    s_add_u32 s63, s63, 2
    s_mul_i32 s64, s63, 52
    s_lshr_b32 s64, s64, 8
    s_mul_i32 s65, s64, 5
    s_sub_u32 s65, s63, s65
    s_lshl_b32 s65, s65, 10
    s_mul_i32 s64, s64, 245760
    s_add_u32 s65, s65, s64
    s_mul_i32 s64, s70, 5120
    s_add_u32 s65, s65, s64
    s_add_u32 s74, s65, 0x100000
    s_lshl_b32 s63, s71, 2
    s_add_u32 s63, s63, 3
    s_mul_i32 s64, s63, 52
    s_lshr_b32 s64, s64, 8
    s_mul_i32 s65, s64, 5
    s_sub_u32 s65, s63, s65
    s_lshl_b32 s65, s65, 10
    s_mul_i32 s64, s64, 245760
    s_add_u32 s65, s65, s64
    s_mul_i32 s64, s70, 5120
    s_add_u32 s65, s65, s64
    s_add_u32 s75, s65, 0x100000
L_fc_nv:
    s_barrier
    ds_read_b64_tr_b16 v[168:169], v2 offset:0
    ds_read_b64_tr_b16 v[170:171], v2 offset:512
    ds_read_b64_tr_b16 v[172:173], v3 offset:0
    ds_read_b64_tr_b16 v[174:175], v3 offset:512
    ds_read_b64_tr_b16 v[176:177], v2 offset:8192
    ds_read_b64_tr_b16 v[178:179], v2 offset:8704
    ds_read_b64_tr_b16 v[180:181], v3 offset:8192
    ds_read_b64_tr_b16 v[182:183], v3 offset:8704
    ds_read_b128 v[136:139], v4 offset:0
    ds_read_b128 v[140:143], v4 offset:2048
    ds_read_b128 v[144:147], v4 offset:4096
    ds_read_b128 v[148:151], v4 offset:6144
    ds_read_b128 v[152:155], v4 offset:8192
    ds_read_b128 v[156:159], v4 offset:10240
    ds_read_b128 v[160:163], v4 offset:12288
    ds_read_b128 v[164:167], v4 offset:14336
.p2align 3
    s_waitcnt lgkmcnt(0)
    s_barrier
    v_mfma_f32_16x16x32_bf16 v[8:11], v[168:171], v[136:139], 0
    ds_read_b64_tr_b16 v[216:217], v2 offset:16384
    v_mfma_f32_16x16x32_bf16 v[12:15], v[172:175], v[136:139], 0
    ds_read_b64_tr_b16 v[218:219], v2 offset:16896
    v_mfma_f32_16x16x32_bf16 v[16:19], v[176:179], v[136:139], 0
    ds_read_b64_tr_b16 v[220:221], v3 offset:16384
    v_mfma_f32_16x16x32_bf16 v[20:23], v[180:183], v[136:139], 0
    ds_read_b64_tr_b16 v[222:223], v3 offset:16896
    v_mfma_f32_16x16x32_bf16 v[24:27], v[168:171], v[140:143], 0
    ds_read_b64_tr_b16 v[224:225], v2 offset:24576
    v_mfma_f32_16x16x32_bf16 v[28:31], v[172:175], v[140:143], 0
    ds_read_b64_tr_b16 v[226:227], v2 offset:25088
    v_mfma_f32_16x16x32_bf16 v[32:35], v[176:179], v[140:143], 0
    ds_read_b64_tr_b16 v[228:229], v3 offset:24576
    v_mfma_f32_16x16x32_bf16 v[36:39], v[180:183], v[140:143], 0
    ds_read_b64_tr_b16 v[230:231], v3 offset:25088
    v_mfma_f32_16x16x32_bf16 v[40:43], v[168:171], v[144:147], 0
    ds_read_b128 v[184:187], v5 offset:0
    v_mfma_f32_16x16x32_bf16 v[44:47], v[172:175], v[144:147], 0
    ds_read_b128 v[188:191], v5 offset:2048
    v_mfma_f32_16x16x32_bf16 v[48:51], v[176:179], v[144:147], 0
    ds_read_b128 v[192:195], v5 offset:4096
    v_mfma_f32_16x16x32_bf16 v[52:55], v[180:183], v[144:147], 0
    ds_read_b128 v[196:199], v5 offset:6144
    v_mfma_f32_16x16x32_bf16 v[56:59], v[168:171], v[148:151], 0
    ds_read_b128 v[200:203], v5 offset:8192
    v_mfma_f32_16x16x32_bf16 v[60:63], v[172:175], v[148:151], 0
    ds_read_b128 v[204:207], v5 offset:10240
    v_mfma_f32_16x16x32_bf16 v[64:67], v[176:179], v[148:151], 0
    ds_read_b128 v[208:211], v5 offset:12288
    v_mfma_f32_16x16x32_bf16 v[68:71], v[180:183], v[148:151], 0
    ds_read_b128 v[212:215], v5 offset:14336
    v_mfma_f32_16x16x32_bf16 v[72:75], v[168:171], v[152:155], 0
    v_mfma_f32_16x16x32_bf16 v[76:79], v[172:175], v[152:155], 0
    v_mfma_f32_16x16x32_bf16 v[80:83], v[176:179], v[152:155], 0
    v_mfma_f32_16x16x32_bf16 v[84:87], v[180:183], v[152:155], 0
    v_mfma_f32_16x16x32_bf16 v[88:91], v[168:171], v[156:159], 0
    v_mfma_f32_16x16x32_bf16 v[92:95], v[172:175], v[156:159], 0
    v_mfma_f32_16x16x32_bf16 v[96:99], v[176:179], v[156:159], 0
    v_mfma_f32_16x16x32_bf16 v[100:103], v[180:183], v[156:159], 0
    v_mfma_f32_16x16x32_bf16 v[104:107], v[168:171], v[160:163], 0
    v_mfma_f32_16x16x32_bf16 v[108:111], v[172:175], v[160:163], 0
    v_mfma_f32_16x16x32_bf16 v[112:115], v[176:179], v[160:163], 0
    v_mfma_f32_16x16x32_bf16 v[116:119], v[180:183], v[160:163], 0
    v_mfma_f32_16x16x32_bf16 v[120:123], v[168:171], v[164:167], 0
    v_mfma_f32_16x16x32_bf16 v[124:127], v[172:175], v[164:167], 0
    v_mfma_f32_16x16x32_bf16 v[128:131], v[176:179], v[164:167], 0
    v_mfma_f32_16x16x32_bf16 v[132:135], v[180:183], v[164:167], 0
    s_waitcnt lgkmcnt(0)
    s_barrier
    s_cmp_eq_u32 s79, 0
    s_cbranch_scc1 L_fc_w1
    s_waitcnt vmcnt(0)
    ds_read_b64_tr_b16 v[238:239], v1 offset:0
    ds_read_b64_tr_b16 v[240:241], v1 offset:2048
    ds_read_b64_tr_b16 v[242:243], v6 offset:0
    ds_read_b64_tr_b16 v[244:245], v6 offset:2048
    ds_read_b64_tr_b16 v[246:247], v7 offset:0
    ds_read_b64_tr_b16 v[248:249], v7 offset:2048
    ds_read_b64_tr_b16 v[250:251], v254 offset:0
    ds_read_b64_tr_b16 v[252:253], v254 offset:2048
    v_bfe_u32 v255, v0, 1, 3
    v_and_b32 v6, 1, v0
    v_lshl_add_u32 v255, v6, 3, v255
    v_and_b32 v6, 48, v0
    v_add_lshl_u32 v255, v255, v6, 4
L_fc_w1:
    v_mfma_f32_16x16x32_bf16 v[8:11], v[216:219], v[184:187], v[8:11]
    ds_read_b64_tr_b16 v[168:169], v2 offset:32768
    v_mfma_f32_16x16x32_bf16 v[12:15], v[220:223], v[184:187], v[12:15]
    ds_read_b64_tr_b16 v[170:171], v2 offset:33280
    v_mfma_f32_16x16x32_bf16 v[16:19], v[224:227], v[184:187], v[16:19]
    ds_read_b64_tr_b16 v[172:173], v3 offset:32768
    v_mfma_f32_16x16x32_bf16 v[20:23], v[228:231], v[184:187], v[20:23]
    ds_read_b64_tr_b16 v[174:175], v3 offset:33280
    v_mfma_f32_16x16x32_bf16 v[24:27], v[216:219], v[188:191], v[24:27]
    ds_read_b64_tr_b16 v[176:177], v2 offset:40960
    v_mfma_f32_16x16x32_bf16 v[28:31], v[220:223], v[188:191], v[28:31]
    ds_read_b64_tr_b16 v[178:179], v2 offset:41472
    v_mfma_f32_16x16x32_bf16 v[32:35], v[224:227], v[188:191], v[32:35]
    ds_read_b64_tr_b16 v[180:181], v3 offset:40960
    v_mfma_f32_16x16x32_bf16 v[36:39], v[228:231], v[188:191], v[36:39]
    ds_read_b64_tr_b16 v[182:183], v3 offset:41472
    v_mfma_f32_16x16x32_bf16 v[40:43], v[216:219], v[192:195], v[40:43]
    ds_read_b128 v[136:139], v4 offset:16384
    v_mfma_f32_16x16x32_bf16 v[44:47], v[220:223], v[192:195], v[44:47]
    ds_read_b128 v[140:143], v4 offset:18432
    v_mfma_f32_16x16x32_bf16 v[48:51], v[224:227], v[192:195], v[48:51]
    ds_read_b128 v[144:147], v4 offset:20480
    v_mfma_f32_16x16x32_bf16 v[52:55], v[228:231], v[192:195], v[52:55]
    ds_read_b128 v[148:151], v4 offset:22528
    v_mfma_f32_16x16x32_bf16 v[56:59], v[216:219], v[196:199], v[56:59]
    ds_read_b128 v[152:155], v4 offset:24576
    v_mfma_f32_16x16x32_bf16 v[60:63], v[220:223], v[196:199], v[60:63]
    ds_read_b128 v[156:159], v4 offset:26624
    v_mfma_f32_16x16x32_bf16 v[64:67], v[224:227], v[196:199], v[64:67]
    ds_read_b128 v[160:163], v4 offset:28672
    v_mfma_f32_16x16x32_bf16 v[68:71], v[228:231], v[196:199], v[68:71]
    ds_read_b128 v[164:167], v4 offset:30720
    v_mfma_f32_16x16x32_bf16 v[72:75], v[216:219], v[200:203], v[72:75]
    v_mfma_f32_16x16x32_bf16 v[76:79], v[220:223], v[200:203], v[76:79]
    v_mfma_f32_16x16x32_bf16 v[80:83], v[224:227], v[200:203], v[80:83]
    v_mfma_f32_16x16x32_bf16 v[84:87], v[228:231], v[200:203], v[84:87]
    v_mfma_f32_16x16x32_bf16 v[88:91], v[216:219], v[204:207], v[88:91]
    v_mfma_f32_16x16x32_bf16 v[92:95], v[220:223], v[204:207], v[92:95]
    v_mfma_f32_16x16x32_bf16 v[96:99], v[224:227], v[204:207], v[96:99]
    v_mfma_f32_16x16x32_bf16 v[100:103], v[228:231], v[204:207], v[100:103]
    v_mfma_f32_16x16x32_bf16 v[104:107], v[216:219], v[208:211], v[104:107]
    v_mfma_f32_16x16x32_bf16 v[108:111], v[220:223], v[208:211], v[108:111]
    v_mfma_f32_16x16x32_bf16 v[112:115], v[224:227], v[208:211], v[112:115]
    v_mfma_f32_16x16x32_bf16 v[116:119], v[228:231], v[208:211], v[116:119]
    v_mfma_f32_16x16x32_bf16 v[120:123], v[216:219], v[212:215], v[120:123]
    v_mfma_f32_16x16x32_bf16 v[124:127], v[220:223], v[212:215], v[124:127]
    v_mfma_f32_16x16x32_bf16 v[128:131], v[224:227], v[212:215], v[128:131]
    v_mfma_f32_16x16x32_bf16 v[132:135], v[228:231], v[212:215], v[132:135]
    s_waitcnt lgkmcnt(0)
    s_barrier
    s_cmp_eq_u32 s79, 0
    s_cbranch_scc1 L_fc_w2
    buffer_store_dwordx4 v[238:241], v255, s[8:11], s72 offen sc1
    buffer_store_dwordx4 v[242:245], v255, s[8:11], s73 offen sc1
    buffer_store_dwordx4 v[246:249], v255, s[8:11], s74 offen sc1
    buffer_store_dwordx4 v[250:253], v255, s[8:11], s75 offen sc1
L_fc_w2:
    v_mfma_f32_16x16x32_bf16 v[8:11], v[168:171], v[136:139], v[8:11]
    ds_read_b64_tr_b16 v[216:217], v232 offset:0
    v_mfma_f32_16x16x32_bf16 v[12:15], v[172:175], v[136:139], v[12:15]
    ds_read_b64_tr_b16 v[218:219], v232 offset:512
    v_mfma_f32_16x16x32_bf16 v[16:19], v[176:179], v[136:139], v[16:19]
    ds_read_b64_tr_b16 v[220:221], v233 offset:0
    v_mfma_f32_16x16x32_bf16 v[20:23], v[180:183], v[136:139], v[20:23]
    ds_read_b64_tr_b16 v[222:223], v233 offset:512
    v_mfma_f32_16x16x32_bf16 v[24:27], v[168:171], v[140:143], v[24:27]
    ds_read_b64_tr_b16 v[224:225], v232 offset:8192
    v_mfma_f32_16x16x32_bf16 v[28:31], v[172:175], v[140:143], v[28:31]
    ds_read_b64_tr_b16 v[226:227], v232 offset:8704
    v_mfma_f32_16x16x32_bf16 v[32:35], v[176:179], v[140:143], v[32:35]
    ds_read_b64_tr_b16 v[228:229], v233 offset:8192
    v_mfma_f32_16x16x32_bf16 v[36:39], v[180:183], v[140:143], v[36:39]
    ds_read_b64_tr_b16 v[230:231], v233 offset:8704
    v_mfma_f32_16x16x32_bf16 v[40:43], v[168:171], v[144:147], v[40:43]
    ds_read_b128 v[184:187], v5 offset:16384
    v_mfma_f32_16x16x32_bf16 v[44:47], v[172:175], v[144:147], v[44:47]
    ds_read_b128 v[188:191], v5 offset:18432
    v_mfma_f32_16x16x32_bf16 v[48:51], v[176:179], v[144:147], v[48:51]
    ds_read_b128 v[192:195], v5 offset:20480
    v_mfma_f32_16x16x32_bf16 v[52:55], v[180:183], v[144:147], v[52:55]
    ds_read_b128 v[196:199], v5 offset:22528
    v_mfma_f32_16x16x32_bf16 v[56:59], v[168:171], v[148:151], v[56:59]
    ds_read_b128 v[200:203], v5 offset:24576
    v_mfma_f32_16x16x32_bf16 v[60:63], v[172:175], v[148:151], v[60:63]
    ds_read_b128 v[204:207], v5 offset:26624
    v_mfma_f32_16x16x32_bf16 v[64:67], v[176:179], v[148:151], v[64:67]
    ds_read_b128 v[208:211], v5 offset:28672
    v_mfma_f32_16x16x32_bf16 v[68:71], v[180:183], v[148:151], v[68:71]
    ds_read_b128 v[212:215], v5 offset:30720
    v_mfma_f32_16x16x32_bf16 v[72:75], v[168:171], v[152:155], v[72:75]
    v_mfma_f32_16x16x32_bf16 v[76:79], v[172:175], v[152:155], v[76:79]
    v_mfma_f32_16x16x32_bf16 v[80:83], v[176:179], v[152:155], v[80:83]
    v_mfma_f32_16x16x32_bf16 v[84:87], v[180:183], v[152:155], v[84:87]
    v_mfma_f32_16x16x32_bf16 v[88:91], v[168:171], v[156:159], v[88:91]
    v_mfma_f32_16x16x32_bf16 v[92:95], v[172:175], v[156:159], v[92:95]
    v_mfma_f32_16x16x32_bf16 v[96:99], v[176:179], v[156:159], v[96:99]
    v_mfma_f32_16x16x32_bf16 v[100:103], v[180:183], v[156:159], v[100:103]
    v_mfma_f32_16x16x32_bf16 v[104:107], v[168:171], v[160:163], v[104:107]
    v_mfma_f32_16x16x32_bf16 v[108:111], v[172:175], v[160:163], v[108:111]
    v_mfma_f32_16x16x32_bf16 v[112:115], v[176:179], v[160:163], v[112:115]
    v_mfma_f32_16x16x32_bf16 v[116:119], v[180:183], v[160:163], v[116:119]
    v_mfma_f32_16x16x32_bf16 v[120:123], v[168:171], v[164:167], v[120:123]
    v_mfma_f32_16x16x32_bf16 v[124:127], v[172:175], v[164:167], v[124:127]
    v_mfma_f32_16x16x32_bf16 v[128:131], v[176:179], v[164:167], v[128:131]
    v_mfma_f32_16x16x32_bf16 v[132:135], v[180:183], v[164:167], v[132:135]
    s_waitcnt lgkmcnt(0)
    s_barrier
    v_mfma_f32_16x16x32_bf16 v[8:11], v[216:219], v[184:187], v[8:11]
    ds_read_b64_tr_b16 v[168:169], v232 offset:16384
    v_mfma_f32_16x16x32_bf16 v[12:15], v[220:223], v[184:187], v[12:15]
    ds_read_b64_tr_b16 v[170:171], v232 offset:16896
    v_mfma_f32_16x16x32_bf16 v[16:19], v[224:227], v[184:187], v[16:19]
    ds_read_b64_tr_b16 v[172:173], v233 offset:16384
    v_mfma_f32_16x16x32_bf16 v[20:23], v[228:231], v[184:187], v[20:23]
    ds_read_b64_tr_b16 v[174:175], v233 offset:16896
    v_mfma_f32_16x16x32_bf16 v[24:27], v[216:219], v[188:191], v[24:27]
    ds_read_b64_tr_b16 v[176:177], v232 offset:24576
    v_mfma_f32_16x16x32_bf16 v[28:31], v[220:223], v[188:191], v[28:31]
    ds_read_b64_tr_b16 v[178:179], v232 offset:25088
    v_mfma_f32_16x16x32_bf16 v[32:35], v[224:227], v[188:191], v[32:35]
    ds_read_b64_tr_b16 v[180:181], v233 offset:24576
    v_mfma_f32_16x16x32_bf16 v[36:39], v[228:231], v[188:191], v[36:39]
    ds_read_b64_tr_b16 v[182:183], v233 offset:25088
    v_mfma_f32_16x16x32_bf16 v[40:43], v[216:219], v[192:195], v[40:43]
    ds_read_b128 v[136:139], v4 offset:32768
    v_mfma_f32_16x16x32_bf16 v[44:47], v[220:223], v[192:195], v[44:47]
    ds_read_b128 v[140:143], v4 offset:34816
    v_mfma_f32_16x16x32_bf16 v[48:51], v[224:227], v[192:195], v[48:51]
    ds_read_b128 v[144:147], v4 offset:36864
    v_mfma_f32_16x16x32_bf16 v[52:55], v[228:231], v[192:195], v[52:55]
    ds_read_b128 v[148:151], v4 offset:38912
    v_mfma_f32_16x16x32_bf16 v[56:59], v[216:219], v[196:199], v[56:59]
    ds_read_b128 v[152:155], v4 offset:40960
    v_mfma_f32_16x16x32_bf16 v[60:63], v[220:223], v[196:199], v[60:63]
    ds_read_b128 v[156:159], v4 offset:43008
    v_mfma_f32_16x16x32_bf16 v[64:67], v[224:227], v[196:199], v[64:67]
    ds_read_b128 v[160:163], v4 offset:45056
    v_mfma_f32_16x16x32_bf16 v[68:71], v[228:231], v[196:199], v[68:71]
    ds_read_b128 v[164:167], v4 offset:47104
    v_mfma_f32_16x16x32_bf16 v[72:75], v[216:219], v[200:203], v[72:75]
    v_mfma_f32_16x16x32_bf16 v[76:79], v[220:223], v[200:203], v[76:79]
    v_mfma_f32_16x16x32_bf16 v[80:83], v[224:227], v[200:203], v[80:83]
    v_mfma_f32_16x16x32_bf16 v[84:87], v[228:231], v[200:203], v[84:87]
    v_mfma_f32_16x16x32_bf16 v[88:91], v[216:219], v[204:207], v[88:91]
    v_mfma_f32_16x16x32_bf16 v[92:95], v[220:223], v[204:207], v[92:95]
    v_mfma_f32_16x16x32_bf16 v[96:99], v[224:227], v[204:207], v[96:99]
    v_mfma_f32_16x16x32_bf16 v[100:103], v[228:231], v[204:207], v[100:103]
    v_mfma_f32_16x16x32_bf16 v[104:107], v[216:219], v[208:211], v[104:107]
    v_mfma_f32_16x16x32_bf16 v[108:111], v[220:223], v[208:211], v[108:111]
    v_mfma_f32_16x16x32_bf16 v[112:115], v[224:227], v[208:211], v[112:115]
    v_mfma_f32_16x16x32_bf16 v[116:119], v[228:231], v[208:211], v[116:119]
    v_mfma_f32_16x16x32_bf16 v[120:123], v[216:219], v[212:215], v[120:123]
    v_mfma_f32_16x16x32_bf16 v[124:127], v[220:223], v[212:215], v[124:127]
    v_mfma_f32_16x16x32_bf16 v[128:131], v[224:227], v[212:215], v[128:131]
    v_mfma_f32_16x16x32_bf16 v[132:135], v[228:231], v[212:215], v[132:135]
    s_waitcnt lgkmcnt(0)
    s_barrier
    v_mfma_f32_16x16x32_bf16 v[8:11], v[168:171], v[136:139], v[8:11]
    ds_read_b64_tr_b16 v[216:217], v232 offset:32768
    v_mfma_f32_16x16x32_bf16 v[12:15], v[172:175], v[136:139], v[12:15]
    ds_read_b64_tr_b16 v[218:219], v232 offset:33280
    v_mfma_f32_16x16x32_bf16 v[16:19], v[176:179], v[136:139], v[16:19]
    ds_read_b64_tr_b16 v[220:221], v233 offset:32768
    v_mfma_f32_16x16x32_bf16 v[20:23], v[180:183], v[136:139], v[20:23]
    ds_read_b64_tr_b16 v[222:223], v233 offset:33280
    v_mfma_f32_16x16x32_bf16 v[24:27], v[168:171], v[140:143], v[24:27]
    ds_read_b64_tr_b16 v[224:225], v232 offset:40960
    v_mfma_f32_16x16x32_bf16 v[28:31], v[172:175], v[140:143], v[28:31]
    ds_read_b64_tr_b16 v[226:227], v232 offset:41472
    v_mfma_f32_16x16x32_bf16 v[32:35], v[176:179], v[140:143], v[32:35]
    ds_read_b64_tr_b16 v[228:229], v233 offset:40960
    v_mfma_f32_16x16x32_bf16 v[36:39], v[180:183], v[140:143], v[36:39]
    ds_read_b64_tr_b16 v[230:231], v233 offset:41472
    v_mfma_f32_16x16x32_bf16 v[40:43], v[168:171], v[144:147], v[40:43]
    ds_read_b128 v[184:187], v5 offset:32768
    v_mfma_f32_16x16x32_bf16 v[44:47], v[172:175], v[144:147], v[44:47]
    ds_read_b128 v[188:191], v5 offset:34816
    v_mfma_f32_16x16x32_bf16 v[48:51], v[176:179], v[144:147], v[48:51]
    ds_read_b128 v[192:195], v5 offset:36864
    v_mfma_f32_16x16x32_bf16 v[52:55], v[180:183], v[144:147], v[52:55]
    ds_read_b128 v[196:199], v5 offset:38912
    v_mfma_f32_16x16x32_bf16 v[56:59], v[168:171], v[148:151], v[56:59]
    ds_read_b128 v[200:203], v5 offset:40960
    v_mfma_f32_16x16x32_bf16 v[60:63], v[172:175], v[148:151], v[60:63]
    ds_read_b128 v[204:207], v5 offset:43008
    v_mfma_f32_16x16x32_bf16 v[64:67], v[176:179], v[148:151], v[64:67]
    ds_read_b128 v[208:211], v5 offset:45056
    v_mfma_f32_16x16x32_bf16 v[68:71], v[180:183], v[148:151], v[68:71]
    ds_read_b128 v[212:215], v5 offset:47104
    v_mfma_f32_16x16x32_bf16 v[72:75], v[168:171], v[152:155], v[72:75]
    v_mfma_f32_16x16x32_bf16 v[76:79], v[172:175], v[152:155], v[76:79]
    v_mfma_f32_16x16x32_bf16 v[80:83], v[176:179], v[152:155], v[80:83]
    v_mfma_f32_16x16x32_bf16 v[84:87], v[180:183], v[152:155], v[84:87]
    v_mfma_f32_16x16x32_bf16 v[88:91], v[168:171], v[156:159], v[88:91]
    v_mfma_f32_16x16x32_bf16 v[92:95], v[172:175], v[156:159], v[92:95]
    v_mfma_f32_16x16x32_bf16 v[96:99], v[176:179], v[156:159], v[96:99]
    v_mfma_f32_16x16x32_bf16 v[100:103], v[180:183], v[156:159], v[100:103]
    v_mfma_f32_16x16x32_bf16 v[104:107], v[168:171], v[160:163], v[104:107]
    v_mfma_f32_16x16x32_bf16 v[108:111], v[172:175], v[160:163], v[108:111]
    v_mfma_f32_16x16x32_bf16 v[112:115], v[176:179], v[160:163], v[112:115]
    v_mfma_f32_16x16x32_bf16 v[116:119], v[180:183], v[160:163], v[116:119]
    v_mfma_f32_16x16x32_bf16 v[120:123], v[168:171], v[164:167], v[120:123]
    v_mfma_f32_16x16x32_bf16 v[124:127], v[172:175], v[164:167], v[124:127]
    v_mfma_f32_16x16x32_bf16 v[128:131], v[176:179], v[164:167], v[128:131]
    v_mfma_f32_16x16x32_bf16 v[132:135], v[180:183], v[164:167], v[132:135]
    s_waitcnt vmcnt(0) lgkmcnt(0)
    s_barrier
    v_mfma_f32_16x16x32_bf16 v[8:11], v[216:219], v[184:187], v[8:11]
    ds_read_b64_tr_b16 v[168:169], v2 offset:0
    v_mfma_f32_16x16x32_bf16 v[12:15], v[220:223], v[184:187], v[12:15]
    ds_read_b64_tr_b16 v[170:171], v2 offset:512
    v_mfma_f32_16x16x32_bf16 v[16:19], v[224:227], v[184:187], v[16:19]
    ds_read_b64_tr_b16 v[172:173], v3 offset:0
    v_mfma_f32_16x16x32_bf16 v[20:23], v[228:231], v[184:187], v[20:23]
    ds_read_b64_tr_b16 v[174:175], v3 offset:512
    v_mfma_f32_16x16x32_bf16 v[24:27], v[216:219], v[188:191], v[24:27]
    ds_read_b64_tr_b16 v[176:177], v2 offset:8192
    v_mfma_f32_16x16x32_bf16 v[28:31], v[220:223], v[188:191], v[28:31]
    ds_read_b64_tr_b16 v[178:179], v2 offset:8704
    v_mfma_f32_16x16x32_bf16 v[32:35], v[224:227], v[188:191], v[32:35]
    ds_read_b64_tr_b16 v[180:181], v3 offset:8192
    v_mfma_f32_16x16x32_bf16 v[36:39], v[228:231], v[188:191], v[36:39]
    ds_read_b64_tr_b16 v[182:183], v3 offset:8704
    v_mfma_f32_16x16x32_bf16 v[40:43], v[216:219], v[192:195], v[40:43]
    ds_read_b128 v[136:139], v4 offset:0
    v_mfma_f32_16x16x32_bf16 v[44:47], v[220:223], v[192:195], v[44:47]
    ds_read_b128 v[140:143], v4 offset:2048
    v_mfma_f32_16x16x32_bf16 v[48:51], v[224:227], v[192:195], v[48:51]
    ds_read_b128 v[144:147], v4 offset:4096
    v_mfma_f32_16x16x32_bf16 v[52:55], v[228:231], v[192:195], v[52:55]
    ds_read_b128 v[148:151], v4 offset:6144
    v_mfma_f32_16x16x32_bf16 v[56:59], v[216:219], v[196:199], v[56:59]
    ds_read_b128 v[152:155], v4 offset:8192
    v_mfma_f32_16x16x32_bf16 v[60:63], v[220:223], v[196:199], v[60:63]
    ds_read_b128 v[156:159], v4 offset:10240
    v_mfma_f32_16x16x32_bf16 v[64:67], v[224:227], v[196:199], v[64:67]
    ds_read_b128 v[160:163], v4 offset:12288
    v_mfma_f32_16x16x32_bf16 v[68:71], v[228:231], v[196:199], v[68:71]
    ds_read_b128 v[164:167], v4 offset:14336
    v_mfma_f32_16x16x32_bf16 v[72:75], v[216:219], v[200:203], v[72:75]
    v_mfma_f32_16x16x32_bf16 v[76:79], v[220:223], v[200:203], v[76:79]
    v_mfma_f32_16x16x32_bf16 v[80:83], v[224:227], v[200:203], v[80:83]
    v_mfma_f32_16x16x32_bf16 v[84:87], v[228:231], v[200:203], v[84:87]
    v_mfma_f32_16x16x32_bf16 v[88:91], v[216:219], v[204:207], v[88:91]
    v_mfma_f32_16x16x32_bf16 v[92:95], v[220:223], v[204:207], v[92:95]
    v_mfma_f32_16x16x32_bf16 v[96:99], v[224:227], v[204:207], v[96:99]
    v_mfma_f32_16x16x32_bf16 v[100:103], v[228:231], v[204:207], v[100:103]
    v_mfma_f32_16x16x32_bf16 v[104:107], v[216:219], v[208:211], v[104:107]
    v_mfma_f32_16x16x32_bf16 v[108:111], v[220:223], v[208:211], v[108:111]
    v_mfma_f32_16x16x32_bf16 v[112:115], v[224:227], v[208:211], v[112:115]
    v_mfma_f32_16x16x32_bf16 v[116:119], v[228:231], v[208:211], v[116:119]
    v_mfma_f32_16x16x32_bf16 v[120:123], v[216:219], v[212:215], v[120:123]
    v_mfma_f32_16x16x32_bf16 v[124:127], v[220:223], v[212:215], v[124:127]
    v_mfma_f32_16x16x32_bf16 v[128:131], v[224:227], v[212:215], v[128:131]
    v_mfma_f32_16x16x32_bf16 v[132:135], v[228:231], v[212:215], v[132:135]
    s_waitcnt lgkmcnt(0)
    s_barrier
    v_mfma_f32_16x16x32_bf16 v[8:11], v[168:171], v[136:139], v[8:11]
    ds_read_b64_tr_b16 v[216:217], v2 offset:16384
    v_mfma_f32_16x16x32_bf16 v[12:15], v[172:175], v[136:139], v[12:15]
    ds_read_b64_tr_b16 v[218:219], v2 offset:16896
    v_mfma_f32_16x16x32_bf16 v[16:19], v[176:179], v[136:139], v[16:19]
    ds_read_b64_tr_b16 v[220:221], v3 offset:16384
    v_mfma_f32_16x16x32_bf16 v[20:23], v[180:183], v[136:139], v[20:23]
    ds_read_b64_tr_b16 v[222:223], v3 offset:16896
    v_mfma_f32_16x16x32_bf16 v[24:27], v[168:171], v[140:143], v[24:27]
    ds_read_b64_tr_b16 v[224:225], v2 offset:24576
    v_mfma_f32_16x16x32_bf16 v[28:31], v[172:175], v[140:143], v[28:31]
    ds_read_b64_tr_b16 v[226:227], v2 offset:25088
    v_mfma_f32_16x16x32_bf16 v[32:35], v[176:179], v[140:143], v[32:35]
    ds_read_b64_tr_b16 v[228:229], v3 offset:24576
    v_mfma_f32_16x16x32_bf16 v[36:39], v[180:183], v[140:143], v[36:39]
    ds_read_b64_tr_b16 v[230:231], v3 offset:25088
    v_mfma_f32_16x16x32_bf16 v[40:43], v[168:171], v[144:147], v[40:43]
    ds_read_b128 v[184:187], v5 offset:0
    v_mfma_f32_16x16x32_bf16 v[44:47], v[172:175], v[144:147], v[44:47]
    ds_read_b128 v[188:191], v5 offset:2048
    v_mfma_f32_16x16x32_bf16 v[48:51], v[176:179], v[144:147], v[48:51]
    ds_read_b128 v[192:195], v5 offset:4096
    v_mfma_f32_16x16x32_bf16 v[52:55], v[180:183], v[144:147], v[52:55]
    ds_read_b128 v[196:199], v5 offset:6144
    v_mfma_f32_16x16x32_bf16 v[56:59], v[168:171], v[148:151], v[56:59]
    ds_read_b128 v[200:203], v5 offset:8192
    v_mfma_f32_16x16x32_bf16 v[60:63], v[172:175], v[148:151], v[60:63]
    ds_read_b128 v[204:207], v5 offset:10240
    v_mfma_f32_16x16x32_bf16 v[64:67], v[176:179], v[148:151], v[64:67]
    ds_read_b128 v[208:211], v5 offset:12288
    v_mfma_f32_16x16x32_bf16 v[68:71], v[180:183], v[148:151], v[68:71]
    ds_read_b128 v[212:215], v5 offset:14336
    v_mfma_f32_16x16x32_bf16 v[72:75], v[168:171], v[152:155], v[72:75]
    v_mfma_f32_16x16x32_bf16 v[76:79], v[172:175], v[152:155], v[76:79]
    v_mfma_f32_16x16x32_bf16 v[80:83], v[176:179], v[152:155], v[80:83]
    v_mfma_f32_16x16x32_bf16 v[84:87], v[180:183], v[152:155], v[84:87]
    v_mfma_f32_16x16x32_bf16 v[88:91], v[168:171], v[156:159], v[88:91]
    v_mfma_f32_16x16x32_bf16 v[92:95], v[172:175], v[156:159], v[92:95]
    v_mfma_f32_16x16x32_bf16 v[96:99], v[176:179], v[156:159], v[96:99]
    v_mfma_f32_16x16x32_bf16 v[100:103], v[180:183], v[156:159], v[100:103]
    v_mfma_f32_16x16x32_bf16 v[104:107], v[168:171], v[160:163], v[104:107]
    v_mfma_f32_16x16x32_bf16 v[108:111], v[172:175], v[160:163], v[108:111]
    v_mfma_f32_16x16x32_bf16 v[112:115], v[176:179], v[160:163], v[112:115]
    v_mfma_f32_16x16x32_bf16 v[116:119], v[180:183], v[160:163], v[116:119]
    v_mfma_f32_16x16x32_bf16 v[120:123], v[168:171], v[164:167], v[120:123]
    v_mfma_f32_16x16x32_bf16 v[124:127], v[172:175], v[164:167], v[124:127]
    v_mfma_f32_16x16x32_bf16 v[128:131], v[176:179], v[164:167], v[128:131]
    v_mfma_f32_16x16x32_bf16 v[132:135], v[180:183], v[164:167], v[132:135]
    s_waitcnt lgkmcnt(0)
    s_barrier
    v_mfma_f32_16x16x32_bf16 v[8:11], v[216:219], v[184:187], v[8:11]
    ds_read_b64_tr_b16 v[168:169], v2 offset:32768
    v_mfma_f32_16x16x32_bf16 v[12:15], v[220:223], v[184:187], v[12:15]
    ds_read_b64_tr_b16 v[170:171], v2 offset:33280
    v_mfma_f32_16x16x32_bf16 v[16:19], v[224:227], v[184:187], v[16:19]
    ds_read_b64_tr_b16 v[172:173], v3 offset:32768
    v_mfma_f32_16x16x32_bf16 v[20:23], v[228:231], v[184:187], v[20:23]
    ds_read_b64_tr_b16 v[174:175], v3 offset:33280
    v_mfma_f32_16x16x32_bf16 v[24:27], v[216:219], v[188:191], v[24:27]
    ds_read_b64_tr_b16 v[176:177], v2 offset:40960
    v_mfma_f32_16x16x32_bf16 v[28:31], v[220:223], v[188:191], v[28:31]
    ds_read_b64_tr_b16 v[178:179], v2 offset:41472
    v_mfma_f32_16x16x32_bf16 v[32:35], v[224:227], v[188:191], v[32:35]
    ds_read_b64_tr_b16 v[180:181], v3 offset:40960
    v_mfma_f32_16x16x32_bf16 v[36:39], v[228:231], v[188:191], v[36:39]
    ds_read_b64_tr_b16 v[182:183], v3 offset:41472
    v_mfma_f32_16x16x32_bf16 v[40:43], v[216:219], v[192:195], v[40:43]
    ds_read_b128 v[136:139], v4 offset:16384
    v_mfma_f32_16x16x32_bf16 v[44:47], v[220:223], v[192:195], v[44:47]
    ds_read_b128 v[140:143], v4 offset:18432
    v_mfma_f32_16x16x32_bf16 v[48:51], v[224:227], v[192:195], v[48:51]
    ds_read_b128 v[144:147], v4 offset:20480
    v_mfma_f32_16x16x32_bf16 v[52:55], v[228:231], v[192:195], v[52:55]
    ds_read_b128 v[148:151], v4 offset:22528
    v_mfma_f32_16x16x32_bf16 v[56:59], v[216:219], v[196:199], v[56:59]
    ds_read_b128 v[152:155], v4 offset:24576
    v_mfma_f32_16x16x32_bf16 v[60:63], v[220:223], v[196:199], v[60:63]
    ds_read_b128 v[156:159], v4 offset:26624
    v_mfma_f32_16x16x32_bf16 v[64:67], v[224:227], v[196:199], v[64:67]
    ds_read_b128 v[160:163], v4 offset:28672
    v_mfma_f32_16x16x32_bf16 v[68:71], v[228:231], v[196:199], v[68:71]
    ds_read_b128 v[164:167], v4 offset:30720
    v_mfma_f32_16x16x32_bf16 v[72:75], v[216:219], v[200:203], v[72:75]
    v_mfma_f32_16x16x32_bf16 v[76:79], v[220:223], v[200:203], v[76:79]
    v_mfma_f32_16x16x32_bf16 v[80:83], v[224:227], v[200:203], v[80:83]
    v_mfma_f32_16x16x32_bf16 v[84:87], v[228:231], v[200:203], v[84:87]
    v_mfma_f32_16x16x32_bf16 v[88:91], v[216:219], v[204:207], v[88:91]
    v_mfma_f32_16x16x32_bf16 v[92:95], v[220:223], v[204:207], v[92:95]
    v_mfma_f32_16x16x32_bf16 v[96:99], v[224:227], v[204:207], v[96:99]
    v_mfma_f32_16x16x32_bf16 v[100:103], v[228:231], v[204:207], v[100:103]
    v_mfma_f32_16x16x32_bf16 v[104:107], v[216:219], v[208:211], v[104:107]
    v_mfma_f32_16x16x32_bf16 v[108:111], v[220:223], v[208:211], v[108:111]
    v_mfma_f32_16x16x32_bf16 v[112:115], v[224:227], v[208:211], v[112:115]
    v_mfma_f32_16x16x32_bf16 v[116:119], v[228:231], v[208:211], v[116:119]
    v_mfma_f32_16x16x32_bf16 v[120:123], v[216:219], v[212:215], v[120:123]
    v_mfma_f32_16x16x32_bf16 v[124:127], v[220:223], v[212:215], v[124:127]
    v_mfma_f32_16x16x32_bf16 v[128:131], v[224:227], v[212:215], v[128:131]
    v_mfma_f32_16x16x32_bf16 v[132:135], v[228:231], v[212:215], v[132:135]
    s_waitcnt lgkmcnt(0)
    s_barrier
    v_mfma_f32_16x16x32_bf16 v[8:11], v[168:171], v[136:139], v[8:11]
    ds_read_b64_tr_b16 v[216:217], v232 offset:0
    v_mfma_f32_16x16x32_bf16 v[12:15], v[172:175], v[136:139], v[12:15]
    ds_read_b64_tr_b16 v[218:219], v232 offset:512
    v_mfma_f32_16x16x32_bf16 v[16:19], v[176:179], v[136:139], v[16:19]
    ds_read_b64_tr_b16 v[220:221], v233 offset:0
    v_mfma_f32_16x16x32_bf16 v[20:23], v[180:183], v[136:139], v[20:23]
    ds_read_b64_tr_b16 v[222:223], v233 offset:512
    v_mfma_f32_16x16x32_bf16 v[24:27], v[168:171], v[140:143], v[24:27]
    ds_read_b64_tr_b16 v[224:225], v232 offset:8192
    v_mfma_f32_16x16x32_bf16 v[28:31], v[172:175], v[140:143], v[28:31]
    ds_read_b64_tr_b16 v[226:227], v232 offset:8704
    v_mfma_f32_16x16x32_bf16 v[32:35], v[176:179], v[140:143], v[32:35]
    ds_read_b64_tr_b16 v[228:229], v233 offset:8192
    v_mfma_f32_16x16x32_bf16 v[36:39], v[180:183], v[140:143], v[36:39]
    ds_read_b64_tr_b16 v[230:231], v233 offset:8704
    v_mfma_f32_16x16x32_bf16 v[40:43], v[168:171], v[144:147], v[40:43]
    ds_read_b128 v[184:187], v5 offset:16384
    v_mfma_f32_16x16x32_bf16 v[44:47], v[172:175], v[144:147], v[44:47]
    ds_read_b128 v[188:191], v5 offset:18432
    v_mfma_f32_16x16x32_bf16 v[48:51], v[176:179], v[144:147], v[48:51]
    ds_read_b128 v[192:195], v5 offset:20480
    v_mfma_f32_16x16x32_bf16 v[52:55], v[180:183], v[144:147], v[52:55]
    ds_read_b128 v[196:199], v5 offset:22528
    v_mfma_f32_16x16x32_bf16 v[56:59], v[168:171], v[148:151], v[56:59]
    ds_read_b128 v[200:203], v5 offset:24576
    v_mfma_f32_16x16x32_bf16 v[60:63], v[172:175], v[148:151], v[60:63]
    ds_read_b128 v[204:207], v5 offset:26624
    v_mfma_f32_16x16x32_bf16 v[64:67], v[176:179], v[148:151], v[64:67]
    ds_read_b128 v[208:211], v5 offset:28672
    v_mfma_f32_16x16x32_bf16 v[68:71], v[180:183], v[148:151], v[68:71]
    ds_read_b128 v[212:215], v5 offset:30720
    v_mfma_f32_16x16x32_bf16 v[72:75], v[168:171], v[152:155], v[72:75]
    v_mfma_f32_16x16x32_bf16 v[76:79], v[172:175], v[152:155], v[76:79]
    v_mfma_f32_16x16x32_bf16 v[80:83], v[176:179], v[152:155], v[80:83]
    v_mfma_f32_16x16x32_bf16 v[84:87], v[180:183], v[152:155], v[84:87]
    v_mfma_f32_16x16x32_bf16 v[88:91], v[168:171], v[156:159], v[88:91]
    v_mfma_f32_16x16x32_bf16 v[92:95], v[172:175], v[156:159], v[92:95]
    v_mfma_f32_16x16x32_bf16 v[96:99], v[176:179], v[156:159], v[96:99]
    v_mfma_f32_16x16x32_bf16 v[100:103], v[180:183], v[156:159], v[100:103]
    v_mfma_f32_16x16x32_bf16 v[104:107], v[168:171], v[160:163], v[104:107]
    v_mfma_f32_16x16x32_bf16 v[108:111], v[172:175], v[160:163], v[108:111]
    v_mfma_f32_16x16x32_bf16 v[112:115], v[176:179], v[160:163], v[112:115]
    v_mfma_f32_16x16x32_bf16 v[116:119], v[180:183], v[160:163], v[116:119]
    v_mfma_f32_16x16x32_bf16 v[120:123], v[168:171], v[164:167], v[120:123]
    v_mfma_f32_16x16x32_bf16 v[124:127], v[172:175], v[164:167], v[124:127]
    v_mfma_f32_16x16x32_bf16 v[128:131], v[176:179], v[164:167], v[128:131]
    v_mfma_f32_16x16x32_bf16 v[132:135], v[180:183], v[164:167], v[132:135]
    s_waitcnt lgkmcnt(0)
    s_barrier
    v_mfma_f32_16x16x32_bf16 v[8:11], v[216:219], v[184:187], v[8:11]
    ds_read_b64_tr_b16 v[168:169], v232 offset:16384
    v_mfma_f32_16x16x32_bf16 v[12:15], v[220:223], v[184:187], v[12:15]
    ds_read_b64_tr_b16 v[170:171], v232 offset:16896
    v_mfma_f32_16x16x32_bf16 v[16:19], v[224:227], v[184:187], v[16:19]
    ds_read_b64_tr_b16 v[172:173], v233 offset:16384
    v_mfma_f32_16x16x32_bf16 v[20:23], v[228:231], v[184:187], v[20:23]
    ds_read_b64_tr_b16 v[174:175], v233 offset:16896
    v_mfma_f32_16x16x32_bf16 v[24:27], v[216:219], v[188:191], v[24:27]
    ds_read_b64_tr_b16 v[176:177], v232 offset:24576
    v_mfma_f32_16x16x32_bf16 v[28:31], v[220:223], v[188:191], v[28:31]
    ds_read_b64_tr_b16 v[178:179], v232 offset:25088
    v_mfma_f32_16x16x32_bf16 v[32:35], v[224:227], v[188:191], v[32:35]
    ds_read_b64_tr_b16 v[180:181], v233 offset:24576
    v_mfma_f32_16x16x32_bf16 v[36:39], v[228:231], v[188:191], v[36:39]
    ds_read_b64_tr_b16 v[182:183], v233 offset:25088
    v_mfma_f32_16x16x32_bf16 v[40:43], v[216:219], v[192:195], v[40:43]
    ds_read_b128 v[136:139], v4 offset:32768
    v_mfma_f32_16x16x32_bf16 v[44:47], v[220:223], v[192:195], v[44:47]
    ds_read_b128 v[140:143], v4 offset:34816
    v_mfma_f32_16x16x32_bf16 v[48:51], v[224:227], v[192:195], v[48:51]
    ds_read_b128 v[144:147], v4 offset:36864
    v_mfma_f32_16x16x32_bf16 v[52:55], v[228:231], v[192:195], v[52:55]
    ds_read_b128 v[148:151], v4 offset:38912
    v_mfma_f32_16x16x32_bf16 v[56:59], v[216:219], v[196:199], v[56:59]
    ds_read_b128 v[152:155], v4 offset:40960
    v_mfma_f32_16x16x32_bf16 v[60:63], v[220:223], v[196:199], v[60:63]
    ds_read_b128 v[156:159], v4 offset:43008
    v_mfma_f32_16x16x32_bf16 v[64:67], v[224:227], v[196:199], v[64:67]
    ds_read_b128 v[160:163], v4 offset:45056
    v_mfma_f32_16x16x32_bf16 v[68:71], v[228:231], v[196:199], v[68:71]
    ds_read_b128 v[164:167], v4 offset:47104
    v_mfma_f32_16x16x32_bf16 v[72:75], v[216:219], v[200:203], v[72:75]
    v_mfma_f32_16x16x32_bf16 v[76:79], v[220:223], v[200:203], v[76:79]
    v_mfma_f32_16x16x32_bf16 v[80:83], v[224:227], v[200:203], v[80:83]
    v_mfma_f32_16x16x32_bf16 v[84:87], v[228:231], v[200:203], v[84:87]
    v_mfma_f32_16x16x32_bf16 v[88:91], v[216:219], v[204:207], v[88:91]
    v_mfma_f32_16x16x32_bf16 v[92:95], v[220:223], v[204:207], v[92:95]
    v_mfma_f32_16x16x32_bf16 v[96:99], v[224:227], v[204:207], v[96:99]
    v_mfma_f32_16x16x32_bf16 v[100:103], v[228:231], v[204:207], v[100:103]
    v_mfma_f32_16x16x32_bf16 v[104:107], v[216:219], v[208:211], v[104:107]
    v_mfma_f32_16x16x32_bf16 v[108:111], v[220:223], v[208:211], v[108:111]
    v_mfma_f32_16x16x32_bf16 v[112:115], v[224:227], v[208:211], v[112:115]
    v_mfma_f32_16x16x32_bf16 v[116:119], v[228:231], v[208:211], v[116:119]
    v_mfma_f32_16x16x32_bf16 v[120:123], v[216:219], v[212:215], v[120:123]
    v_mfma_f32_16x16x32_bf16 v[124:127], v[220:223], v[212:215], v[124:127]
    v_mfma_f32_16x16x32_bf16 v[128:131], v[224:227], v[212:215], v[128:131]
    v_mfma_f32_16x16x32_bf16 v[132:135], v[228:231], v[212:215], v[132:135]
    s_waitcnt lgkmcnt(0)
    s_barrier
    v_mfma_f32_16x16x32_bf16 v[8:11], v[168:171], v[136:139], v[8:11]
    ds_read_b64_tr_b16 v[216:217], v232 offset:32768
    v_mfma_f32_16x16x32_bf16 v[12:15], v[172:175], v[136:139], v[12:15]
    ds_read_b64_tr_b16 v[218:219], v232 offset:33280
    v_mfma_f32_16x16x32_bf16 v[16:19], v[176:179], v[136:139], v[16:19]
    ds_read_b64_tr_b16 v[220:221], v233 offset:32768
    v_mfma_f32_16x16x32_bf16 v[20:23], v[180:183], v[136:139], v[20:23]
    ds_read_b64_tr_b16 v[222:223], v233 offset:33280
    v_mfma_f32_16x16x32_bf16 v[24:27], v[168:171], v[140:143], v[24:27]
    ds_read_b64_tr_b16 v[224:225], v232 offset:40960
    v_mfma_f32_16x16x32_bf16 v[28:31], v[172:175], v[140:143], v[28:31]
    ds_read_b64_tr_b16 v[226:227], v232 offset:41472
    v_mfma_f32_16x16x32_bf16 v[32:35], v[176:179], v[140:143], v[32:35]
    ds_read_b64_tr_b16 v[228:229], v233 offset:40960
    v_mfma_f32_16x16x32_bf16 v[36:39], v[180:183], v[140:143], v[36:39]
    ds_read_b64_tr_b16 v[230:231], v233 offset:41472
    v_mfma_f32_16x16x32_bf16 v[40:43], v[168:171], v[144:147], v[40:43]
    ds_read_b128 v[184:187], v5 offset:32768
    v_mfma_f32_16x16x32_bf16 v[44:47], v[172:175], v[144:147], v[44:47]
    ds_read_b128 v[188:191], v5 offset:34816
    v_mfma_f32_16x16x32_bf16 v[48:51], v[176:179], v[144:147], v[48:51]
    ds_read_b128 v[192:195], v5 offset:36864
    v_mfma_f32_16x16x32_bf16 v[52:55], v[180:183], v[144:147], v[52:55]
    ds_read_b128 v[196:199], v5 offset:38912
    v_mfma_f32_16x16x32_bf16 v[56:59], v[168:171], v[148:151], v[56:59]
    ds_read_b128 v[200:203], v5 offset:40960
    v_mfma_f32_16x16x32_bf16 v[60:63], v[172:175], v[148:151], v[60:63]
    ds_read_b128 v[204:207], v5 offset:43008
    v_mfma_f32_16x16x32_bf16 v[64:67], v[176:179], v[148:151], v[64:67]
    ds_read_b128 v[208:211], v5 offset:45056
    v_mfma_f32_16x16x32_bf16 v[68:71], v[180:183], v[148:151], v[68:71]
    ds_read_b128 v[212:215], v5 offset:47104
    v_mfma_f32_16x16x32_bf16 v[72:75], v[168:171], v[152:155], v[72:75]
    v_mfma_f32_16x16x32_bf16 v[76:79], v[172:175], v[152:155], v[76:79]
    v_mfma_f32_16x16x32_bf16 v[80:83], v[176:179], v[152:155], v[80:83]
    v_mfma_f32_16x16x32_bf16 v[84:87], v[180:183], v[152:155], v[84:87]
    v_mfma_f32_16x16x32_bf16 v[88:91], v[168:171], v[156:159], v[88:91]
    v_mfma_f32_16x16x32_bf16 v[92:95], v[172:175], v[156:159], v[92:95]
    v_mfma_f32_16x16x32_bf16 v[96:99], v[176:179], v[156:159], v[96:99]
    v_mfma_f32_16x16x32_bf16 v[100:103], v[180:183], v[156:159], v[100:103]
    v_mfma_f32_16x16x32_bf16 v[104:107], v[168:171], v[160:163], v[104:107]
    v_mfma_f32_16x16x32_bf16 v[108:111], v[172:175], v[160:163], v[108:111]
    v_mfma_f32_16x16x32_bf16 v[112:115], v[176:179], v[160:163], v[112:115]
    v_mfma_f32_16x16x32_bf16 v[116:119], v[180:183], v[160:163], v[116:119]
    v_mfma_f32_16x16x32_bf16 v[120:123], v[168:171], v[164:167], v[120:123]
    v_mfma_f32_16x16x32_bf16 v[124:127], v[172:175], v[164:167], v[124:127]
    v_mfma_f32_16x16x32_bf16 v[128:131], v[176:179], v[164:167], v[128:131]
    v_mfma_f32_16x16x32_bf16 v[132:135], v[180:183], v[164:167], v[132:135]
    s_waitcnt lgkmcnt(0)
    s_barrier
    v_mfma_f32_16x16x32_bf16 v[8:11], v[216:219], v[184:187], v[8:11]
    ds_read_b64_tr_b16 v[168:169], v2 offset:0
    v_mfma_f32_16x16x32_bf16 v[12:15], v[220:223], v[184:187], v[12:15]
    ds_read_b64_tr_b16 v[170:171], v2 offset:512
    v_mfma_f32_16x16x32_bf16 v[16:19], v[224:227], v[184:187], v[16:19]
    ds_read_b64_tr_b16 v[172:173], v3 offset:0
    v_mfma_f32_16x16x32_bf16 v[20:23], v[228:231], v[184:187], v[20:23]
    ds_read_b64_tr_b16 v[174:175], v3 offset:512
    v_mfma_f32_16x16x32_bf16 v[24:27], v[216:219], v[188:191], v[24:27]
    ds_read_b64_tr_b16 v[176:177], v2 offset:8192
    v_mfma_f32_16x16x32_bf16 v[28:31], v[220:223], v[188:191], v[28:31]
    ds_read_b64_tr_b16 v[178:179], v2 offset:8704
    v_mfma_f32_16x16x32_bf16 v[32:35], v[224:227], v[188:191], v[32:35]
    ds_read_b64_tr_b16 v[180:181], v3 offset:8192
    v_mfma_f32_16x16x32_bf16 v[36:39], v[228:231], v[188:191], v[36:39]
    ds_read_b64_tr_b16 v[182:183], v3 offset:8704
    v_mfma_f32_16x16x32_bf16 v[40:43], v[216:219], v[192:195], v[40:43]
    ds_read_b128 v[136:139], v4 offset:0
    v_mfma_f32_16x16x32_bf16 v[44:47], v[220:223], v[192:195], v[44:47]
    ds_read_b128 v[140:143], v4 offset:2048
    v_mfma_f32_16x16x32_bf16 v[48:51], v[224:227], v[192:195], v[48:51]
    ds_read_b128 v[144:147], v4 offset:4096
    v_mfma_f32_16x16x32_bf16 v[52:55], v[228:231], v[192:195], v[52:55]
    ds_read_b128 v[148:151], v4 offset:6144
    v_mfma_f32_16x16x32_bf16 v[56:59], v[216:219], v[196:199], v[56:59]
    ds_read_b128 v[152:155], v4 offset:8192
    v_mfma_f32_16x16x32_bf16 v[60:63], v[220:223], v[196:199], v[60:63]
    ds_read_b128 v[156:159], v4 offset:10240
    v_mfma_f32_16x16x32_bf16 v[64:67], v[224:227], v[196:199], v[64:67]
    ds_read_b128 v[160:163], v4 offset:12288
    v_mfma_f32_16x16x32_bf16 v[68:71], v[228:231], v[196:199], v[68:71]
    ds_read_b128 v[164:167], v4 offset:14336
    v_mfma_f32_16x16x32_bf16 v[72:75], v[216:219], v[200:203], v[72:75]
    v_mfma_f32_16x16x32_bf16 v[76:79], v[220:223], v[200:203], v[76:79]
    v_mfma_f32_16x16x32_bf16 v[80:83], v[224:227], v[200:203], v[80:83]
    v_mfma_f32_16x16x32_bf16 v[84:87], v[228:231], v[200:203], v[84:87]
    v_mfma_f32_16x16x32_bf16 v[88:91], v[216:219], v[204:207], v[88:91]
    v_mfma_f32_16x16x32_bf16 v[92:95], v[220:223], v[204:207], v[92:95]
    v_mfma_f32_16x16x32_bf16 v[96:99], v[224:227], v[204:207], v[96:99]
    v_mfma_f32_16x16x32_bf16 v[100:103], v[228:231], v[204:207], v[100:103]
    v_mfma_f32_16x16x32_bf16 v[104:107], v[216:219], v[208:211], v[104:107]
    v_mfma_f32_16x16x32_bf16 v[108:111], v[220:223], v[208:211], v[108:111]
    v_mfma_f32_16x16x32_bf16 v[112:115], v[224:227], v[208:211], v[112:115]
    v_mfma_f32_16x16x32_bf16 v[116:119], v[228:231], v[208:211], v[116:119]
    v_mfma_f32_16x16x32_bf16 v[120:123], v[216:219], v[212:215], v[120:123]
    v_mfma_f32_16x16x32_bf16 v[124:127], v[220:223], v[212:215], v[124:127]
    v_mfma_f32_16x16x32_bf16 v[128:131], v[224:227], v[212:215], v[128:131]
    v_mfma_f32_16x16x32_bf16 v[132:135], v[228:231], v[212:215], v[132:135]
    s_waitcnt lgkmcnt(0)
    s_barrier
    v_mfma_f32_16x16x32_bf16 v[8:11], v[168:171], v[136:139], v[8:11]
    ds_read_b64_tr_b16 v[216:217], v2 offset:16384
    v_mfma_f32_16x16x32_bf16 v[12:15], v[172:175], v[136:139], v[12:15]
    ds_read_b64_tr_b16 v[218:219], v2 offset:16896
    v_mfma_f32_16x16x32_bf16 v[16:19], v[176:179], v[136:139], v[16:19]
    ds_read_b64_tr_b16 v[220:221], v3 offset:16384
    v_mfma_f32_16x16x32_bf16 v[20:23], v[180:183], v[136:139], v[20:23]
    ds_read_b64_tr_b16 v[222:223], v3 offset:16896
    v_mfma_f32_16x16x32_bf16 v[24:27], v[168:171], v[140:143], v[24:27]
    ds_read_b64_tr_b16 v[224:225], v2 offset:24576
    v_mfma_f32_16x16x32_bf16 v[28:31], v[172:175], v[140:143], v[28:31]
    ds_read_b64_tr_b16 v[226:227], v2 offset:25088
    v_mfma_f32_16x16x32_bf16 v[32:35], v[176:179], v[140:143], v[32:35]
    ds_read_b64_tr_b16 v[228:229], v3 offset:24576
    v_mfma_f32_16x16x32_bf16 v[36:39], v[180:183], v[140:143], v[36:39]
    ds_read_b64_tr_b16 v[230:231], v3 offset:25088
    v_mfma_f32_16x16x32_bf16 v[40:43], v[168:171], v[144:147], v[40:43]
    ds_read_b128 v[184:187], v5 offset:0
    v_mfma_f32_16x16x32_bf16 v[44:47], v[172:175], v[144:147], v[44:47]
    ds_read_b128 v[188:191], v5 offset:2048
    v_mfma_f32_16x16x32_bf16 v[48:51], v[176:179], v[144:147], v[48:51]
    ds_read_b128 v[192:195], v5 offset:4096
    v_mfma_f32_16x16x32_bf16 v[52:55], v[180:183], v[144:147], v[52:55]
    ds_read_b128 v[196:199], v5 offset:6144
    v_mfma_f32_16x16x32_bf16 v[56:59], v[168:171], v[148:151], v[56:59]
    ds_read_b128 v[200:203], v5 offset:8192
    v_mfma_f32_16x16x32_bf16 v[60:63], v[172:175], v[148:151], v[60:63]
    ds_read_b128 v[204:207], v5 offset:10240
    v_mfma_f32_16x16x32_bf16 v[64:67], v[176:179], v[148:151], v[64:67]
    ds_read_b128 v[208:211], v5 offset:12288
    v_mfma_f32_16x16x32_bf16 v[68:71], v[180:183], v[148:151], v[68:71]
    ds_read_b128 v[212:215], v5 offset:14336
    v_mfma_f32_16x16x32_bf16 v[72:75], v[168:171], v[152:155], v[72:75]
    v_mfma_f32_16x16x32_bf16 v[76:79], v[172:175], v[152:155], v[76:79]
    v_mfma_f32_16x16x32_bf16 v[80:83], v[176:179], v[152:155], v[80:83]
    v_mfma_f32_16x16x32_bf16 v[84:87], v[180:183], v[152:155], v[84:87]
    v_mfma_f32_16x16x32_bf16 v[88:91], v[168:171], v[156:159], v[88:91]
    v_mfma_f32_16x16x32_bf16 v[92:95], v[172:175], v[156:159], v[92:95]
    v_mfma_f32_16x16x32_bf16 v[96:99], v[176:179], v[156:159], v[96:99]
    v_mfma_f32_16x16x32_bf16 v[100:103], v[180:183], v[156:159], v[100:103]
    v_mfma_f32_16x16x32_bf16 v[104:107], v[168:171], v[160:163], v[104:107]
    v_mfma_f32_16x16x32_bf16 v[108:111], v[172:175], v[160:163], v[108:111]
    v_mfma_f32_16x16x32_bf16 v[112:115], v[176:179], v[160:163], v[112:115]
    v_mfma_f32_16x16x32_bf16 v[116:119], v[180:183], v[160:163], v[116:119]
    v_mfma_f32_16x16x32_bf16 v[120:123], v[168:171], v[164:167], v[120:123]
    v_mfma_f32_16x16x32_bf16 v[124:127], v[172:175], v[164:167], v[124:127]
    v_mfma_f32_16x16x32_bf16 v[128:131], v[176:179], v[164:167], v[128:131]
    v_mfma_f32_16x16x32_bf16 v[132:135], v[180:183], v[164:167], v[132:135]
    s_waitcnt lgkmcnt(0)
    s_barrier
    v_mfma_f32_16x16x32_bf16 v[8:11], v[216:219], v[184:187], v[8:11]
    ds_read_b64_tr_b16 v[168:169], v2 offset:32768
    v_mfma_f32_16x16x32_bf16 v[12:15], v[220:223], v[184:187], v[12:15]
    ds_read_b64_tr_b16 v[170:171], v2 offset:33280
    v_mfma_f32_16x16x32_bf16 v[16:19], v[224:227], v[184:187], v[16:19]
    ds_read_b64_tr_b16 v[172:173], v3 offset:32768
    v_mfma_f32_16x16x32_bf16 v[20:23], v[228:231], v[184:187], v[20:23]
    ds_read_b64_tr_b16 v[174:175], v3 offset:33280
    v_mfma_f32_16x16x32_bf16 v[24:27], v[216:219], v[188:191], v[24:27]
    ds_read_b64_tr_b16 v[176:177], v2 offset:40960
    v_mfma_f32_16x16x32_bf16 v[28:31], v[220:223], v[188:191], v[28:31]
    ds_read_b64_tr_b16 v[178:179], v2 offset:41472
    v_mfma_f32_16x16x32_bf16 v[32:35], v[224:227], v[188:191], v[32:35]
    ds_read_b64_tr_b16 v[180:181], v3 offset:40960
    v_mfma_f32_16x16x32_bf16 v[36:39], v[228:231], v[188:191], v[36:39]
    ds_read_b64_tr_b16 v[182:183], v3 offset:41472
    v_mfma_f32_16x16x32_bf16 v[40:43], v[216:219], v[192:195], v[40:43]
    ds_read_b128 v[136:139], v4 offset:16384
    v_mfma_f32_16x16x32_bf16 v[44:47], v[220:223], v[192:195], v[44:47]
    ds_read_b128 v[140:143], v4 offset:18432
    v_mfma_f32_16x16x32_bf16 v[48:51], v[224:227], v[192:195], v[48:51]
    ds_read_b128 v[144:147], v4 offset:20480
    v_mfma_f32_16x16x32_bf16 v[52:55], v[228:231], v[192:195], v[52:55]
    ds_read_b128 v[148:151], v4 offset:22528
    v_mfma_f32_16x16x32_bf16 v[56:59], v[216:219], v[196:199], v[56:59]
    ds_read_b128 v[152:155], v4 offset:24576
    v_mfma_f32_16x16x32_bf16 v[60:63], v[220:223], v[196:199], v[60:63]
    ds_read_b128 v[156:159], v4 offset:26624
    v_mfma_f32_16x16x32_bf16 v[64:67], v[224:227], v[196:199], v[64:67]
    ds_read_b128 v[160:163], v4 offset:28672
    v_mfma_f32_16x16x32_bf16 v[68:71], v[228:231], v[196:199], v[68:71]
    ds_read_b128 v[164:167], v4 offset:30720
    v_mfma_f32_16x16x32_bf16 v[72:75], v[216:219], v[200:203], v[72:75]
    v_mfma_f32_16x16x32_bf16 v[76:79], v[220:223], v[200:203], v[76:79]
    v_mfma_f32_16x16x32_bf16 v[80:83], v[224:227], v[200:203], v[80:83]
    v_mfma_f32_16x16x32_bf16 v[84:87], v[228:231], v[200:203], v[84:87]
    v_mfma_f32_16x16x32_bf16 v[88:91], v[216:219], v[204:207], v[88:91]
    v_mfma_f32_16x16x32_bf16 v[92:95], v[220:223], v[204:207], v[92:95]
    v_mfma_f32_16x16x32_bf16 v[96:99], v[224:227], v[204:207], v[96:99]
    v_mfma_f32_16x16x32_bf16 v[100:103], v[228:231], v[204:207], v[100:103]
    v_mfma_f32_16x16x32_bf16 v[104:107], v[216:219], v[208:211], v[104:107]
    v_mfma_f32_16x16x32_bf16 v[108:111], v[220:223], v[208:211], v[108:111]
    v_mfma_f32_16x16x32_bf16 v[112:115], v[224:227], v[208:211], v[112:115]
    v_mfma_f32_16x16x32_bf16 v[116:119], v[228:231], v[208:211], v[116:119]
    v_mfma_f32_16x16x32_bf16 v[120:123], v[216:219], v[212:215], v[120:123]
    v_mfma_f32_16x16x32_bf16 v[124:127], v[220:223], v[212:215], v[124:127]
    v_mfma_f32_16x16x32_bf16 v[128:131], v[224:227], v[212:215], v[128:131]
    v_mfma_f32_16x16x32_bf16 v[132:135], v[228:231], v[212:215], v[132:135]
    s_waitcnt lgkmcnt(0)
    s_barrier
    v_mfma_f32_16x16x32_bf16 v[8:11], v[168:171], v[136:139], v[8:11]
    ds_read_b64_tr_b16 v[216:217], v232 offset:0
    v_mfma_f32_16x16x32_bf16 v[12:15], v[172:175], v[136:139], v[12:15]
    ds_read_b64_tr_b16 v[218:219], v232 offset:512
    v_mfma_f32_16x16x32_bf16 v[16:19], v[176:179], v[136:139], v[16:19]
    ds_read_b64_tr_b16 v[220:221], v233 offset:0
    v_mfma_f32_16x16x32_bf16 v[20:23], v[180:183], v[136:139], v[20:23]
    ds_read_b64_tr_b16 v[222:223], v233 offset:512
    v_mfma_f32_16x16x32_bf16 v[24:27], v[168:171], v[140:143], v[24:27]
    ds_read_b64_tr_b16 v[224:225], v232 offset:8192
    v_mfma_f32_16x16x32_bf16 v[28:31], v[172:175], v[140:143], v[28:31]
    ds_read_b64_tr_b16 v[226:227], v232 offset:8704
    v_mfma_f32_16x16x32_bf16 v[32:35], v[176:179], v[140:143], v[32:35]
    ds_read_b64_tr_b16 v[228:229], v233 offset:8192
    v_mfma_f32_16x16x32_bf16 v[36:39], v[180:183], v[140:143], v[36:39]
    ds_read_b64_tr_b16 v[230:231], v233 offset:8704
    v_mfma_f32_16x16x32_bf16 v[40:43], v[168:171], v[144:147], v[40:43]
    ds_read_b128 v[184:187], v5 offset:16384
    v_mfma_f32_16x16x32_bf16 v[44:47], v[172:175], v[144:147], v[44:47]
    ds_read_b128 v[188:191], v5 offset:18432
    v_mfma_f32_16x16x32_bf16 v[48:51], v[176:179], v[144:147], v[48:51]
    ds_read_b128 v[192:195], v5 offset:20480
    v_mfma_f32_16x16x32_bf16 v[52:55], v[180:183], v[144:147], v[52:55]
    ds_read_b128 v[196:199], v5 offset:22528
    v_mfma_f32_16x16x32_bf16 v[56:59], v[168:171], v[148:151], v[56:59]
    ds_read_b128 v[200:203], v5 offset:24576
    v_mfma_f32_16x16x32_bf16 v[60:63], v[172:175], v[148:151], v[60:63]
    ds_read_b128 v[204:207], v5 offset:26624
    v_mfma_f32_16x16x32_bf16 v[64:67], v[176:179], v[148:151], v[64:67]
    ds_read_b128 v[208:211], v5 offset:28672
    v_mfma_f32_16x16x32_bf16 v[68:71], v[180:183], v[148:151], v[68:71]
    ds_read_b128 v[212:215], v5 offset:30720
    v_mfma_f32_16x16x32_bf16 v[72:75], v[168:171], v[152:155], v[72:75]
    v_mfma_f32_16x16x32_bf16 v[76:79], v[172:175], v[152:155], v[76:79]
    v_mfma_f32_16x16x32_bf16 v[80:83], v[176:179], v[152:155], v[80:83]
    v_mfma_f32_16x16x32_bf16 v[84:87], v[180:183], v[152:155], v[84:87]
    v_mfma_f32_16x16x32_bf16 v[88:91], v[168:171], v[156:159], v[88:91]
    v_mfma_f32_16x16x32_bf16 v[92:95], v[172:175], v[156:159], v[92:95]
    v_mfma_f32_16x16x32_bf16 v[96:99], v[176:179], v[156:159], v[96:99]
    v_mfma_f32_16x16x32_bf16 v[100:103], v[180:183], v[156:159], v[100:103]
    v_mfma_f32_16x16x32_bf16 v[104:107], v[168:171], v[160:163], v[104:107]
    v_mfma_f32_16x16x32_bf16 v[108:111], v[172:175], v[160:163], v[108:111]
    v_mfma_f32_16x16x32_bf16 v[112:115], v[176:179], v[160:163], v[112:115]
    v_mfma_f32_16x16x32_bf16 v[116:119], v[180:183], v[160:163], v[116:119]
    v_mfma_f32_16x16x32_bf16 v[120:123], v[168:171], v[164:167], v[120:123]
    v_mfma_f32_16x16x32_bf16 v[124:127], v[172:175], v[164:167], v[124:127]
    v_mfma_f32_16x16x32_bf16 v[128:131], v[176:179], v[164:167], v[128:131]
    v_mfma_f32_16x16x32_bf16 v[132:135], v[180:183], v[164:167], v[132:135]
    s_waitcnt lgkmcnt(0)
    s_barrier
    v_mfma_f32_16x16x32_bf16 v[8:11], v[216:219], v[184:187], v[8:11]
    ds_read_b64_tr_b16 v[168:169], v232 offset:16384
    v_mfma_f32_16x16x32_bf16 v[12:15], v[220:223], v[184:187], v[12:15]
    ds_read_b64_tr_b16 v[170:171], v232 offset:16896
    v_mfma_f32_16x16x32_bf16 v[16:19], v[224:227], v[184:187], v[16:19]
    ds_read_b64_tr_b16 v[172:173], v233 offset:16384
    v_mfma_f32_16x16x32_bf16 v[20:23], v[228:231], v[184:187], v[20:23]
    ds_read_b64_tr_b16 v[174:175], v233 offset:16896
    v_mfma_f32_16x16x32_bf16 v[24:27], v[216:219], v[188:191], v[24:27]
    ds_read_b64_tr_b16 v[176:177], v232 offset:24576
    v_mfma_f32_16x16x32_bf16 v[28:31], v[220:223], v[188:191], v[28:31]
    ds_read_b64_tr_b16 v[178:179], v232 offset:25088
    v_mfma_f32_16x16x32_bf16 v[32:35], v[224:227], v[188:191], v[32:35]
    ds_read_b64_tr_b16 v[180:181], v233 offset:24576
    v_mfma_f32_16x16x32_bf16 v[36:39], v[228:231], v[188:191], v[36:39]
    ds_read_b64_tr_b16 v[182:183], v233 offset:25088
    v_mfma_f32_16x16x32_bf16 v[40:43], v[216:219], v[192:195], v[40:43]
    ds_read_b128 v[136:139], v4 offset:32768
    v_mfma_f32_16x16x32_bf16 v[44:47], v[220:223], v[192:195], v[44:47]
    ds_read_b128 v[140:143], v4 offset:34816
    v_mfma_f32_16x16x32_bf16 v[48:51], v[224:227], v[192:195], v[48:51]
    ds_read_b128 v[144:147], v4 offset:36864
    v_mfma_f32_16x16x32_bf16 v[52:55], v[228:231], v[192:195], v[52:55]
    ds_read_b128 v[148:151], v4 offset:38912
    v_mfma_f32_16x16x32_bf16 v[56:59], v[216:219], v[196:199], v[56:59]
    ds_read_b128 v[152:155], v4 offset:40960
    v_mfma_f32_16x16x32_bf16 v[60:63], v[220:223], v[196:199], v[60:63]
    ds_read_b128 v[156:159], v4 offset:43008
    v_mfma_f32_16x16x32_bf16 v[64:67], v[224:227], v[196:199], v[64:67]
    ds_read_b128 v[160:163], v4 offset:45056
    v_mfma_f32_16x16x32_bf16 v[68:71], v[228:231], v[196:199], v[68:71]
    ds_read_b128 v[164:167], v4 offset:47104
    v_mfma_f32_16x16x32_bf16 v[72:75], v[216:219], v[200:203], v[72:75]
    v_mfma_f32_16x16x32_bf16 v[76:79], v[220:223], v[200:203], v[76:79]
    v_mfma_f32_16x16x32_bf16 v[80:83], v[224:227], v[200:203], v[80:83]
    v_mfma_f32_16x16x32_bf16 v[84:87], v[228:231], v[200:203], v[84:87]
    v_mfma_f32_16x16x32_bf16 v[88:91], v[216:219], v[204:207], v[88:91]
    v_mfma_f32_16x16x32_bf16 v[92:95], v[220:223], v[204:207], v[92:95]
    v_mfma_f32_16x16x32_bf16 v[96:99], v[224:227], v[204:207], v[96:99]
    v_mfma_f32_16x16x32_bf16 v[100:103], v[228:231], v[204:207], v[100:103]
    v_mfma_f32_16x16x32_bf16 v[104:107], v[216:219], v[208:211], v[104:107]
    v_mfma_f32_16x16x32_bf16 v[108:111], v[220:223], v[208:211], v[108:111]
    v_mfma_f32_16x16x32_bf16 v[112:115], v[224:227], v[208:211], v[112:115]
    v_mfma_f32_16x16x32_bf16 v[116:119], v[228:231], v[208:211], v[116:119]
    v_mfma_f32_16x16x32_bf16 v[120:123], v[216:219], v[212:215], v[120:123]
    v_mfma_f32_16x16x32_bf16 v[124:127], v[220:223], v[212:215], v[124:127]
    v_mfma_f32_16x16x32_bf16 v[128:131], v[224:227], v[212:215], v[128:131]
    v_mfma_f32_16x16x32_bf16 v[132:135], v[228:231], v[212:215], v[132:135]
    s_waitcnt lgkmcnt(0)
    s_barrier
    v_mfma_f32_16x16x32_bf16 v[8:11], v[168:171], v[136:139], v[8:11]
    ds_read_b64_tr_b16 v[216:217], v232 offset:32768
    v_mfma_f32_16x16x32_bf16 v[12:15], v[172:175], v[136:139], v[12:15]
    ds_read_b64_tr_b16 v[218:219], v232 offset:33280
    v_mfma_f32_16x16x32_bf16 v[16:19], v[176:179], v[136:139], v[16:19]
    ds_read_b64_tr_b16 v[220:221], v233 offset:32768
    v_mfma_f32_16x16x32_bf16 v[20:23], v[180:183], v[136:139], v[20:23]
    ds_read_b64_tr_b16 v[222:223], v233 offset:33280
    v_mfma_f32_16x16x32_bf16 v[24:27], v[168:171], v[140:143], v[24:27]
    ds_read_b64_tr_b16 v[224:225], v232 offset:40960
    v_mfma_f32_16x16x32_bf16 v[28:31], v[172:175], v[140:143], v[28:31]
    ds_read_b64_tr_b16 v[226:227], v232 offset:41472
    v_mfma_f32_16x16x32_bf16 v[32:35], v[176:179], v[140:143], v[32:35]
    ds_read_b64_tr_b16 v[228:229], v233 offset:40960
    v_mfma_f32_16x16x32_bf16 v[36:39], v[180:183], v[140:143], v[36:39]
    ds_read_b64_tr_b16 v[230:231], v233 offset:41472
    v_mfma_f32_16x16x32_bf16 v[40:43], v[168:171], v[144:147], v[40:43]
    ds_read_b128 v[184:187], v5 offset:32768
    v_mfma_f32_16x16x32_bf16 v[44:47], v[172:175], v[144:147], v[44:47]
    ds_read_b128 v[188:191], v5 offset:34816
    v_mfma_f32_16x16x32_bf16 v[48:51], v[176:179], v[144:147], v[48:51]
    ds_read_b128 v[192:195], v5 offset:36864
    v_mfma_f32_16x16x32_bf16 v[52:55], v[180:183], v[144:147], v[52:55]
    ds_read_b128 v[196:199], v5 offset:38912
    v_mfma_f32_16x16x32_bf16 v[56:59], v[168:171], v[148:151], v[56:59]
    ds_read_b128 v[200:203], v5 offset:40960
    v_mfma_f32_16x16x32_bf16 v[60:63], v[172:175], v[148:151], v[60:63]
    ds_read_b128 v[204:207], v5 offset:43008
    v_mfma_f32_16x16x32_bf16 v[64:67], v[176:179], v[148:151], v[64:67]
    ds_read_b128 v[208:211], v5 offset:45056
    v_mfma_f32_16x16x32_bf16 v[68:71], v[180:183], v[148:151], v[68:71]
    ds_read_b128 v[212:215], v5 offset:47104
    v_mfma_f32_16x16x32_bf16 v[72:75], v[168:171], v[152:155], v[72:75]
    v_mfma_f32_16x16x32_bf16 v[76:79], v[172:175], v[152:155], v[76:79]
    v_mfma_f32_16x16x32_bf16 v[80:83], v[176:179], v[152:155], v[80:83]
    v_mfma_f32_16x16x32_bf16 v[84:87], v[180:183], v[152:155], v[84:87]
    v_mfma_f32_16x16x32_bf16 v[88:91], v[168:171], v[156:159], v[88:91]
    v_mfma_f32_16x16x32_bf16 v[92:95], v[172:175], v[156:159], v[92:95]
    v_mfma_f32_16x16x32_bf16 v[96:99], v[176:179], v[156:159], v[96:99]
    v_mfma_f32_16x16x32_bf16 v[100:103], v[180:183], v[156:159], v[100:103]
    v_mfma_f32_16x16x32_bf16 v[104:107], v[168:171], v[160:163], v[104:107]
    v_mfma_f32_16x16x32_bf16 v[108:111], v[172:175], v[160:163], v[108:111]
    v_mfma_f32_16x16x32_bf16 v[112:115], v[176:179], v[160:163], v[112:115]
    v_mfma_f32_16x16x32_bf16 v[116:119], v[180:183], v[160:163], v[116:119]
    v_mfma_f32_16x16x32_bf16 v[120:123], v[168:171], v[164:167], v[120:123]
    v_mfma_f32_16x16x32_bf16 v[124:127], v[172:175], v[164:167], v[124:127]
    v_mfma_f32_16x16x32_bf16 v[128:131], v[176:179], v[164:167], v[128:131]
    v_mfma_f32_16x16x32_bf16 v[132:135], v[180:183], v[164:167], v[132:135]
    s_waitcnt lgkmcnt(0)
    s_barrier
    v_mfma_f32_16x16x32_bf16 v[8:11], v[216:219], v[184:187], v[8:11]
    ds_read_b64_tr_b16 v[168:169], v2 offset:0
    v_mfma_f32_16x16x32_bf16 v[12:15], v[220:223], v[184:187], v[12:15]
    ds_read_b64_tr_b16 v[170:171], v2 offset:512
    v_mfma_f32_16x16x32_bf16 v[16:19], v[224:227], v[184:187], v[16:19]
    ds_read_b64_tr_b16 v[172:173], v3 offset:0
    v_mfma_f32_16x16x32_bf16 v[20:23], v[228:231], v[184:187], v[20:23]
    ds_read_b64_tr_b16 v[174:175], v3 offset:512
    v_mfma_f32_16x16x32_bf16 v[24:27], v[216:219], v[188:191], v[24:27]
    ds_read_b64_tr_b16 v[176:177], v2 offset:8192
    v_mfma_f32_16x16x32_bf16 v[28:31], v[220:223], v[188:191], v[28:31]
    ds_read_b64_tr_b16 v[178:179], v2 offset:8704
    v_mfma_f32_16x16x32_bf16 v[32:35], v[224:227], v[188:191], v[32:35]
    ds_read_b64_tr_b16 v[180:181], v3 offset:8192
    v_mfma_f32_16x16x32_bf16 v[36:39], v[228:231], v[188:191], v[36:39]
    ds_read_b64_tr_b16 v[182:183], v3 offset:8704
    v_mfma_f32_16x16x32_bf16 v[40:43], v[216:219], v[192:195], v[40:43]
    ds_read_b128 v[136:139], v4 offset:0
    v_mfma_f32_16x16x32_bf16 v[44:47], v[220:223], v[192:195], v[44:47]
    ds_read_b128 v[140:143], v4 offset:2048
    v_mfma_f32_16x16x32_bf16 v[48:51], v[224:227], v[192:195], v[48:51]
    ds_read_b128 v[144:147], v4 offset:4096
    v_mfma_f32_16x16x32_bf16 v[52:55], v[228:231], v[192:195], v[52:55]
    ds_read_b128 v[148:151], v4 offset:6144
    v_mfma_f32_16x16x32_bf16 v[56:59], v[216:219], v[196:199], v[56:59]
    ds_read_b128 v[152:155], v4 offset:8192
    v_mfma_f32_16x16x32_bf16 v[60:63], v[220:223], v[196:199], v[60:63]
    ds_read_b128 v[156:159], v4 offset:10240
    v_mfma_f32_16x16x32_bf16 v[64:67], v[224:227], v[196:199], v[64:67]
    ds_read_b128 v[160:163], v4 offset:12288
    v_mfma_f32_16x16x32_bf16 v[68:71], v[228:231], v[196:199], v[68:71]
    ds_read_b128 v[164:167], v4 offset:14336
    v_mfma_f32_16x16x32_bf16 v[72:75], v[216:219], v[200:203], v[72:75]
    v_mfma_f32_16x16x32_bf16 v[76:79], v[220:223], v[200:203], v[76:79]
    v_mfma_f32_16x16x32_bf16 v[80:83], v[224:227], v[200:203], v[80:83]
    v_mfma_f32_16x16x32_bf16 v[84:87], v[228:231], v[200:203], v[84:87]
    v_mfma_f32_16x16x32_bf16 v[88:91], v[216:219], v[204:207], v[88:91]
    v_mfma_f32_16x16x32_bf16 v[92:95], v[220:223], v[204:207], v[92:95]
    v_mfma_f32_16x16x32_bf16 v[96:99], v[224:227], v[204:207], v[96:99]
    v_mfma_f32_16x16x32_bf16 v[100:103], v[228:231], v[204:207], v[100:103]
    v_mfma_f32_16x16x32_bf16 v[104:107], v[216:219], v[208:211], v[104:107]
    v_mfma_f32_16x16x32_bf16 v[108:111], v[220:223], v[208:211], v[108:111]
    v_mfma_f32_16x16x32_bf16 v[112:115], v[224:227], v[208:211], v[112:115]
    v_mfma_f32_16x16x32_bf16 v[116:119], v[228:231], v[208:211], v[116:119]
    v_mfma_f32_16x16x32_bf16 v[120:123], v[216:219], v[212:215], v[120:123]
    v_mfma_f32_16x16x32_bf16 v[124:127], v[220:223], v[212:215], v[124:127]
    v_mfma_f32_16x16x32_bf16 v[128:131], v[224:227], v[212:215], v[128:131]
    v_mfma_f32_16x16x32_bf16 v[132:135], v[228:231], v[212:215], v[132:135]
    s_waitcnt lgkmcnt(0)
    s_barrier
    v_mfma_f32_16x16x32_bf16 v[8:11], v[168:171], v[136:139], v[8:11]
    ds_read_b64_tr_b16 v[216:217], v2 offset:16384
    v_mfma_f32_16x16x32_bf16 v[12:15], v[172:175], v[136:139], v[12:15]
    ds_read_b64_tr_b16 v[218:219], v2 offset:16896
    v_mfma_f32_16x16x32_bf16 v[16:19], v[176:179], v[136:139], v[16:19]
    ds_read_b64_tr_b16 v[220:221], v3 offset:16384
    v_mfma_f32_16x16x32_bf16 v[20:23], v[180:183], v[136:139], v[20:23]
    ds_read_b64_tr_b16 v[222:223], v3 offset:16896
    v_mfma_f32_16x16x32_bf16 v[24:27], v[168:171], v[140:143], v[24:27]
    ds_read_b64_tr_b16 v[224:225], v2 offset:24576
    v_mfma_f32_16x16x32_bf16 v[28:31], v[172:175], v[140:143], v[28:31]
    ds_read_b64_tr_b16 v[226:227], v2 offset:25088
    v_mfma_f32_16x16x32_bf16 v[32:35], v[176:179], v[140:143], v[32:35]
    ds_read_b64_tr_b16 v[228:229], v3 offset:24576
    v_mfma_f32_16x16x32_bf16 v[36:39], v[180:183], v[140:143], v[36:39]
    ds_read_b64_tr_b16 v[230:231], v3 offset:25088
    v_mfma_f32_16x16x32_bf16 v[40:43], v[168:171], v[144:147], v[40:43]
    ds_read_b128 v[184:187], v5 offset:0
    v_mfma_f32_16x16x32_bf16 v[44:47], v[172:175], v[144:147], v[44:47]
    ds_read_b128 v[188:191], v5 offset:2048
    v_mfma_f32_16x16x32_bf16 v[48:51], v[176:179], v[144:147], v[48:51]
    ds_read_b128 v[192:195], v5 offset:4096
    v_mfma_f32_16x16x32_bf16 v[52:55], v[180:183], v[144:147], v[52:55]
    ds_read_b128 v[196:199], v5 offset:6144
    v_mfma_f32_16x16x32_bf16 v[56:59], v[168:171], v[148:151], v[56:59]
    ds_read_b128 v[200:203], v5 offset:8192
    v_mfma_f32_16x16x32_bf16 v[60:63], v[172:175], v[148:151], v[60:63]
    ds_read_b128 v[204:207], v5 offset:10240
    v_mfma_f32_16x16x32_bf16 v[64:67], v[176:179], v[148:151], v[64:67]
    ds_read_b128 v[208:211], v5 offset:12288
    v_mfma_f32_16x16x32_bf16 v[68:71], v[180:183], v[148:151], v[68:71]
    ds_read_b128 v[212:215], v5 offset:14336
    v_mfma_f32_16x16x32_bf16 v[72:75], v[168:171], v[152:155], v[72:75]
    v_mfma_f32_16x16x32_bf16 v[76:79], v[172:175], v[152:155], v[76:79]
    v_mfma_f32_16x16x32_bf16 v[80:83], v[176:179], v[152:155], v[80:83]
    v_mfma_f32_16x16x32_bf16 v[84:87], v[180:183], v[152:155], v[84:87]
    v_mfma_f32_16x16x32_bf16 v[88:91], v[168:171], v[156:159], v[88:91]
    v_mfma_f32_16x16x32_bf16 v[92:95], v[172:175], v[156:159], v[92:95]
    v_mfma_f32_16x16x32_bf16 v[96:99], v[176:179], v[156:159], v[96:99]
    v_mfma_f32_16x16x32_bf16 v[100:103], v[180:183], v[156:159], v[100:103]
    v_mfma_f32_16x16x32_bf16 v[104:107], v[168:171], v[160:163], v[104:107]
    v_mfma_f32_16x16x32_bf16 v[108:111], v[172:175], v[160:163], v[108:111]
    v_mfma_f32_16x16x32_bf16 v[112:115], v[176:179], v[160:163], v[112:115]
    v_mfma_f32_16x16x32_bf16 v[116:119], v[180:183], v[160:163], v[116:119]
    v_mfma_f32_16x16x32_bf16 v[120:123], v[168:171], v[164:167], v[120:123]
    v_mfma_f32_16x16x32_bf16 v[124:127], v[172:175], v[164:167], v[124:127]
    v_mfma_f32_16x16x32_bf16 v[128:131], v[176:179], v[164:167], v[128:131]
    v_mfma_f32_16x16x32_bf16 v[132:135], v[180:183], v[164:167], v[132:135]
    s_waitcnt lgkmcnt(0)
    s_barrier
    v_mfma_f32_16x16x32_bf16 v[8:11], v[216:219], v[184:187], v[8:11]
    ds_read_b128 v[136:139], v234 offset:0
    v_mfma_f32_16x16x32_bf16 v[12:15], v[220:223], v[184:187], v[12:15]
    ds_read_b128 v[140:143], v234 offset:256
    v_mfma_f32_16x16x32_bf16 v[16:19], v[224:227], v[184:187], v[16:19]
    ds_read_b128 v[144:147], v234 offset:512
    v_mfma_f32_16x16x32_bf16 v[20:23], v[228:231], v[184:187], v[20:23]
    ds_read_b128 v[148:151], v234 offset:768
    v_mfma_f32_16x16x32_bf16 v[24:27], v[216:219], v[188:191], v[24:27]
    ds_read_b128 v[152:155], v234 offset:1024
    v_mfma_f32_16x16x32_bf16 v[28:31], v[220:223], v[188:191], v[28:31]
    ds_read_b128 v[156:159], v234 offset:1280
    v_mfma_f32_16x16x32_bf16 v[32:35], v[224:227], v[188:191], v[32:35]
    ds_read_b128 v[160:163], v234 offset:1536
    v_mfma_f32_16x16x32_bf16 v[36:39], v[228:231], v[188:191], v[36:39]
    ds_read_b128 v[164:167], v234 offset:1792
    v_mfma_f32_16x16x32_bf16 v[40:43], v[216:219], v[192:195], v[40:43]
    ds_read_b128 v[168:171], v235 offset:0
    v_mfma_f32_16x16x32_bf16 v[44:47], v[220:223], v[192:195], v[44:47]
    ds_read_b128 v[172:175], v235 offset:64
    v_mfma_f32_16x16x32_bf16 v[48:51], v[224:227], v[192:195], v[48:51]
    ds_read_b128 v[176:179], v235 offset:512
    v_mfma_f32_16x16x32_bf16 v[52:55], v[228:231], v[192:195], v[52:55]
    ds_read_b128 v[180:183], v235 offset:576
    v_mfma_f32_16x16x32_bf16 v[56:59], v[216:219], v[196:199], v[56:59]
    v_mfma_f32_16x16x32_bf16 v[60:63], v[220:223], v[196:199], v[60:63]
    v_mfma_f32_16x16x32_bf16 v[64:67], v[224:227], v[196:199], v[64:67]
    v_mfma_f32_16x16x32_bf16 v[68:71], v[228:231], v[196:199], v[68:71]
    v_mfma_f32_16x16x32_bf16 v[72:75], v[216:219], v[200:203], v[72:75]
    v_mfma_f32_16x16x32_bf16 v[76:79], v[220:223], v[200:203], v[76:79]
    v_mfma_f32_16x16x32_bf16 v[80:83], v[224:227], v[200:203], v[80:83]
    v_mfma_f32_16x16x32_bf16 v[84:87], v[228:231], v[200:203], v[84:87]
    v_mfma_f32_16x16x32_bf16 v[88:91], v[216:219], v[204:207], v[88:91]
    v_mfma_f32_16x16x32_bf16 v[92:95], v[220:223], v[204:207], v[92:95]
    v_mfma_f32_16x16x32_bf16 v[96:99], v[224:227], v[204:207], v[96:99]
    v_mfma_f32_16x16x32_bf16 v[100:103], v[228:231], v[204:207], v[100:103]
    v_mfma_f32_16x16x32_bf16 v[104:107], v[216:219], v[208:211], v[104:107]
    v_mfma_f32_16x16x32_bf16 v[108:111], v[220:223], v[208:211], v[108:111]
    v_mfma_f32_16x16x32_bf16 v[112:115], v[224:227], v[208:211], v[112:115]
    v_mfma_f32_16x16x32_bf16 v[116:119], v[228:231], v[208:211], v[116:119]
    v_mfma_f32_16x16x32_bf16 v[120:123], v[216:219], v[212:215], v[120:123]
    v_mfma_f32_16x16x32_bf16 v[124:127], v[220:223], v[212:215], v[124:127]
    v_mfma_f32_16x16x32_bf16 v[128:131], v[224:227], v[212:215], v[128:131]
    v_mfma_f32_16x16x32_bf16 v[132:135], v[228:231], v[212:215], v[132:135]
    s_waitcnt lgkmcnt(0)
.p2align 3
L_fc_epi:
    v_pk_fma_f32 v[8:9], v[136:137], v[168:169], v[8:9] op_sel_hi:[0,1,1] neg_lo:[1,0,0] neg_hi:[1,0,0]
    v_pk_fma_f32 v[16:17], v[136:137], v[176:177], v[16:17] op_sel_hi:[0,1,1] neg_lo:[1,0,0] neg_hi:[1,0,0]
    v_pk_fma_f32 v[10:11], v[136:137], v[170:171], v[10:11] op_sel_hi:[0,1,1] neg_lo:[1,0,0] neg_hi:[1,0,0]
    v_pk_fma_f32 v[18:19], v[136:137], v[178:179], v[18:19] op_sel_hi:[0,1,1] neg_lo:[1,0,0] neg_hi:[1,0,0]
    v_pk_fma_f32 v[12:13], v[136:137], v[172:173], v[12:13] op_sel_hi:[0,1,1] neg_lo:[1,0,0] neg_hi:[1,0,0]
    v_pk_fma_f32 v[20:21], v[136:137], v[180:181], v[20:21] op_sel_hi:[0,1,1] neg_lo:[1,0,0] neg_hi:[1,0,0]
    v_pk_fma_f32 v[14:15], v[136:137], v[174:175], v[14:15] op_sel_hi:[0,1,1] neg_lo:[1,0,0] neg_hi:[1,0,0]
    v_pk_fma_f32 v[22:23], v[136:137], v[182:183], v[22:23] op_sel_hi:[0,1,1] neg_lo:[1,0,0] neg_hi:[1,0,0]
    v_pk_mul_f32 v[238:239], v[8:9], v[136:137] op_sel:[0,1] op_sel_hi:[1,1]
    v_pk_mul_f32 v[240:241], v[10:11], v[136:137] op_sel:[0,1] op_sel_hi:[1,1]
    v_pk_mul_f32 v[242:243], v[12:13], v[136:137] op_sel:[0,1] op_sel_hi:[1,1]
    v_pk_mul_f32 v[244:245], v[14:15], v[136:137] op_sel:[0,1] op_sel_hi:[1,1]
    v_exp_f32 v238, v238
    v_exp_f32 v239, v239
    v_exp_f32 v240, v240
    v_exp_f32 v241, v241
    v_exp_f32 v242, v242
    v_exp_f32 v243, v243
    v_exp_f32 v244, v244
    v_exp_f32 v245, v245
    v_pk_mul_f32 v[8:9], v[8:9], v[16:17]
    v_pk_fma_f32 v[238:239], v[238:239], v[138:139], v[138:139] op_sel_hi:[1,0,0]
    v_pk_mul_f32 v[10:11], v[10:11], v[18:19]
    v_pk_fma_f32 v[240:241], v[240:241], v[138:139], v[138:139] op_sel_hi:[1,0,0]
    v_pk_mul_f32 v[12:13], v[12:13], v[20:21]
    v_pk_fma_f32 v[242:243], v[242:243], v[138:139], v[138:139] op_sel_hi:[1,0,0]
    v_pk_mul_f32 v[14:15], v[14:15], v[22:23]
    v_pk_fma_f32 v[244:245], v[244:245], v[138:139], v[138:139] op_sel_hi:[1,0,0]
    v_rcp_f32 v238, v238
    v_rcp_f32 v239, v239
    v_rcp_f32 v240, v240
    v_rcp_f32 v241, v241
    v_rcp_f32 v242, v242
    v_rcp_f32 v243, v243
    v_rcp_f32 v244, v244
    v_rcp_f32 v245, v245
    s_add_u32 s60, s57, 49152
    v_pk_mul_f32 v[8:9], v[8:9], v[238:239]
    v_pk_mul_f32 v[10:11], v[10:11], v[240:241]
    v_pk_mul_f32 v[12:13], v[12:13], v[242:243]
    v_pk_mul_f32 v[14:15], v[14:15], v[244:245]
    v_cvt_pk_bf16_f32 v184, v8, v9
    v_cvt_pk_bf16_f32 v185, v10, v11
    v_cvt_pk_bf16_f32 v186, v12, v13
    v_cvt_pk_bf16_f32 v187, v14, v15
    buffer_store_dwordx4 v[184:187], v236, s[8:11], s60 offen sc1
    v_pk_fma_f32 v[24:25], v[140:141], v[168:169], v[24:25] op_sel_hi:[0,1,1] neg_lo:[1,0,0] neg_hi:[1,0,0]
    v_pk_fma_f32 v[32:33], v[140:141], v[176:177], v[32:33] op_sel_hi:[0,1,1] neg_lo:[1,0,0] neg_hi:[1,0,0]
    v_pk_fma_f32 v[26:27], v[140:141], v[170:171], v[26:27] op_sel_hi:[0,1,1] neg_lo:[1,0,0] neg_hi:[1,0,0]
    v_pk_fma_f32 v[34:35], v[140:141], v[178:179], v[34:35] op_sel_hi:[0,1,1] neg_lo:[1,0,0] neg_hi:[1,0,0]
    v_pk_fma_f32 v[28:29], v[140:141], v[172:173], v[28:29] op_sel_hi:[0,1,1] neg_lo:[1,0,0] neg_hi:[1,0,0]
    v_pk_fma_f32 v[36:37], v[140:141], v[180:181], v[36:37] op_sel_hi:[0,1,1] neg_lo:[1,0,0] neg_hi:[1,0,0]
    v_pk_fma_f32 v[30:31], v[140:141], v[174:175], v[30:31] op_sel_hi:[0,1,1] neg_lo:[1,0,0] neg_hi:[1,0,0]
    v_pk_fma_f32 v[38:39], v[140:141], v[182:183], v[38:39] op_sel_hi:[0,1,1] neg_lo:[1,0,0] neg_hi:[1,0,0]
    v_pk_mul_f32 v[246:247], v[24:25], v[140:141] op_sel:[0,1] op_sel_hi:[1,1]
    v_pk_mul_f32 v[248:249], v[26:27], v[140:141] op_sel:[0,1] op_sel_hi:[1,1]
    v_pk_mul_f32 v[250:251], v[28:29], v[140:141] op_sel:[0,1] op_sel_hi:[1,1]
    v_pk_mul_f32 v[252:253], v[30:31], v[140:141] op_sel:[0,1] op_sel_hi:[1,1]
    v_exp_f32 v246, v246
    v_exp_f32 v247, v247
    v_exp_f32 v248, v248
    v_exp_f32 v249, v249
    v_exp_f32 v250, v250
    v_exp_f32 v251, v251
    v_exp_f32 v252, v252
    v_exp_f32 v253, v253
    v_pk_mul_f32 v[24:25], v[24:25], v[32:33]
    v_pk_fma_f32 v[246:247], v[246:247], v[142:143], v[142:143] op_sel_hi:[1,0,0]
    v_pk_mul_f32 v[26:27], v[26:27], v[34:35]
    v_pk_fma_f32 v[248:249], v[248:249], v[142:143], v[142:143] op_sel_hi:[1,0,0]
    v_pk_mul_f32 v[28:29], v[28:29], v[36:37]
    v_pk_fma_f32 v[250:251], v[250:251], v[142:143], v[142:143] op_sel_hi:[1,0,0]
    v_pk_mul_f32 v[30:31], v[30:31], v[38:39]
    v_pk_fma_f32 v[252:253], v[252:253], v[142:143], v[142:143] op_sel_hi:[1,0,0]
    v_rcp_f32 v246, v246
    v_rcp_f32 v247, v247
    v_rcp_f32 v248, v248
    v_rcp_f32 v249, v249
    v_rcp_f32 v250, v250
    v_rcp_f32 v251, v251
    v_rcp_f32 v252, v252
    v_rcp_f32 v253, v253
    s_add_u32 s61, s57, 98304
    v_pk_mul_f32 v[24:25], v[24:25], v[246:247]
    v_pk_mul_f32 v[26:27], v[26:27], v[248:249]
    v_pk_mul_f32 v[28:29], v[28:29], v[250:251]
    v_pk_mul_f32 v[30:31], v[30:31], v[252:253]
    v_cvt_pk_bf16_f32 v188, v24, v25
    v_cvt_pk_bf16_f32 v189, v26, v27
    v_cvt_pk_bf16_f32 v190, v28, v29
    v_cvt_pk_bf16_f32 v191, v30, v31
    buffer_store_dwordx4 v[188:191], v236, s[8:11], s61 offen sc1
    v_pk_fma_f32 v[40:41], v[144:145], v[168:169], v[40:41] op_sel_hi:[0,1,1] neg_lo:[1,0,0] neg_hi:[1,0,0]
    v_pk_fma_f32 v[48:49], v[144:145], v[176:177], v[48:49] op_sel_hi:[0,1,1] neg_lo:[1,0,0] neg_hi:[1,0,0]
    v_pk_fma_f32 v[42:43], v[144:145], v[170:171], v[42:43] op_sel_hi:[0,1,1] neg_lo:[1,0,0] neg_hi:[1,0,0]
    v_pk_fma_f32 v[50:51], v[144:145], v[178:179], v[50:51] op_sel_hi:[0,1,1] neg_lo:[1,0,0] neg_hi:[1,0,0]
    v_pk_fma_f32 v[44:45], v[144:145], v[172:173], v[44:45] op_sel_hi:[0,1,1] neg_lo:[1,0,0] neg_hi:[1,0,0]
    v_pk_fma_f32 v[52:53], v[144:145], v[180:181], v[52:53] op_sel_hi:[0,1,1] neg_lo:[1,0,0] neg_hi:[1,0,0]
    v_pk_fma_f32 v[46:47], v[144:145], v[174:175], v[46:47] op_sel_hi:[0,1,1] neg_lo:[1,0,0] neg_hi:[1,0,0]
    v_pk_fma_f32 v[54:55], v[144:145], v[182:183], v[54:55] op_sel_hi:[0,1,1] neg_lo:[1,0,0] neg_hi:[1,0,0]
    v_pk_mul_f32 v[238:239], v[40:41], v[144:145] op_sel:[0,1] op_sel_hi:[1,1]
    v_pk_mul_f32 v[240:241], v[42:43], v[144:145] op_sel:[0,1] op_sel_hi:[1,1]
    v_pk_mul_f32 v[242:243], v[44:45], v[144:145] op_sel:[0,1] op_sel_hi:[1,1]
    v_pk_mul_f32 v[244:245], v[46:47], v[144:145] op_sel:[0,1] op_sel_hi:[1,1]
    v_exp_f32 v238, v238
    v_exp_f32 v239, v239
    v_exp_f32 v240, v240
    v_exp_f32 v241, v241
    v_exp_f32 v242, v242
    v_exp_f32 v243, v243
    v_exp_f32 v244, v244
    v_exp_f32 v245, v245
    v_pk_mul_f32 v[40:41], v[40:41], v[48:49]
    v_pk_fma_f32 v[238:239], v[238:239], v[146:147], v[146:147] op_sel_hi:[1,0,0]
    v_pk_mul_f32 v[42:43], v[42:43], v[50:51]
    v_pk_fma_f32 v[240:241], v[240:241], v[146:147], v[146:147] op_sel_hi:[1,0,0]
    v_pk_mul_f32 v[44:45], v[44:45], v[52:53]
    v_pk_fma_f32 v[242:243], v[242:243], v[146:147], v[146:147] op_sel_hi:[1,0,0]
    v_pk_mul_f32 v[46:47], v[46:47], v[54:55]
    v_pk_fma_f32 v[244:245], v[244:245], v[146:147], v[146:147] op_sel_hi:[1,0,0]
    v_rcp_f32 v238, v238
    v_rcp_f32 v239, v239
    v_rcp_f32 v240, v240
    v_rcp_f32 v241, v241
    v_rcp_f32 v242, v242
    v_rcp_f32 v243, v243
    v_rcp_f32 v244, v244
    v_rcp_f32 v245, v245
    s_add_u32 s62, s57, 147456
    v_pk_mul_f32 v[40:41], v[40:41], v[238:239]
    v_pk_mul_f32 v[42:43], v[42:43], v[240:241]
    v_pk_mul_f32 v[44:45], v[44:45], v[242:243]
    v_pk_mul_f32 v[46:47], v[46:47], v[244:245]
    v_cvt_pk_bf16_f32 v192, v40, v41
    v_cvt_pk_bf16_f32 v193, v42, v43
    v_cvt_pk_bf16_f32 v194, v44, v45
    v_cvt_pk_bf16_f32 v195, v46, v47
    buffer_store_dwordx4 v[192:195], v236, s[8:11], s62 offen sc1
    v_pk_fma_f32 v[56:57], v[148:149], v[168:169], v[56:57] op_sel_hi:[0,1,1] neg_lo:[1,0,0] neg_hi:[1,0,0]
    v_pk_fma_f32 v[64:65], v[148:149], v[176:177], v[64:65] op_sel_hi:[0,1,1] neg_lo:[1,0,0] neg_hi:[1,0,0]
    v_pk_fma_f32 v[58:59], v[148:149], v[170:171], v[58:59] op_sel_hi:[0,1,1] neg_lo:[1,0,0] neg_hi:[1,0,0]
    v_pk_fma_f32 v[66:67], v[148:149], v[178:179], v[66:67] op_sel_hi:[0,1,1] neg_lo:[1,0,0] neg_hi:[1,0,0]
    v_pk_fma_f32 v[60:61], v[148:149], v[172:173], v[60:61] op_sel_hi:[0,1,1] neg_lo:[1,0,0] neg_hi:[1,0,0]
    v_pk_fma_f32 v[68:69], v[148:149], v[180:181], v[68:69] op_sel_hi:[0,1,1] neg_lo:[1,0,0] neg_hi:[1,0,0]
    v_pk_fma_f32 v[62:63], v[148:149], v[174:175], v[62:63] op_sel_hi:[0,1,1] neg_lo:[1,0,0] neg_hi:[1,0,0]
    v_pk_fma_f32 v[70:71], v[148:149], v[182:183], v[70:71] op_sel_hi:[0,1,1] neg_lo:[1,0,0] neg_hi:[1,0,0]
    v_pk_mul_f32 v[246:247], v[56:57], v[148:149] op_sel:[0,1] op_sel_hi:[1,1]
    v_pk_mul_f32 v[248:249], v[58:59], v[148:149] op_sel:[0,1] op_sel_hi:[1,1]
    v_pk_mul_f32 v[250:251], v[60:61], v[148:149] op_sel:[0,1] op_sel_hi:[1,1]
    v_pk_mul_f32 v[252:253], v[62:63], v[148:149] op_sel:[0,1] op_sel_hi:[1,1]
    v_exp_f32 v246, v246
    v_exp_f32 v247, v247
    v_exp_f32 v248, v248
    v_exp_f32 v249, v249
    v_exp_f32 v250, v250
    v_exp_f32 v251, v251
    v_exp_f32 v252, v252
    v_exp_f32 v253, v253
    v_pk_mul_f32 v[56:57], v[56:57], v[64:65]
    v_pk_fma_f32 v[246:247], v[246:247], v[150:151], v[150:151] op_sel_hi:[1,0,0]
    v_pk_mul_f32 v[58:59], v[58:59], v[66:67]
    v_pk_fma_f32 v[248:249], v[248:249], v[150:151], v[150:151] op_sel_hi:[1,0,0]
    v_pk_mul_f32 v[60:61], v[60:61], v[68:69]
    v_pk_fma_f32 v[250:251], v[250:251], v[150:151], v[150:151] op_sel_hi:[1,0,0]
    v_pk_mul_f32 v[62:63], v[62:63], v[70:71]
    v_pk_fma_f32 v[252:253], v[252:253], v[150:151], v[150:151] op_sel_hi:[1,0,0]
    v_rcp_f32 v246, v246
    v_rcp_f32 v247, v247
    v_rcp_f32 v248, v248
    v_rcp_f32 v249, v249
    v_rcp_f32 v250, v250
    v_rcp_f32 v251, v251
    v_rcp_f32 v252, v252
    v_rcp_f32 v253, v253
    s_add_u32 s63, s57, 196608
    v_pk_mul_f32 v[56:57], v[56:57], v[246:247]
    v_pk_mul_f32 v[58:59], v[58:59], v[248:249]
    v_pk_mul_f32 v[60:61], v[60:61], v[250:251]
    v_pk_mul_f32 v[62:63], v[62:63], v[252:253]
    v_cvt_pk_bf16_f32 v196, v56, v57
    v_cvt_pk_bf16_f32 v197, v58, v59
    v_cvt_pk_bf16_f32 v198, v60, v61
    v_cvt_pk_bf16_f32 v199, v62, v63
    buffer_store_dwordx4 v[196:199], v236, s[8:11], s63 offen sc1
    v_pk_fma_f32 v[72:73], v[152:153], v[168:169], v[72:73] op_sel_hi:[0,1,1] neg_lo:[1,0,0] neg_hi:[1,0,0]
    v_pk_fma_f32 v[80:81], v[152:153], v[176:177], v[80:81] op_sel_hi:[0,1,1] neg_lo:[1,0,0] neg_hi:[1,0,0]
    v_pk_fma_f32 v[74:75], v[152:153], v[170:171], v[74:75] op_sel_hi:[0,1,1] neg_lo:[1,0,0] neg_hi:[1,0,0]
    v_pk_fma_f32 v[82:83], v[152:153], v[178:179], v[82:83] op_sel_hi:[0,1,1] neg_lo:[1,0,0] neg_hi:[1,0,0]
    v_pk_fma_f32 v[76:77], v[152:153], v[172:173], v[76:77] op_sel_hi:[0,1,1] neg_lo:[1,0,0] neg_hi:[1,0,0]
    v_pk_fma_f32 v[84:85], v[152:153], v[180:181], v[84:85] op_sel_hi:[0,1,1] neg_lo:[1,0,0] neg_hi:[1,0,0]
    v_pk_fma_f32 v[78:79], v[152:153], v[174:175], v[78:79] op_sel_hi:[0,1,1] neg_lo:[1,0,0] neg_hi:[1,0,0]
    v_pk_fma_f32 v[86:87], v[152:153], v[182:183], v[86:87] op_sel_hi:[0,1,1] neg_lo:[1,0,0] neg_hi:[1,0,0]
    v_pk_mul_f32 v[238:239], v[72:73], v[152:153] op_sel:[0,1] op_sel_hi:[1,1]
    v_pk_mul_f32 v[240:241], v[74:75], v[152:153] op_sel:[0,1] op_sel_hi:[1,1]
    v_pk_mul_f32 v[242:243], v[76:77], v[152:153] op_sel:[0,1] op_sel_hi:[1,1]
    v_pk_mul_f32 v[244:245], v[78:79], v[152:153] op_sel:[0,1] op_sel_hi:[1,1]
    v_exp_f32 v238, v238
    v_exp_f32 v239, v239
    v_exp_f32 v240, v240
    v_exp_f32 v241, v241
    v_exp_f32 v242, v242
    v_exp_f32 v243, v243
    v_exp_f32 v244, v244
    v_exp_f32 v245, v245
    v_pk_mul_f32 v[72:73], v[72:73], v[80:81]
    v_pk_fma_f32 v[238:239], v[238:239], v[154:155], v[154:155] op_sel_hi:[1,0,0]
    v_pk_mul_f32 v[74:75], v[74:75], v[82:83]
    v_pk_fma_f32 v[240:241], v[240:241], v[154:155], v[154:155] op_sel_hi:[1,0,0]
    v_pk_mul_f32 v[76:77], v[76:77], v[84:85]
    v_pk_fma_f32 v[242:243], v[242:243], v[154:155], v[154:155] op_sel_hi:[1,0,0]
    v_pk_mul_f32 v[78:79], v[78:79], v[86:87]
    v_pk_fma_f32 v[244:245], v[244:245], v[154:155], v[154:155] op_sel_hi:[1,0,0]
    v_rcp_f32 v238, v238
    v_rcp_f32 v239, v239
    v_rcp_f32 v240, v240
    v_rcp_f32 v241, v241
    v_rcp_f32 v242, v242
    v_rcp_f32 v243, v243
    v_rcp_f32 v244, v244
    v_rcp_f32 v245, v245
    s_add_u32 s64, s57, 245760
    v_pk_mul_f32 v[72:73], v[72:73], v[238:239]
    v_pk_mul_f32 v[74:75], v[74:75], v[240:241]
    v_pk_mul_f32 v[76:77], v[76:77], v[242:243]
    v_pk_mul_f32 v[78:79], v[78:79], v[244:245]
    v_cvt_pk_bf16_f32 v200, v72, v73
    v_cvt_pk_bf16_f32 v201, v74, v75
    v_cvt_pk_bf16_f32 v202, v76, v77
    v_cvt_pk_bf16_f32 v203, v78, v79
    buffer_store_dwordx4 v[200:203], v236, s[8:11], s64 offen sc1
    v_pk_fma_f32 v[88:89], v[156:157], v[168:169], v[88:89] op_sel_hi:[0,1,1] neg_lo:[1,0,0] neg_hi:[1,0,0]
    v_pk_fma_f32 v[96:97], v[156:157], v[176:177], v[96:97] op_sel_hi:[0,1,1] neg_lo:[1,0,0] neg_hi:[1,0,0]
    v_pk_fma_f32 v[90:91], v[156:157], v[170:171], v[90:91] op_sel_hi:[0,1,1] neg_lo:[1,0,0] neg_hi:[1,0,0]
    v_pk_fma_f32 v[98:99], v[156:157], v[178:179], v[98:99] op_sel_hi:[0,1,1] neg_lo:[1,0,0] neg_hi:[1,0,0]
    v_pk_fma_f32 v[92:93], v[156:157], v[172:173], v[92:93] op_sel_hi:[0,1,1] neg_lo:[1,0,0] neg_hi:[1,0,0]
    v_pk_fma_f32 v[100:101], v[156:157], v[180:181], v[100:101] op_sel_hi:[0,1,1] neg_lo:[1,0,0] neg_hi:[1,0,0]
    v_pk_fma_f32 v[94:95], v[156:157], v[174:175], v[94:95] op_sel_hi:[0,1,1] neg_lo:[1,0,0] neg_hi:[1,0,0]
    v_pk_fma_f32 v[102:103], v[156:157], v[182:183], v[102:103] op_sel_hi:[0,1,1] neg_lo:[1,0,0] neg_hi:[1,0,0]
    v_pk_mul_f32 v[246:247], v[88:89], v[156:157] op_sel:[0,1] op_sel_hi:[1,1]
    v_pk_mul_f32 v[248:249], v[90:91], v[156:157] op_sel:[0,1] op_sel_hi:[1,1]
    v_pk_mul_f32 v[250:251], v[92:93], v[156:157] op_sel:[0,1] op_sel_hi:[1,1]
    v_pk_mul_f32 v[252:253], v[94:95], v[156:157] op_sel:[0,1] op_sel_hi:[1,1]
    v_exp_f32 v246, v246
    v_exp_f32 v247, v247
    v_exp_f32 v248, v248
    v_exp_f32 v249, v249
    v_exp_f32 v250, v250
    v_exp_f32 v251, v251
    v_exp_f32 v252, v252
    v_exp_f32 v253, v253
    v_pk_mul_f32 v[88:89], v[88:89], v[96:97]
    v_pk_fma_f32 v[246:247], v[246:247], v[158:159], v[158:159] op_sel_hi:[1,0,0]
    v_pk_mul_f32 v[90:91], v[90:91], v[98:99]
    v_pk_fma_f32 v[248:249], v[248:249], v[158:159], v[158:159] op_sel_hi:[1,0,0]
    v_pk_mul_f32 v[92:93], v[92:93], v[100:101]
    v_pk_fma_f32 v[250:251], v[250:251], v[158:159], v[158:159] op_sel_hi:[1,0,0]
    v_pk_mul_f32 v[94:95], v[94:95], v[102:103]
    v_pk_fma_f32 v[252:253], v[252:253], v[158:159], v[158:159] op_sel_hi:[1,0,0]
    v_rcp_f32 v246, v246
    v_rcp_f32 v247, v247
    v_rcp_f32 v248, v248
    v_rcp_f32 v249, v249
    v_rcp_f32 v250, v250
    v_rcp_f32 v251, v251
    v_rcp_f32 v252, v252
    v_rcp_f32 v253, v253
    s_add_u32 s65, s57, 294912
    v_pk_mul_f32 v[88:89], v[88:89], v[246:247]
    v_pk_mul_f32 v[90:91], v[90:91], v[248:249]
    v_pk_mul_f32 v[92:93], v[92:93], v[250:251]
    v_pk_mul_f32 v[94:95], v[94:95], v[252:253]
    v_cvt_pk_bf16_f32 v204, v88, v89
    v_cvt_pk_bf16_f32 v205, v90, v91
    v_cvt_pk_bf16_f32 v206, v92, v93
    v_cvt_pk_bf16_f32 v207, v94, v95
    buffer_store_dwordx4 v[204:207], v236, s[8:11], s65 offen sc1
    v_pk_fma_f32 v[104:105], v[160:161], v[168:169], v[104:105] op_sel_hi:[0,1,1] neg_lo:[1,0,0] neg_hi:[1,0,0]
    v_pk_fma_f32 v[112:113], v[160:161], v[176:177], v[112:113] op_sel_hi:[0,1,1] neg_lo:[1,0,0] neg_hi:[1,0,0]
    v_pk_fma_f32 v[106:107], v[160:161], v[170:171], v[106:107] op_sel_hi:[0,1,1] neg_lo:[1,0,0] neg_hi:[1,0,0]
    v_pk_fma_f32 v[114:115], v[160:161], v[178:179], v[114:115] op_sel_hi:[0,1,1] neg_lo:[1,0,0] neg_hi:[1,0,0]
    v_pk_fma_f32 v[108:109], v[160:161], v[172:173], v[108:109] op_sel_hi:[0,1,1] neg_lo:[1,0,0] neg_hi:[1,0,0]
    v_pk_fma_f32 v[116:117], v[160:161], v[180:181], v[116:117] op_sel_hi:[0,1,1] neg_lo:[1,0,0] neg_hi:[1,0,0]
    v_pk_fma_f32 v[110:111], v[160:161], v[174:175], v[110:111] op_sel_hi:[0,1,1] neg_lo:[1,0,0] neg_hi:[1,0,0]
    v_pk_fma_f32 v[118:119], v[160:161], v[182:183], v[118:119] op_sel_hi:[0,1,1] neg_lo:[1,0,0] neg_hi:[1,0,0]
    v_pk_mul_f32 v[238:239], v[104:105], v[160:161] op_sel:[0,1] op_sel_hi:[1,1]
    v_pk_mul_f32 v[240:241], v[106:107], v[160:161] op_sel:[0,1] op_sel_hi:[1,1]
    v_pk_mul_f32 v[242:243], v[108:109], v[160:161] op_sel:[0,1] op_sel_hi:[1,1]
    v_pk_mul_f32 v[244:245], v[110:111], v[160:161] op_sel:[0,1] op_sel_hi:[1,1]
    v_exp_f32 v238, v238
    v_exp_f32 v239, v239
    v_exp_f32 v240, v240
    v_exp_f32 v241, v241
    v_exp_f32 v242, v242
    v_exp_f32 v243, v243
    v_exp_f32 v244, v244
    v_exp_f32 v245, v245
    v_pk_mul_f32 v[104:105], v[104:105], v[112:113]
    v_pk_fma_f32 v[238:239], v[238:239], v[162:163], v[162:163] op_sel_hi:[1,0,0]
    v_pk_mul_f32 v[106:107], v[106:107], v[114:115]
    v_pk_fma_f32 v[240:241], v[240:241], v[162:163], v[162:163] op_sel_hi:[1,0,0]
    v_pk_mul_f32 v[108:109], v[108:109], v[116:117]
    v_pk_fma_f32 v[242:243], v[242:243], v[162:163], v[162:163] op_sel_hi:[1,0,0]
    v_pk_mul_f32 v[110:111], v[110:111], v[118:119]
    v_pk_fma_f32 v[244:245], v[244:245], v[162:163], v[162:163] op_sel_hi:[1,0,0]
    v_rcp_f32 v238, v238
    v_rcp_f32 v239, v239
    v_rcp_f32 v240, v240
    v_rcp_f32 v241, v241
    v_rcp_f32 v242, v242
    v_rcp_f32 v243, v243
    v_rcp_f32 v244, v244
    v_rcp_f32 v245, v245
    s_add_u32 s66, s57, 344064
    v_pk_mul_f32 v[104:105], v[104:105], v[238:239]
    v_pk_mul_f32 v[106:107], v[106:107], v[240:241]
    v_pk_mul_f32 v[108:109], v[108:109], v[242:243]
    v_pk_mul_f32 v[110:111], v[110:111], v[244:245]
    v_cvt_pk_bf16_f32 v208, v104, v105
    v_cvt_pk_bf16_f32 v209, v106, v107
    v_cvt_pk_bf16_f32 v210, v108, v109
    v_cvt_pk_bf16_f32 v211, v110, v111
    buffer_store_dwordx4 v[208:211], v236, s[8:11], s66 offen sc1
    v_pk_fma_f32 v[120:121], v[164:165], v[168:169], v[120:121] op_sel_hi:[0,1,1] neg_lo:[1,0,0] neg_hi:[1,0,0]
    v_pk_fma_f32 v[128:129], v[164:165], v[176:177], v[128:129] op_sel_hi:[0,1,1] neg_lo:[1,0,0] neg_hi:[1,0,0]
    v_pk_fma_f32 v[122:123], v[164:165], v[170:171], v[122:123] op_sel_hi:[0,1,1] neg_lo:[1,0,0] neg_hi:[1,0,0]
    v_pk_fma_f32 v[130:131], v[164:165], v[178:179], v[130:131] op_sel_hi:[0,1,1] neg_lo:[1,0,0] neg_hi:[1,0,0]
    v_pk_fma_f32 v[124:125], v[164:165], v[172:173], v[124:125] op_sel_hi:[0,1,1] neg_lo:[1,0,0] neg_hi:[1,0,0]
    v_pk_fma_f32 v[132:133], v[164:165], v[180:181], v[132:133] op_sel_hi:[0,1,1] neg_lo:[1,0,0] neg_hi:[1,0,0]
    v_pk_fma_f32 v[126:127], v[164:165], v[174:175], v[126:127] op_sel_hi:[0,1,1] neg_lo:[1,0,0] neg_hi:[1,0,0]
    v_pk_fma_f32 v[134:135], v[164:165], v[182:183], v[134:135] op_sel_hi:[0,1,1] neg_lo:[1,0,0] neg_hi:[1,0,0]
    v_pk_mul_f32 v[246:247], v[120:121], v[164:165] op_sel:[0,1] op_sel_hi:[1,1]
    v_pk_mul_f32 v[248:249], v[122:123], v[164:165] op_sel:[0,1] op_sel_hi:[1,1]
    v_pk_mul_f32 v[250:251], v[124:125], v[164:165] op_sel:[0,1] op_sel_hi:[1,1]
    v_pk_mul_f32 v[252:253], v[126:127], v[164:165] op_sel:[0,1] op_sel_hi:[1,1]
    v_exp_f32 v246, v246
    v_exp_f32 v247, v247
    v_exp_f32 v248, v248
    v_exp_f32 v249, v249
    v_exp_f32 v250, v250
    v_exp_f32 v251, v251
    v_exp_f32 v252, v252
    v_exp_f32 v253, v253
    v_pk_mul_f32 v[120:121], v[120:121], v[128:129]
    v_pk_fma_f32 v[246:247], v[246:247], v[166:167], v[166:167] op_sel_hi:[1,0,0]
    v_pk_mul_f32 v[122:123], v[122:123], v[130:131]
    v_pk_fma_f32 v[248:249], v[248:249], v[166:167], v[166:167] op_sel_hi:[1,0,0]
    v_pk_mul_f32 v[124:125], v[124:125], v[132:133]
    v_pk_fma_f32 v[250:251], v[250:251], v[166:167], v[166:167] op_sel_hi:[1,0,0]
    v_pk_mul_f32 v[126:127], v[126:127], v[134:135]
    v_pk_fma_f32 v[252:253], v[252:253], v[166:167], v[166:167] op_sel_hi:[1,0,0]
    v_rcp_f32 v246, v246
    v_rcp_f32 v247, v247
    v_rcp_f32 v248, v248
    v_rcp_f32 v249, v249
    v_rcp_f32 v250, v250
    v_rcp_f32 v251, v251
    v_rcp_f32 v252, v252
    v_rcp_f32 v253, v253
    s_add_u32 s67, s57, 393216
    v_pk_mul_f32 v[120:121], v[120:121], v[246:247]
    v_pk_mul_f32 v[122:123], v[122:123], v[248:249]
    v_pk_mul_f32 v[124:125], v[124:125], v[250:251]
    v_pk_mul_f32 v[126:127], v[126:127], v[252:253]
    v_cvt_pk_bf16_f32 v212, v120, v121
    v_cvt_pk_bf16_f32 v213, v122, v123
    v_cvt_pk_bf16_f32 v214, v124, v125
    v_cvt_pk_bf16_f32 v215, v126, v127
    buffer_store_dwordx4 v[212:215], v236, s[8:11], s67 offen sc1
    v_mov_b32 v2, 150528
    v_mov_b32 v3, 1
    s_mov_b64 exec, 1
    ds_add_u32 v2, v3
    s_mov_b64 exec, -1
    s_waitcnt vmcnt(0)
    v_mov_b32 v2, s12
    v_mov_b32 v3, s13
    s_mov_b64 exec, 1
    buffer_store_dwordx2 v[2:3], v237, s[8:11], 0 offen sc1
    s_mov_b64 exec, -1
    s_branch L_p2_mfma
L_p2_help:
    s_and_b32 s56, s48, 1
    s_lshr_b32 s57, s48, 1
    v_lshlrev_b32 v1, 3, v0
    s_add_u32 m0, s40, 0
    s_nop 0
    buffer_load_dwordx4 v228, s[4:7], s39 offen lds
    s_add_u32 m0, s40, 1024
    s_nop 0
    buffer_load_dwordx4 v229, s[4:7], s39 offen lds
    s_add_u32 m0, s40, 2048
    s_nop 0
    buffer_load_dwordx4 v230, s[4:7], s39 offen lds
    s_mul_i32 s61, s57, 71680
    s_mul_i32 s62, s56, 5120
    s_add_u32 s61, s61, s62
    v_add_u32 v6, s61, v2
    s_mul_i32 s61, s56, 71680
    s_mul_i32 s62, s57, 15360
    s_add_u32 s62, s62, s61
    s_add_u32 s62, s62, 51200
    v_add_u32 v7, s62, v2
    s_mul_i32 s62, s57, 5120
    s_sub_u32 s62, s61, s62
    s_add_u32 s62, s62, 61440
    v_add_u32 v8, s62, v2
    s_waitcnt vmcnt(0)
    ds_read_b128 v[96:99], v231 offset:0
    ds_read_b128 v[100:103], v231 offset:32
    ds_read_b128 v[104:107], v231 offset:64
    ds_read_b128 v[108:111], v231 offset:96
    ds_read_b128 v[112:115], v231 offset:128
    s_cmp_ge_u32 s50, 24
    s_cbranch_scc1 L_p2_sx
    v_mov_b32 v12, 150528
    s_mov_b32 s53, 0
L_p2_sq:
    ds_read_b32 v13, v12
    s_add_u32 s53, s53, 1
    s_cmp_gt_u32 s53, 0x100000
    s_cbranch_scc1 L_p2_sx
    s_waitcnt lgkmcnt(0)
    v_cmp_ne_u32 vcc, 4, v13
    s_cbranch_vccz L_p2_sx
    s_sleep 1
    s_branch L_p2_sq
L_p2_sx:
    s_mov_b32 s53, 0
L_p2_pd:
    buffer_load_dwordx2 v[254:255], v1, s[8:11], s38 offen sc1
    s_add_u32 s53, s53, 1
    s_cmp_gt_u32 s53, 0x100000
    s_cbranch_scc1 L_p2_pd_x
    s_waitcnt vmcnt(0)
L_p2_pd_c:
    v_cmp_ne_u64 vcc, s[12:13], v[254:255]
    s_cbranch_vccz L_p2_pd_x
    s_sleep 8
    s_branch L_p2_pd
L_p2_pd_x:
    buffer_load_dwordx4 v[56:59], v248, s[8:11], s36 offen sc1
    buffer_load_dwordx4 v[60:63], v249, s[8:11], s36 offen sc1
    buffer_load_dwordx4 v[64:67], v250, s[8:11], s36 offen sc1
    buffer_load_dwordx4 v[68:71], v251, s[8:11], s36 offen sc1
    buffer_load_dwordx4 v[72:75], v252, s[8:11], s36 offen sc1
    buffer_load_dwordx4 v[76:79], v248, s[8:11], s37 offen sc1
    buffer_load_dwordx4 v[80:83], v249, s[8:11], s37 offen sc1
    buffer_load_dwordx4 v[84:87], v250, s[8:11], s37 offen sc1
    buffer_load_dwordx4 v[88:91], v251, s[8:11], s37 offen sc1
    buffer_load_dwordx4 v[92:95], v252, s[8:11], s37 offen sc1
    s_waitcnt lgkmcnt(0)
    v_lshrrev_b32 v9, 5, v0
    v_lshlrev_b32 v9, 4, v9
    v_sub_u32 v9, 16, v9
    v_lshlrev_b32 v96, v9, v96
    v_and_b32 v16, 0xffff0000, v96
    v_lshlrev_b32 v97, v9, v97
    v_and_b32 v17, 0xffff0000, v97
    v_lshlrev_b32 v98, v9, v98
    v_and_b32 v18, 0xffff0000, v98
    v_lshlrev_b32 v99, v9, v99
    v_and_b32 v19, 0xffff0000, v99
    v_lshlrev_b32 v100, v9, v100
    v_and_b32 v20, 0xffff0000, v100
    v_lshlrev_b32 v101, v9, v101
    v_and_b32 v21, 0xffff0000, v101
    v_lshlrev_b32 v102, v9, v102
    v_and_b32 v22, 0xffff0000, v102
    v_lshlrev_b32 v103, v9, v103
    v_and_b32 v23, 0xffff0000, v103
    v_lshlrev_b32 v104, v9, v104
    v_and_b32 v24, 0xffff0000, v104
    v_lshlrev_b32 v105, v9, v105
    v_and_b32 v25, 0xffff0000, v105
    v_lshlrev_b32 v106, v9, v106
    v_and_b32 v26, 0xffff0000, v106
    v_lshlrev_b32 v107, v9, v107
    v_and_b32 v27, 0xffff0000, v107
    v_lshlrev_b32 v108, v9, v108
    v_and_b32 v28, 0xffff0000, v108
    v_lshlrev_b32 v109, v9, v109
    v_and_b32 v29, 0xffff0000, v109
    v_lshlrev_b32 v110, v9, v110
    v_and_b32 v30, 0xffff0000, v110
    v_lshlrev_b32 v111, v9, v111
    v_and_b32 v31, 0xffff0000, v111
    v_lshlrev_b32 v112, v9, v112
    v_and_b32 v32, 0xffff0000, v112
    v_lshlrev_b32 v113, v9, v113
    v_and_b32 v33, 0xffff0000, v113
    v_lshlrev_b32 v114, v9, v114
    v_and_b32 v34, 0xffff0000, v114
    v_lshlrev_b32 v115, v9, v115
    v_and_b32 v35, 0xffff0000, v115
    s_barrier
    s_waitcnt vmcnt(0)
    v_mfma_f32_16x16x32_bf16 v[16:19], v[56:59], v[232:235], v[16:19]
    v_mfma_f32_16x16x32_bf16 v[36:39], v[56:59], v[240:243], 0
    v_mfma_f32_16x16x32_bf16 v[20:23], v[60:63], v[232:235], v[20:23]
    v_mfma_f32_16x16x32_bf16 v[40:43], v[60:63], v[240:243], 0
    v_mfma_f32_16x16x32_bf16 v[24:27], v[64:67], v[232:235], v[24:27]
    v_mfma_f32_16x16x32_bf16 v[44:47], v[64:67], v[240:243], 0
    v_mfma_f32_16x16x32_bf16 v[28:31], v[68:71], v[232:235], v[28:31]
    v_mfma_f32_16x16x32_bf16 v[48:51], v[68:71], v[240:243], 0
    v_mfma_f32_16x16x32_bf16 v[32:35], v[72:75], v[232:235], v[32:35]
    v_mfma_f32_16x16x32_bf16 v[52:55], v[72:75], v[240:243], 0
    v_mfma_f32_16x16x32_bf16 v[16:19], v[76:79], v[236:239], v[16:19]
    v_mfma_f32_16x16x32_bf16 v[36:39], v[76:79], v[244:247], v[36:39]
    v_mfma_f32_16x16x32_bf16 v[20:23], v[80:83], v[236:239], v[20:23]
    v_mfma_f32_16x16x32_bf16 v[40:43], v[80:83], v[244:247], v[40:43]
    v_mfma_f32_16x16x32_bf16 v[24:27], v[84:87], v[236:239], v[24:27]
    v_mfma_f32_16x16x32_bf16 v[44:47], v[84:87], v[244:247], v[44:47]
    v_mfma_f32_16x16x32_bf16 v[28:31], v[88:91], v[236:239], v[28:31]
    v_mfma_f32_16x16x32_bf16 v[48:51], v[88:91], v[244:247], v[48:51]
    v_mfma_f32_16x16x32_bf16 v[32:35], v[92:95], v[236:239], v[32:35]
    v_mfma_f32_16x16x32_bf16 v[52:55], v[92:95], v[244:247], v[52:55]
    s_barrier
    ds_write_b128 v6, v[128:131] offset:0
    ds_write_b128 v6, v[132:135] offset:1024
    ds_write_b128 v6, v[136:139] offset:2048
    ds_write_b128 v6, v[140:143] offset:3072
    ds_write_b128 v6, v[144:147] offset:4096
    ds_write_b128 v6, v[148:151] offset:10240
    ds_write_b128 v6, v[152:155] offset:11264
    ds_write_b128 v6, v[156:159] offset:12288
    s_waitcnt lgkmcnt(0)
    s_barrier
    ds_write_b128 v6, v[160:163] offset:13312
    ds_write_b128 v6, v[164:167] offset:14336
    ds_write_b128 v6, v[168:171] offset:20480
    ds_write_b128 v6, v[172:175] offset:21504
    ds_write_b128 v6, v[176:179] offset:22528
    ds_write_b128 v6, v[180:183] offset:23552
    ds_write_b128 v6, v[184:187] offset:24576
    ds_write_b128 v6, v[188:191] offset:30720
    s_waitcnt lgkmcnt(0)
    s_barrier
    ds_write_b128 v6, v[192:195] offset:31744
    ds_write_b128 v6, v[196:199] offset:32768
    ds_write_b128 v6, v[200:203] offset:33792
    ds_write_b128 v6, v[204:207] offset:34816
    ds_write_b128 v6, v[208:211] offset:40960
    ds_write_b128 v6, v[212:215] offset:41984
    ds_write_b128 v6, v[216:219] offset:43008
    ds_write_b128 v6, v[220:223] offset:44032
    s_waitcnt lgkmcnt(0)
    s_barrier
    ds_write_b128 v6, v[224:227] offset:45056
    ds_write_b128 v7, v[16:19] offset:0
    ds_write_b128 v7, v[20:23] offset:1024
    ds_write_b128 v7, v[24:27] offset:2048
    ds_write_b128 v7, v[28:31] offset:3072
    ds_write_b128 v7, v[32:35] offset:4096
    s_waitcnt lgkmcnt(0)
    s_barrier
    ds_write_b128 v8, v[36:39] offset:0
    ds_write_b128 v8, v[40:43] offset:1024
    ds_write_b128 v8, v[44:47] offset:2048
    ds_write_b128 v8, v[48:51] offset:3072
    ds_write_b128 v8, v[52:55] offset:4096
    s_waitcnt lgkmcnt(0)
    s_barrier
    s_or_b32 s53, s2, s48
    s_cmp_eq_u32 s53, 0
    s_cbranch_scc0 L_ph_x
    v_mov_b32 v2, 0x18000
    v_mov_b32 v4, s12
    v_mov_b32 v5, s13
    s_mov_b64 exec, 1
    buffer_store_dwordx2 v[4:5], v2, s[8:11], 0 offen sc1
    s_mov_b64 exec, -1
L_ph_x:
    s_endpgm
L_p2_mfma:
    s_setprio 1
    s_and_b32 s56, s48, 1
    s_bfe_u32 s57, s48, 0x10001
    v_lshlrev_b32 v2, 4, v0
    s_mov_b32 s76, 0
    s_mul_i32 s77, s52, 245760
    s_mul_i32 s53, s76, 5120
    s_add_u32 s77, s77, s53
    s_add_u32 s77, s77, 0x100000
    s_sub_u32 s75, s77, 122880
    s_sub_u32 s76, 24, s76
    s_lshl_b32 s58, s56, 1
    s_add_u32 s59, s58, s57
    s_sub_u32 s58, s58, s57
    s_add_u32 s58, s58, 1
    s_lshl_b32 s61, s51, 2
    s_add_u32 s62, s61, s59
    s_mul_i32 s62, s62, 49152
    v_add_u32 v6, s62, v2
    s_add_u32 s62, s61, s58
    s_mul_i32 s62, s62, 49152
    v_add_u32 v7, s62, v2
    s_mul_i32 s62, s57, 24
    s_sub_u32 s62, s62, s76
    s_lshl_b32 s62, s62, 10
    s_add_u32 s63, s62, 0x600000
    s_add_u32 s62, s62, 0x606000
    s_mul_i32 s61, s57, 71680
    v_add_u32 v3, s61, v2
    v_add_u32 v4, 0xc800, v3
    s_lshl_b32 s60, s59, 9
    s_add_u32 s60, s60, s51
    s_mul_i32 s60, s60, 1280
    s_mul_i32 s61, s52, 160
    s_add_u32 s60, s60, s61
    s_and_b32 s74, s48, 3
    s_xor_b32 s73, s74, 2
    s_mul_i32 s73, s73, 5120
    s_add_u32 s73, s73, 143360
    s_mul_i32 s74, s74, 5120
    s_add_u32 s74, s74, 143360
    v_add_u32 v8, 0, v0
    v_mul_u32_u24 v9, 205, v8
    v_lshrrev_b32 v9, 11, v9
    v_mul_u32_u24 v10, 10, v9
    v_sub_u32 v8, v8, v10
    v_lshlrev_b32 v8, 4, v8
    v_mul_u32_u24 v10, 40960, v9
    v_add_u32 v10, v10, v8
    v_mul_u32_u24 v9, 176, v9
    v_add3_u32 v13, v9, v8, s74
    v_add_u32 v8, 64, v0
    v_mul_u32_u24 v9, 205, v8
    v_lshrrev_b32 v9, 11, v9
    v_mul_u32_u24 v11, 10, v9
    v_sub_u32 v8, v8, v11
    v_lshlrev_b32 v8, 4, v8
    v_mul_u32_u24 v11, 40960, v9
    v_add_u32 v11, v11, v8
    v_mul_u32_u24 v9, 176, v9
    v_add3_u32 v14, v9, v8, s74
    v_add_u32 v8, 128, v0
    v_mul_u32_u24 v9, 205, v8
    v_lshrrev_b32 v9, 11, v9
    v_mul_u32_u24 v12, 10, v9
    v_sub_u32 v8, v8, v12
    v_lshlrev_b32 v8, 4, v8
    v_mul_u32_u24 v12, 40960, v9
    v_add_u32 v12, v12, v8
    v_mul_u32_u24 v9, 176, v9
    v_add3_u32 v15, v9, v8, s74
    v_cmp_gt_u32 vcc, 32, v0
    v_mov_b32 v8, 0x7ffffff0
    s_nop 0
    v_cndmask_b32 v12, v8, v12, vcc
    v_and_b32 v8, 15, v0
    v_mul_u32_u24 v8, 176, v8
    v_bfe_u32 v9, v0, 4, 1
    v_lshl_add_u32 v8, v9, 4, v8
    v_lshrrev_b32 v9, 5, v0
    v_lshl_add_u32 v8, v9, 3, v8
    v_add_u32 v8, s74, v8
    v_add_u32 v9, s73, v2
    v_add_u32 v5, s74, v2
    s_mul_i32 s61, s56, 71680
    s_mul_i32 s53, s57, 10240
    s_add_u32 s61, s61, s53
    s_add_u32 s61, s61, 51200
    v_add_u32 v1, s61, v2
    s_lshr_b32 s64, s51, 1
    s_mul_i32 s64, s64, 512
    s_mul_i32 s65, s57, 192
    s_add_u32 s64, s64, s65
    s_add_u32 s64, s64, 0x0
    v_min_u32 v250, 23, v0
    s_mov_b32 s66, -1
    v_lshlrev_b32 v250, 3, v250
    s_barrier
    s_and_b32 s67, s66, 0xf
    s_cbranch_scc1 L_en0
L_en0_r:
    s_cmp_le_u32 s76, 0
    s_cselect_b32 s61, s63, s62
    s_add_u32 s61, s61, 0
    buffer_load_dwordx4 v[136:139], v6, s[8:11], s61 offen sc1
    buffer_load_dwordx4 v[140:143], v7, s[8:11], s61 offen sc1
    s_cmp_le_u32 s76, 1
    s_cselect_b32 s61, s63, s62
    s_add_u32 s61, s61, 1024
    buffer_load_dwordx4 v[144:147], v6, s[8:11], s61 offen sc1
    buffer_load_dwordx4 v[148:151], v7, s[8:11], s61 offen sc1
    s_cmp_le_u32 s76, 2
    s_cselect_b32 s61, s63, s62
    s_add_u32 s61, s61, 2048
    buffer_load_dwordx4 v[152:155], v6, s[8:11], s61 offen sc1
    buffer_load_dwordx4 v[156:159], v7, s[8:11], s61 offen sc1
    s_cmp_le_u32 s76, 3
    s_cselect_b32 s61, s63, s62
    s_add_u32 s61, s61, 3072
    buffer_load_dwordx4 v[160:163], v6, s[8:11], s61 offen sc1
    buffer_load_dwordx4 v[164:167], v7, s[8:11], s61 offen sc1
    s_and_b32 s67, s66, 0xf0
    s_cbranch_scc1 L_en1
L_en1_r:
    s_cmp_le_u32 s76, 4
    s_cselect_b32 s61, s63, s62
    s_add_u32 s61, s61, 4096
    buffer_load_dwordx4 v[168:171], v6, s[8:11], s61 offen sc1
    buffer_load_dwordx4 v[172:175], v7, s[8:11], s61 offen sc1
    s_cmp_le_u32 s76, 5
    s_cselect_b32 s61, s63, s62
    s_add_u32 s61, s61, 5120
    buffer_load_dwordx4 v[176:179], v6, s[8:11], s61 offen sc1
    buffer_load_dwordx4 v[180:183], v7, s[8:11], s61 offen sc1
    s_cmp_le_u32 s76, 6
    s_cselect_b32 s61, s63, s62
    s_add_u32 s61, s61, 6144
    buffer_load_dwordx4 v[184:187], v6, s[8:11], s61 offen sc1
    buffer_load_dwordx4 v[188:191], v7, s[8:11], s61 offen sc1
    s_cmp_le_u32 s76, 7
    s_cselect_b32 s61, s63, s62
    s_add_u32 s61, s61, 7168
    buffer_load_dwordx4 v[192:195], v6, s[8:11], s61 offen sc1
    buffer_load_dwordx4 v[196:199], v7, s[8:11], s61 offen sc1
    s_and_b32 s67, s66, 0xf00
    s_cbranch_scc1 L_en2
L_en2_r:
    s_cmp_le_u32 s76, 8
    s_cselect_b32 s61, s63, s62
    s_add_u32 s61, s61, 8192
    buffer_load_dwordx4 v[200:203], v6, s[8:11], s61 offen sc1
    buffer_load_dwordx4 v[204:207], v7, s[8:11], s61 offen sc1
    s_cmp_le_u32 s76, 9
    s_cselect_b32 s61, s63, s62
    s_add_u32 s61, s61, 9216
    buffer_load_dwordx4 v[208:211], v6, s[8:11], s61 offen sc1
    buffer_load_dwordx4 v[212:215], v7, s[8:11], s61 offen sc1
    ds_read_b128 v[56:59], v3 offset:0
    ds_read_b128 v[60:63], v3 offset:1024
    ds_read_b128 v[64:67], v3 offset:2048
    ds_read_b128 v[68:71], v3 offset:3072
    ds_read_b128 v[72:75], v3 offset:4096
    ds_read_b128 v[76:79], v3 offset:5120
    ds_read_b128 v[80:83], v3 offset:6144
    ds_read_b128 v[84:87], v3 offset:7168
    ds_read_b128 v[88:91], v3 offset:8192
    ds_read_b128 v[92:95], v3 offset:9216
    s_waitcnt vmcnt(18) lgkmcnt(5)
    v_mfma_f32_16x16x32_bf16 v[16:19], v[56:59], v[136:139], 0
    ds_read_b128 v[96:99], v3 offset:10240
    v_mfma_f32_16x16x32_bf16 v[36:39], v[56:59], v[140:143], 0
    ds_read_b128 v[100:103], v3 offset:11264
    v_mfma_f32_16x16x32_bf16 v[20:23], v[60:63], v[136:139], 0
    ds_read_b128 v[104:107], v3 offset:12288
    v_mfma_f32_16x16x32_bf16 v[40:43], v[60:63], v[140:143], 0
    ds_read_b128 v[108:111], v3 offset:13312
    v_mfma_f32_16x16x32_bf16 v[24:27], v[64:67], v[136:139], 0
    ds_read_b128 v[112:115], v3 offset:14336
    v_mfma_f32_16x16x32_bf16 v[44:47], v[64:67], v[140:143], 0
    s_cmp_le_u32 s76, 10
    s_cselect_b32 s61, s63, s62
    s_add_u32 s61, s61, 10240
    buffer_load_dwordx4 v[216:219], v6, s[8:11], s61 offen sc1
    buffer_load_dwordx4 v[220:223], v7, s[8:11], s61 offen sc1
    v_mfma_f32_16x16x32_bf16 v[28:31], v[68:71], v[136:139], 0
    v_mfma_f32_16x16x32_bf16 v[48:51], v[68:71], v[140:143], 0
    s_cmp_le_u32 s76, 11
    s_cselect_b32 s61, s63, s62
    s_add_u32 s61, s61, 11264
    buffer_load_dwordx4 v[224:227], v6, s[8:11], s61 offen sc1
    buffer_load_dwordx4 v[228:231], v7, s[8:11], s61 offen sc1
    v_mfma_f32_16x16x32_bf16 v[32:35], v[72:75], v[136:139], 0
    v_mfma_f32_16x16x32_bf16 v[52:55], v[72:75], v[140:143], 0
    s_waitcnt vmcnt(20) lgkmcnt(5)
    v_mfma_f32_16x16x32_bf16 v[16:19], v[76:79], v[144:147], v[16:19]
    ds_read_b128 v[116:119], v3 offset:15360
    v_mfma_f32_16x16x32_bf16 v[36:39], v[76:79], v[148:151], v[36:39]
    ds_read_b128 v[120:123], v3 offset:16384
    v_mfma_f32_16x16x32_bf16 v[20:23], v[80:83], v[144:147], v[20:23]
    ds_read_b128 v[124:127], v3 offset:17408
    v_mfma_f32_16x16x32_bf16 v[40:43], v[80:83], v[148:151], v[40:43]
    ds_read_b128 v[128:131], v3 offset:18432
    v_mfma_f32_16x16x32_bf16 v[24:27], v[84:87], v[144:147], v[24:27]
    ds_read_b128 v[132:135], v3 offset:19456
    v_mfma_f32_16x16x32_bf16 v[44:47], v[84:87], v[148:151], v[44:47]
    s_and_b32 s67, s66, 0xf000
    s_cbranch_scc1 L_en3
L_en3_r:
    s_cmp_le_u32 s76, 12
    s_cselect_b32 s61, s63, s62
    s_add_u32 s61, s61, 12288
    buffer_load_dwordx4 v[232:235], v6, s[8:11], s61 offen sc1
    buffer_load_dwordx4 v[236:239], v7, s[8:11], s61 offen sc1
    v_mfma_f32_16x16x32_bf16 v[28:31], v[88:91], v[144:147], v[28:31]
    v_mfma_f32_16x16x32_bf16 v[48:51], v[88:91], v[148:151], v[48:51]
    s_cmp_le_u32 s76, 13
    s_cselect_b32 s61, s63, s62
    s_add_u32 s61, s61, 13312
    buffer_load_dwordx4 v[240:243], v6, s[8:11], s61 offen sc1
    buffer_load_dwordx4 v[244:247], v7, s[8:11], s61 offen sc1
    v_mfma_f32_16x16x32_bf16 v[32:35], v[92:95], v[144:147], v[32:35]
    v_mfma_f32_16x16x32_bf16 v[52:55], v[92:95], v[148:151], v[52:55]
    s_waitcnt vmcnt(22) lgkmcnt(5)
    v_mfma_f32_16x16x32_bf16 v[16:19], v[96:99], v[152:155], v[16:19]
    ds_read_b128 v[56:59], v3 offset:20480
    v_mfma_f32_16x16x32_bf16 v[36:39], v[96:99], v[156:159], v[36:39]
    ds_read_b128 v[60:63], v3 offset:21504
    v_mfma_f32_16x16x32_bf16 v[20:23], v[100:103], v[152:155], v[20:23]
    ds_read_b128 v[64:67], v3 offset:22528
    v_mfma_f32_16x16x32_bf16 v[40:43], v[100:103], v[156:159], v[40:43]
    ds_read_b128 v[68:71], v3 offset:23552
    v_mfma_f32_16x16x32_bf16 v[24:27], v[104:107], v[152:155], v[24:27]
    ds_read_b128 v[72:75], v3 offset:24576
    v_mfma_f32_16x16x32_bf16 v[44:47], v[104:107], v[156:159], v[44:47]
    s_cmp_le_u32 s76, 14
    s_cselect_b32 s61, s63, s62
    s_add_u32 s61, s61, 14336
    buffer_load_dwordx4 v[136:139], v6, s[8:11], s61 offen sc1
    buffer_load_dwordx4 v[140:143], v7, s[8:11], s61 offen sc1
    v_mfma_f32_16x16x32_bf16 v[28:31], v[108:111], v[152:155], v[28:31]
    v_mfma_f32_16x16x32_bf16 v[48:51], v[108:111], v[156:159], v[48:51]
    v_mfma_f32_16x16x32_bf16 v[32:35], v[112:115], v[152:155], v[32:35]
    v_mfma_f32_16x16x32_bf16 v[52:55], v[112:115], v[156:159], v[52:55]
    s_waitcnt vmcnt(22) lgkmcnt(5)
    s_barrier
    v_mfma_f32_16x16x32_bf16 v[16:19], v[116:119], v[160:163], v[16:19]
    ds_read_b128 v[76:79], v3 offset:25600
    v_mfma_f32_16x16x32_bf16 v[36:39], v[116:119], v[164:167], v[36:39]
    ds_read_b128 v[80:83], v3 offset:26624
    v_mfma_f32_16x16x32_bf16 v[20:23], v[120:123], v[160:163], v[20:23]
    ds_read_b128 v[84:87], v3 offset:27648
    v_mfma_f32_16x16x32_bf16 v[40:43], v[120:123], v[164:167], v[40:43]
    ds_read_b128 v[88:91], v3 offset:28672
    v_mfma_f32_16x16x32_bf16 v[24:27], v[124:127], v[160:163], v[24:27]
    ds_read_b128 v[92:95], v3 offset:29696
    v_mfma_f32_16x16x32_bf16 v[44:47], v[124:127], v[164:167], v[44:47]
    s_cmp_le_u32 s76, 15
    s_cselect_b32 s61, s63, s62
    s_add_u32 s61, s61, 15360
    buffer_load_dwordx4 v[144:147], v6, s[8:11], s61 offen sc1
    buffer_load_dwordx4 v[148:151], v7, s[8:11], s61 offen sc1
    v_mfma_f32_16x16x32_bf16 v[28:31], v[128:131], v[160:163], v[28:31]
    v_mfma_f32_16x16x32_bf16 v[48:51], v[128:131], v[164:167], v[48:51]
    v_mfma_f32_16x16x32_bf16 v[32:35], v[132:135], v[160:163], v[32:35]
    v_mfma_f32_16x16x32_bf16 v[52:55], v[132:135], v[164:167], v[52:55]
    s_waitcnt vmcnt(22) lgkmcnt(5)
    v_mfma_f32_16x16x32_bf16 v[16:19], v[56:59], v[168:171], v[16:19]
    ds_read_b128 v[96:99], v3 offset:30720
    v_mfma_f32_16x16x32_bf16 v[36:39], v[56:59], v[172:175], v[36:39]
    ds_read_b128 v[100:103], v3 offset:31744
    v_mfma_f32_16x16x32_bf16 v[20:23], v[60:63], v[168:171], v[20:23]
    ds_read_b128 v[104:107], v3 offset:32768
    v_mfma_f32_16x16x32_bf16 v[40:43], v[60:63], v[172:175], v[40:43]
    ds_read_b128 v[108:111], v3 offset:33792
    v_mfma_f32_16x16x32_bf16 v[24:27], v[64:67], v[168:171], v[24:27]
    ds_read_b128 v[112:115], v3 offset:34816
    v_mfma_f32_16x16x32_bf16 v[44:47], v[64:67], v[172:175], v[44:47]
    s_and_b32 s67, s66, 0xf0000
    s_cbranch_scc1 L_en4
L_en4_r:
    s_cmp_le_u32 s76, 16
    s_cselect_b32 s61, s63, s62
    s_add_u32 s61, s61, 16384
    buffer_load_dwordx4 v[152:155], v6, s[8:11], s61 offen sc1
    buffer_load_dwordx4 v[156:159], v7, s[8:11], s61 offen sc1
    v_mfma_f32_16x16x32_bf16 v[28:31], v[68:71], v[168:171], v[28:31]
    v_mfma_f32_16x16x32_bf16 v[48:51], v[68:71], v[172:175], v[48:51]
    v_mfma_f32_16x16x32_bf16 v[32:35], v[72:75], v[168:171], v[32:35]
    v_mfma_f32_16x16x32_bf16 v[52:55], v[72:75], v[172:175], v[52:55]
    s_waitcnt vmcnt(22) lgkmcnt(5)
    v_mfma_f32_16x16x32_bf16 v[16:19], v[76:79], v[176:179], v[16:19]
    ds_read_b128 v[116:119], v3 offset:35840
    v_mfma_f32_16x16x32_bf16 v[36:39], v[76:79], v[180:183], v[36:39]
    ds_read_b128 v[120:123], v3 offset:36864
    v_mfma_f32_16x16x32_bf16 v[20:23], v[80:83], v[176:179], v[20:23]
    ds_read_b128 v[124:127], v3 offset:37888
    v_mfma_f32_16x16x32_bf16 v[40:43], v[80:83], v[180:183], v[40:43]
    ds_read_b128 v[128:131], v3 offset:38912
    v_mfma_f32_16x16x32_bf16 v[24:27], v[84:87], v[176:179], v[24:27]
    ds_read_b128 v[132:135], v3 offset:39936
    v_mfma_f32_16x16x32_bf16 v[44:47], v[84:87], v[180:183], v[44:47]
    s_cmp_le_u32 s76, 17
    s_cselect_b32 s61, s63, s62
    s_add_u32 s61, s61, 17408
    buffer_load_dwordx4 v[160:163], v6, s[8:11], s61 offen sc1
    buffer_load_dwordx4 v[164:167], v7, s[8:11], s61 offen sc1
    v_mfma_f32_16x16x32_bf16 v[28:31], v[88:91], v[176:179], v[28:31]
    v_mfma_f32_16x16x32_bf16 v[48:51], v[88:91], v[180:183], v[48:51]
    v_mfma_f32_16x16x32_bf16 v[32:35], v[92:95], v[176:179], v[32:35]
    v_mfma_f32_16x16x32_bf16 v[52:55], v[92:95], v[180:183], v[52:55]
    s_waitcnt vmcnt(22) lgkmcnt(5)
    v_mfma_f32_16x16x32_bf16 v[16:19], v[96:99], v[184:187], v[16:19]
    ds_read_b128 v[56:59], v3 offset:40960
    v_mfma_f32_16x16x32_bf16 v[36:39], v[96:99], v[188:191], v[36:39]
    ds_read_b128 v[60:63], v3 offset:41984
    v_mfma_f32_16x16x32_bf16 v[20:23], v[100:103], v[184:187], v[20:23]
    ds_read_b128 v[64:67], v3 offset:43008
    v_mfma_f32_16x16x32_bf16 v[40:43], v[100:103], v[188:191], v[40:43]
    ds_read_b128 v[68:71], v3 offset:44032
    v_mfma_f32_16x16x32_bf16 v[24:27], v[104:107], v[184:187], v[24:27]
    ds_read_b128 v[72:75], v3 offset:45056
    v_mfma_f32_16x16x32_bf16 v[44:47], v[104:107], v[188:191], v[44:47]
    s_cmp_le_u32 s76, 18
    s_cselect_b32 s61, s63, s62
    s_add_u32 s61, s61, 18432
    buffer_load_dwordx4 v[168:171], v6, s[8:11], s61 offen sc1
    buffer_load_dwordx4 v[172:175], v7, s[8:11], s61 offen sc1
    v_mfma_f32_16x16x32_bf16 v[28:31], v[108:111], v[184:187], v[28:31]
    v_mfma_f32_16x16x32_bf16 v[48:51], v[108:111], v[188:191], v[48:51]
    v_mfma_f32_16x16x32_bf16 v[32:35], v[112:115], v[184:187], v[32:35]
    v_mfma_f32_16x16x32_bf16 v[52:55], v[112:115], v[188:191], v[52:55]
    s_waitcnt vmcnt(22) lgkmcnt(5)
    s_barrier
    v_mfma_f32_16x16x32_bf16 v[16:19], v[116:119], v[192:195], v[16:19]
    ds_read_b128 v[76:79], v3 offset:46080
    v_mfma_f32_16x16x32_bf16 v[36:39], v[116:119], v[196:199], v[36:39]
    ds_read_b128 v[80:83], v3 offset:47104
    v_mfma_f32_16x16x32_bf16 v[20:23], v[120:123], v[192:195], v[20:23]
    ds_read_b128 v[84:87], v3 offset:48128
    v_mfma_f32_16x16x32_bf16 v[40:43], v[120:123], v[196:199], v[40:43]
    ds_read_b128 v[88:91], v3 offset:49152
    v_mfma_f32_16x16x32_bf16 v[24:27], v[124:127], v[192:195], v[24:27]
    ds_read_b128 v[92:95], v3 offset:50176
    v_mfma_f32_16x16x32_bf16 v[44:47], v[124:127], v[196:199], v[44:47]
    s_cmp_le_u32 s76, 19
    s_cselect_b32 s61, s63, s62
    s_add_u32 s61, s61, 19456
    buffer_load_dwordx4 v[176:179], v6, s[8:11], s61 offen sc1
    buffer_load_dwordx4 v[180:183], v7, s[8:11], s61 offen sc1
    v_mfma_f32_16x16x32_bf16 v[28:31], v[128:131], v[192:195], v[28:31]
    v_mfma_f32_16x16x32_bf16 v[48:51], v[128:131], v[196:199], v[48:51]
    v_mfma_f32_16x16x32_bf16 v[32:35], v[132:135], v[192:195], v[32:35]
    v_mfma_f32_16x16x32_bf16 v[52:55], v[132:135], v[196:199], v[52:55]
    s_waitcnt vmcnt(22) lgkmcnt(5)
    v_mfma_f32_16x16x32_bf16 v[16:19], v[56:59], v[200:203], v[16:19]
    ds_read_b128 v[96:99], v4 offset:0
    v_mfma_f32_16x16x32_bf16 v[36:39], v[56:59], v[204:207], v[36:39]
    ds_read_b128 v[100:103], v4 offset:1024
    v_mfma_f32_16x16x32_bf16 v[20:23], v[60:63], v[200:203], v[20:23]
    ds_read_b128 v[104:107], v4 offset:2048
    v_mfma_f32_16x16x32_bf16 v[40:43], v[60:63], v[204:207], v[40:43]
    ds_read_b128 v[108:111], v4 offset:3072
    v_mfma_f32_16x16x32_bf16 v[24:27], v[64:67], v[200:203], v[24:27]
    ds_read_b128 v[112:115], v4 offset:4096
    v_mfma_f32_16x16x32_bf16 v[44:47], v[64:67], v[204:207], v[44:47]
    s_and_b32 s67, s66, 0xf00000
    s_cbranch_scc1 L_en5
L_en5_r:
    s_cmp_le_u32 s76, 20
    s_cselect_b32 s61, s63, s62
    s_add_u32 s61, s61, 20480
    buffer_load_dwordx4 v[184:187], v6, s[8:11], s61 offen sc1
    buffer_load_dwordx4 v[188:191], v7, s[8:11], s61 offen sc1
    v_mfma_f32_16x16x32_bf16 v[28:31], v[68:71], v[200:203], v[28:31]
    v_mfma_f32_16x16x32_bf16 v[48:51], v[68:71], v[204:207], v[48:51]
    v_mfma_f32_16x16x32_bf16 v[32:35], v[72:75], v[200:203], v[32:35]
    v_mfma_f32_16x16x32_bf16 v[52:55], v[72:75], v[204:207], v[52:55]
    s_waitcnt vmcnt(22) lgkmcnt(5)
    v_mfma_f32_16x16x32_bf16 v[16:19], v[76:79], v[208:211], v[16:19]
    ds_read_b128 v[116:119], v4 offset:5120
    v_mfma_f32_16x16x32_bf16 v[36:39], v[76:79], v[212:215], v[36:39]
    ds_read_b128 v[120:123], v4 offset:6144
    v_mfma_f32_16x16x32_bf16 v[20:23], v[80:83], v[208:211], v[20:23]
    ds_read_b128 v[124:127], v4 offset:7168
    v_mfma_f32_16x16x32_bf16 v[40:43], v[80:83], v[212:215], v[40:43]
    ds_read_b128 v[128:131], v4 offset:8192
    v_mfma_f32_16x16x32_bf16 v[24:27], v[84:87], v[208:211], v[24:27]
    ds_read_b128 v[132:135], v4 offset:9216
    v_mfma_f32_16x16x32_bf16 v[44:47], v[84:87], v[212:215], v[44:47]
    s_cmp_le_u32 s76, 21
    s_cselect_b32 s61, s63, s62
    s_add_u32 s61, s61, 21504
    buffer_load_dwordx4 v[192:195], v6, s[8:11], s61 offen sc1
    buffer_load_dwordx4 v[196:199], v7, s[8:11], s61 offen sc1
    v_mfma_f32_16x16x32_bf16 v[28:31], v[88:91], v[208:211], v[28:31]
    v_mfma_f32_16x16x32_bf16 v[48:51], v[88:91], v[212:215], v[48:51]
    v_mfma_f32_16x16x32_bf16 v[32:35], v[92:95], v[208:211], v[32:35]
    v_mfma_f32_16x16x32_bf16 v[52:55], v[92:95], v[212:215], v[52:55]
    s_waitcnt vmcnt(22) lgkmcnt(5)
    v_mfma_f32_16x16x32_bf16 v[16:19], v[96:99], v[216:219], v[16:19]
    ds_read_b128 v[56:59], v4 offset:10240
    v_mfma_f32_16x16x32_bf16 v[36:39], v[96:99], v[220:223], v[36:39]
    ds_read_b128 v[60:63], v4 offset:11264
    v_mfma_f32_16x16x32_bf16 v[20:23], v[100:103], v[216:219], v[20:23]
    ds_read_b128 v[64:67], v4 offset:12288
    v_mfma_f32_16x16x32_bf16 v[40:43], v[100:103], v[220:223], v[40:43]
    ds_read_b128 v[68:71], v4 offset:13312
    v_mfma_f32_16x16x32_bf16 v[24:27], v[104:107], v[216:219], v[24:27]
    ds_read_b128 v[72:75], v4 offset:14336
    v_mfma_f32_16x16x32_bf16 v[44:47], v[104:107], v[220:223], v[44:47]
    s_cmp_le_u32 s76, 22
    s_cselect_b32 s61, s63, s62
    s_add_u32 s61, s61, 22528
    buffer_load_dwordx4 v[200:203], v6, s[8:11], s61 offen sc1
    buffer_load_dwordx4 v[204:207], v7, s[8:11], s61 offen sc1
    v_mfma_f32_16x16x32_bf16 v[28:31], v[108:111], v[216:219], v[28:31]
    v_mfma_f32_16x16x32_bf16 v[48:51], v[108:111], v[220:223], v[48:51]
    v_mfma_f32_16x16x32_bf16 v[32:35], v[112:115], v[216:219], v[32:35]
    v_mfma_f32_16x16x32_bf16 v[52:55], v[112:115], v[220:223], v[52:55]
    s_waitcnt vmcnt(22) lgkmcnt(5)
    s_barrier
    v_mfma_f32_16x16x32_bf16 v[16:19], v[116:119], v[224:227], v[16:19]
    ds_read_b128 v[76:79], v4 offset:15360
    v_mfma_f32_16x16x32_bf16 v[36:39], v[116:119], v[228:231], v[36:39]
    ds_read_b128 v[80:83], v4 offset:16384
    v_mfma_f32_16x16x32_bf16 v[20:23], v[120:123], v[224:227], v[20:23]
    ds_read_b128 v[84:87], v4 offset:17408
    v_mfma_f32_16x16x32_bf16 v[40:43], v[120:123], v[228:231], v[40:43]
    ds_read_b128 v[88:91], v4 offset:18432
    v_mfma_f32_16x16x32_bf16 v[24:27], v[124:127], v[224:227], v[24:27]
    ds_read_b128 v[92:95], v4 offset:19456
    v_mfma_f32_16x16x32_bf16 v[44:47], v[124:127], v[228:231], v[44:47]
    s_cmp_le_u32 s76, 23
    s_cselect_b32 s61, s63, s62
    s_add_u32 s61, s61, 23552
    buffer_load_dwordx4 v[208:211], v6, s[8:11], s61 offen sc1
    buffer_load_dwordx4 v[212:215], v7, s[8:11], s61 offen sc1
    v_mfma_f32_16x16x32_bf16 v[28:31], v[128:131], v[224:227], v[28:31]
    v_mfma_f32_16x16x32_bf16 v[48:51], v[128:131], v[228:231], v[48:51]
    v_mfma_f32_16x16x32_bf16 v[32:35], v[132:135], v[224:227], v[32:35]
    v_mfma_f32_16x16x32_bf16 v[52:55], v[132:135], v[228:231], v[52:55]
    s_waitcnt vmcnt(22) lgkmcnt(5)
    v_mfma_f32_16x16x32_bf16 v[16:19], v[56:59], v[232:235], v[16:19]
    ds_read_b128 v[96:99], v3 offset:0
    v_mfma_f32_16x16x32_bf16 v[36:39], v[56:59], v[236:239], v[36:39]
    ds_read_b128 v[100:103], v3 offset:1024
    v_mfma_f32_16x16x32_bf16 v[20:23], v[60:63], v[232:235], v[20:23]
    ds_read_b128 v[104:107], v3 offset:2048
    v_mfma_f32_16x16x32_bf16 v[40:43], v[60:63], v[236:239], v[40:43]
    ds_read_b128 v[108:111], v3 offset:3072
    v_mfma_f32_16x16x32_bf16 v[24:27], v[64:67], v[232:235], v[24:27]
    ds_read_b128 v[112:115], v3 offset:4096
    v_mfma_f32_16x16x32_bf16 v[44:47], v[64:67], v[236:239], v[44:47]
    v_mfma_f32_16x16x32_bf16 v[28:31], v[68:71], v[232:235], v[28:31]
    v_mfma_f32_16x16x32_bf16 v[48:51], v[68:71], v[236:239], v[48:51]
    v_mfma_f32_16x16x32_bf16 v[32:35], v[72:75], v[232:235], v[32:35]
    v_mfma_f32_16x16x32_bf16 v[52:55], v[72:75], v[236:239], v[52:55]
    s_waitcnt vmcnt(20) lgkmcnt(5)
    v_mfma_f32_16x16x32_bf16 v[16:19], v[76:79], v[240:243], v[16:19]
    ds_read_b128 v[116:119], v3 offset:5120
    v_mfma_f32_16x16x32_bf16 v[36:39], v[76:79], v[244:247], v[36:39]
    ds_read_b128 v[120:123], v3 offset:6144
    v_mfma_f32_16x16x32_bf16 v[20:23], v[80:83], v[240:243], v[20:23]
    ds_read_b128 v[124:127], v3 offset:7168
    v_mfma_f32_16x16x32_bf16 v[40:43], v[80:83], v[244:247], v[40:43]
    ds_read_b128 v[128:131], v3 offset:8192
    v_mfma_f32_16x16x32_bf16 v[24:27], v[84:87], v[240:243], v[24:27]
    ds_read_b128 v[132:135], v3 offset:9216
    v_mfma_f32_16x16x32_bf16 v[44:47], v[84:87], v[244:247], v[44:47]
    v_mfma_f32_16x16x32_bf16 v[28:31], v[88:91], v[240:243], v[28:31]
    v_mfma_f32_16x16x32_bf16 v[48:51], v[88:91], v[244:247], v[48:51]
    v_mfma_f32_16x16x32_bf16 v[32:35], v[92:95], v[240:243], v[32:35]
    v_mfma_f32_16x16x32_bf16 v[52:55], v[92:95], v[244:247], v[52:55]
    s_waitcnt vmcnt(18) lgkmcnt(5)
    v_mfma_f32_16x16x32_bf16 v[16:19], v[96:99], v[136:139], v[16:19]
    ds_read_b128 v[56:59], v3 offset:10240
    v_mfma_f32_16x16x32_bf16 v[36:39], v[96:99], v[140:143], v[36:39]
    ds_read_b128 v[60:63], v3 offset:11264
    v_mfma_f32_16x16x32_bf16 v[20:23], v[100:103], v[136:139], v[20:23]
    ds_read_b128 v[64:67], v3 offset:12288
    v_mfma_f32_16x16x32_bf16 v[40:43], v[100:103], v[140:143], v[40:43]
    ds_read_b128 v[68:71], v3 offset:13312
    v_mfma_f32_16x16x32_bf16 v[24:27], v[104:107], v[136:139], v[24:27]
    ds_read_b128 v[72:75], v3 offset:14336
    v_mfma_f32_16x16x32_bf16 v[44:47], v[104:107], v[140:143], v[44:47]
    v_mfma_f32_16x16x32_bf16 v[28:31], v[108:111], v[136:139], v[28:31]
    v_mfma_f32_16x16x32_bf16 v[48:51], v[108:111], v[140:143], v[48:51]
    v_mfma_f32_16x16x32_bf16 v[32:35], v[112:115], v[136:139], v[32:35]
    v_mfma_f32_16x16x32_bf16 v[52:55], v[112:115], v[140:143], v[52:55]
    s_waitcnt vmcnt(16) lgkmcnt(5)
    s_barrier
    v_mfma_f32_16x16x32_bf16 v[16:19], v[116:119], v[144:147], v[16:19]
    ds_read_b128 v[76:79], v3 offset:15360
    v_mfma_f32_16x16x32_bf16 v[36:39], v[116:119], v[148:151], v[36:39]
    ds_read_b128 v[80:83], v3 offset:16384
    v_mfma_f32_16x16x32_bf16 v[20:23], v[120:123], v[144:147], v[20:23]
    ds_read_b128 v[84:87], v3 offset:17408
    v_mfma_f32_16x16x32_bf16 v[40:43], v[120:123], v[148:151], v[40:43]
    ds_read_b128 v[88:91], v3 offset:18432
    v_mfma_f32_16x16x32_bf16 v[24:27], v[124:127], v[144:147], v[24:27]
    ds_read_b128 v[92:95], v3 offset:19456
    v_mfma_f32_16x16x32_bf16 v[44:47], v[124:127], v[148:151], v[44:47]
    v_mfma_f32_16x16x32_bf16 v[28:31], v[128:131], v[144:147], v[28:31]
    v_mfma_f32_16x16x32_bf16 v[48:51], v[128:131], v[148:151], v[48:51]
    v_mfma_f32_16x16x32_bf16 v[32:35], v[132:135], v[144:147], v[32:35]
    v_mfma_f32_16x16x32_bf16 v[52:55], v[132:135], v[148:151], v[52:55]
    s_waitcnt vmcnt(14) lgkmcnt(5)
    v_mfma_f32_16x16x32_bf16 v[16:19], v[56:59], v[152:155], v[16:19]
    ds_read_b128 v[96:99], v3 offset:20480
    v_mfma_f32_16x16x32_bf16 v[36:39], v[56:59], v[156:159], v[36:39]
    ds_read_b128 v[100:103], v3 offset:21504
    v_mfma_f32_16x16x32_bf16 v[20:23], v[60:63], v[152:155], v[20:23]
    ds_read_b128 v[104:107], v3 offset:22528
    v_mfma_f32_16x16x32_bf16 v[40:43], v[60:63], v[156:159], v[40:43]
    ds_read_b128 v[108:111], v3 offset:23552
    v_mfma_f32_16x16x32_bf16 v[24:27], v[64:67], v[152:155], v[24:27]
    ds_read_b128 v[112:115], v3 offset:24576
    v_mfma_f32_16x16x32_bf16 v[44:47], v[64:67], v[156:159], v[44:47]
    v_mfma_f32_16x16x32_bf16 v[28:31], v[68:71], v[152:155], v[28:31]
    v_mfma_f32_16x16x32_bf16 v[48:51], v[68:71], v[156:159], v[48:51]
    v_mfma_f32_16x16x32_bf16 v[32:35], v[72:75], v[152:155], v[32:35]
    v_mfma_f32_16x16x32_bf16 v[52:55], v[72:75], v[156:159], v[52:55]
    s_waitcnt vmcnt(12) lgkmcnt(5)
    v_mfma_f32_16x16x32_bf16 v[16:19], v[76:79], v[160:163], v[16:19]
    ds_read_b128 v[116:119], v3 offset:25600
    v_mfma_f32_16x16x32_bf16 v[36:39], v[76:79], v[164:167], v[36:39]
    ds_read_b128 v[120:123], v3 offset:26624
    v_mfma_f32_16x16x32_bf16 v[20:23], v[80:83], v[160:163], v[20:23]
    ds_read_b128 v[124:127], v3 offset:27648
    v_mfma_f32_16x16x32_bf16 v[40:43], v[80:83], v[164:167], v[40:43]
    ds_read_b128 v[128:131], v3 offset:28672
    v_mfma_f32_16x16x32_bf16 v[24:27], v[84:87], v[160:163], v[24:27]
    ds_read_b128 v[132:135], v3 offset:29696
    v_mfma_f32_16x16x32_bf16 v[44:47], v[84:87], v[164:167], v[44:47]
    v_mfma_f32_16x16x32_bf16 v[28:31], v[88:91], v[160:163], v[28:31]
    v_mfma_f32_16x16x32_bf16 v[48:51], v[88:91], v[164:167], v[48:51]
    v_mfma_f32_16x16x32_bf16 v[32:35], v[92:95], v[160:163], v[32:35]
    v_mfma_f32_16x16x32_bf16 v[52:55], v[92:95], v[164:167], v[52:55]
    s_waitcnt vmcnt(10) lgkmcnt(5)
    v_mfma_f32_16x16x32_bf16 v[16:19], v[96:99], v[168:171], v[16:19]
    ds_read_b128 v[56:59], v3 offset:30720
    v_mfma_f32_16x16x32_bf16 v[36:39], v[96:99], v[172:175], v[36:39]
    ds_read_b128 v[60:63], v3 offset:31744
    v_mfma_f32_16x16x32_bf16 v[20:23], v[100:103], v[168:171], v[20:23]
    ds_read_b128 v[64:67], v3 offset:32768
    v_mfma_f32_16x16x32_bf16 v[40:43], v[100:103], v[172:175], v[40:43]
    ds_read_b128 v[68:71], v3 offset:33792
    v_mfma_f32_16x16x32_bf16 v[24:27], v[104:107], v[168:171], v[24:27]
    ds_read_b128 v[72:75], v3 offset:34816
    v_mfma_f32_16x16x32_bf16 v[44:47], v[104:107], v[172:175], v[44:47]
    v_mfma_f32_16x16x32_bf16 v[28:31], v[108:111], v[168:171], v[28:31]
    v_mfma_f32_16x16x32_bf16 v[48:51], v[108:111], v[172:175], v[48:51]
    v_mfma_f32_16x16x32_bf16 v[32:35], v[112:115], v[168:171], v[32:35]
    v_mfma_f32_16x16x32_bf16 v[52:55], v[112:115], v[172:175], v[52:55]
    s_waitcnt vmcnt(8) lgkmcnt(5)
    s_barrier
    v_mfma_f32_16x16x32_bf16 v[16:19], v[116:119], v[176:179], v[16:19]
    ds_read_b128 v[76:79], v3 offset:35840
    v_mfma_f32_16x16x32_bf16 v[36:39], v[116:119], v[180:183], v[36:39]
    ds_read_b128 v[80:83], v3 offset:36864
    v_mfma_f32_16x16x32_bf16 v[20:23], v[120:123], v[176:179], v[20:23]
    ds_read_b128 v[84:87], v3 offset:37888
    v_mfma_f32_16x16x32_bf16 v[40:43], v[120:123], v[180:183], v[40:43]
    ds_read_b128 v[88:91], v3 offset:38912
    v_mfma_f32_16x16x32_bf16 v[24:27], v[124:127], v[176:179], v[24:27]
    ds_read_b128 v[92:95], v3 offset:39936
    v_mfma_f32_16x16x32_bf16 v[44:47], v[124:127], v[180:183], v[44:47]
    v_mfma_f32_16x16x32_bf16 v[28:31], v[128:131], v[176:179], v[28:31]
    v_mfma_f32_16x16x32_bf16 v[48:51], v[128:131], v[180:183], v[48:51]
    v_mfma_f32_16x16x32_bf16 v[32:35], v[132:135], v[176:179], v[32:35]
    v_mfma_f32_16x16x32_bf16 v[52:55], v[132:135], v[180:183], v[52:55]
    s_waitcnt vmcnt(6) lgkmcnt(5)
    v_mfma_f32_16x16x32_bf16 v[16:19], v[56:59], v[184:187], v[16:19]
    ds_read_b128 v[96:99], v3 offset:40960
    v_mfma_f32_16x16x32_bf16 v[36:39], v[56:59], v[188:191], v[36:39]
    ds_read_b128 v[100:103], v3 offset:41984
    v_mfma_f32_16x16x32_bf16 v[20:23], v[60:63], v[184:187], v[20:23]
    ds_read_b128 v[104:107], v3 offset:43008
    v_mfma_f32_16x16x32_bf16 v[40:43], v[60:63], v[188:191], v[40:43]
    ds_read_b128 v[108:111], v3 offset:44032
    v_mfma_f32_16x16x32_bf16 v[24:27], v[64:67], v[184:187], v[24:27]
    ds_read_b128 v[112:115], v3 offset:45056
    v_mfma_f32_16x16x32_bf16 v[44:47], v[64:67], v[188:191], v[44:47]
    v_mfma_f32_16x16x32_bf16 v[28:31], v[68:71], v[184:187], v[28:31]
    v_mfma_f32_16x16x32_bf16 v[48:51], v[68:71], v[188:191], v[48:51]
    v_mfma_f32_16x16x32_bf16 v[32:35], v[72:75], v[184:187], v[32:35]
    v_mfma_f32_16x16x32_bf16 v[52:55], v[72:75], v[188:191], v[52:55]
    s_waitcnt vmcnt(4) lgkmcnt(5)
    v_mfma_f32_16x16x32_bf16 v[16:19], v[76:79], v[192:195], v[16:19]
    ds_read_b128 v[116:119], v3 offset:46080
    v_mfma_f32_16x16x32_bf16 v[36:39], v[76:79], v[196:199], v[36:39]
    ds_read_b128 v[120:123], v3 offset:47104
    v_mfma_f32_16x16x32_bf16 v[20:23], v[80:83], v[192:195], v[20:23]
    ds_read_b128 v[124:127], v3 offset:48128
    v_mfma_f32_16x16x32_bf16 v[40:43], v[80:83], v[196:199], v[40:43]
    ds_read_b128 v[128:131], v3 offset:49152
    v_mfma_f32_16x16x32_bf16 v[24:27], v[84:87], v[192:195], v[24:27]
    ds_read_b128 v[132:135], v3 offset:50176
    v_mfma_f32_16x16x32_bf16 v[44:47], v[84:87], v[196:199], v[44:47]
    v_mfma_f32_16x16x32_bf16 v[28:31], v[88:91], v[192:195], v[28:31]
    v_mfma_f32_16x16x32_bf16 v[48:51], v[88:91], v[196:199], v[48:51]
    v_mfma_f32_16x16x32_bf16 v[32:35], v[92:95], v[192:195], v[32:35]
    v_mfma_f32_16x16x32_bf16 v[52:55], v[92:95], v[196:199], v[52:55]
    s_waitcnt vmcnt(2) lgkmcnt(5)
    v_mfma_f32_16x16x32_bf16 v[16:19], v[96:99], v[200:203], v[16:19]
    v_mfma_f32_16x16x32_bf16 v[36:39], v[96:99], v[204:207], v[36:39]
    v_mfma_f32_16x16x32_bf16 v[20:23], v[100:103], v[200:203], v[20:23]
    v_mfma_f32_16x16x32_bf16 v[40:43], v[100:103], v[204:207], v[40:43]
    v_mfma_f32_16x16x32_bf16 v[24:27], v[104:107], v[200:203], v[24:27]
    v_mfma_f32_16x16x32_bf16 v[44:47], v[104:107], v[204:207], v[44:47]
    v_mfma_f32_16x16x32_bf16 v[28:31], v[108:111], v[200:203], v[28:31]
    v_mfma_f32_16x16x32_bf16 v[48:51], v[108:111], v[204:207], v[48:51]
    v_mfma_f32_16x16x32_bf16 v[32:35], v[112:115], v[200:203], v[32:35]
    v_mfma_f32_16x16x32_bf16 v[52:55], v[112:115], v[204:207], v[52:55]
    s_waitcnt vmcnt(0) lgkmcnt(0)
    v_mfma_f32_16x16x32_bf16 v[16:19], v[116:119], v[208:211], v[16:19]
    v_mfma_f32_16x16x32_bf16 v[36:39], v[116:119], v[212:215], v[36:39]
    v_mfma_f32_16x16x32_bf16 v[20:23], v[120:123], v[208:211], v[20:23]
    v_mfma_f32_16x16x32_bf16 v[40:43], v[120:123], v[212:215], v[40:43]
    v_mfma_f32_16x16x32_bf16 v[24:27], v[124:127], v[208:211], v[24:27]
    v_mfma_f32_16x16x32_bf16 v[44:47], v[124:127], v[212:215], v[44:47]
    v_mfma_f32_16x16x32_bf16 v[28:31], v[128:131], v[208:211], v[28:31]
    v_mfma_f32_16x16x32_bf16 v[48:51], v[128:131], v[212:215], v[48:51]
    v_mfma_f32_16x16x32_bf16 v[32:35], v[132:135], v[208:211], v[32:35]
    v_mfma_f32_16x16x32_bf16 v[52:55], v[132:135], v[212:215], v[52:55]
    s_nop 6
    ds_write_b128 v9, v[36:39] offset:0
    ds_write_b128 v9, v[40:43] offset:1024
    ds_write_b128 v9, v[44:47] offset:2048
    ds_write_b128 v9, v[48:51] offset:3072
    ds_write_b128 v9, v[52:55] offset:4096
    s_waitcnt lgkmcnt(0)
    s_barrier
    ds_read_b128 v[56:59], v1 offset:0
    ds_read_b128 v[60:63], v1 offset:5120
    ds_read_b128 v[64:67], v5 offset:0
    ds_read_b128 v[68:71], v1 offset:1024
    ds_read_b128 v[72:75], v1 offset:6144
    ds_read_b128 v[76:79], v5 offset:1024
    ds_read_b128 v[80:83], v1 offset:2048
    ds_read_b128 v[84:87], v1 offset:7168
    ds_read_b128 v[88:91], v5 offset:2048
    ds_read_b128 v[92:95], v1 offset:3072
    ds_read_b128 v[96:99], v1 offset:8192
    ds_read_b128 v[100:103], v5 offset:3072
    ds_read_b128 v[104:107], v1 offset:4096
    ds_read_b128 v[108:111], v1 offset:9216
    ds_read_b128 v[112:115], v5 offset:4096
    s_waitcnt lgkmcnt(12)
    v_pk_add_f32 v[56:57], v[56:57], v[60:61]
    v_pk_add_f32 v[16:17], v[16:17], v[64:65]
    v_pk_add_f32 v[58:59], v[58:59], v[62:63]
    v_pk_add_f32 v[18:19], v[18:19], v[66:67]
    v_pk_add_f32 v[16:17], v[16:17], v[56:57]
    v_pk_add_f32 v[18:19], v[18:19], v[58:59]
    s_nop 1
    v_permlane32_swap_b32 v16, v18
    v_permlane32_swap_b32 v17, v19
    v_cvt_pk_bf16_f32 v36, v16, v18
    v_cvt_pk_bf16_f32 v37, v17, v19
    ds_write_b64 v8, v[36:37] offset:0
    s_waitcnt lgkmcnt(10)
    v_pk_add_f32 v[68:69], v[68:69], v[72:73]
    v_pk_add_f32 v[20:21], v[20:21], v[76:77]
    v_pk_add_f32 v[70:71], v[70:71], v[74:75]
    v_pk_add_f32 v[22:23], v[22:23], v[78:79]
    v_pk_add_f32 v[20:21], v[20:21], v[68:69]
    v_pk_add_f32 v[22:23], v[22:23], v[70:71]
    s_nop 1
    v_permlane32_swap_b32 v20, v22
    v_permlane32_swap_b32 v21, v23
    v_cvt_pk_bf16_f32 v40, v20, v22
    v_cvt_pk_bf16_f32 v41, v21, v23
    ds_write_b64 v8, v[40:41] offset:32
    s_waitcnt lgkmcnt(8)
    v_pk_add_f32 v[80:81], v[80:81], v[84:85]
    v_pk_add_f32 v[24:25], v[24:25], v[88:89]
    v_pk_add_f32 v[82:83], v[82:83], v[86:87]
    v_pk_add_f32 v[26:27], v[26:27], v[90:91]
    v_pk_add_f32 v[24:25], v[24:25], v[80:81]
    v_pk_add_f32 v[26:27], v[26:27], v[82:83]
    s_nop 1
    v_permlane32_swap_b32 v24, v26
    v_permlane32_swap_b32 v25, v27
    v_cvt_pk_bf16_f32 v44, v24, v26
    v_cvt_pk_bf16_f32 v45, v25, v27
    ds_write_b64 v8, v[44:45] offset:64
    s_waitcnt lgkmcnt(6)
    v_pk_add_f32 v[92:93], v[92:93], v[96:97]
    v_pk_add_f32 v[28:29], v[28:29], v[100:101]
    v_pk_add_f32 v[94:95], v[94:95], v[98:99]
    v_pk_add_f32 v[30:31], v[30:31], v[102:103]
    v_pk_add_f32 v[28:29], v[28:29], v[92:93]
    v_pk_add_f32 v[30:31], v[30:31], v[94:95]
    s_nop 1
    v_permlane32_swap_b32 v28, v30
    v_permlane32_swap_b32 v29, v31
    v_cvt_pk_bf16_f32 v48, v28, v30
    v_cvt_pk_bf16_f32 v49, v29, v31
    ds_write_b64 v8, v[48:49] offset:96
    s_waitcnt lgkmcnt(4)
    v_pk_add_f32 v[104:105], v[104:105], v[108:109]
    v_pk_add_f32 v[32:33], v[32:33], v[112:113]
    v_pk_add_f32 v[106:107], v[106:107], v[110:111]
    v_pk_add_f32 v[34:35], v[34:35], v[114:115]
    v_pk_add_f32 v[32:33], v[32:33], v[104:105]
    v_pk_add_f32 v[34:35], v[34:35], v[106:107]
    s_nop 1
    v_permlane32_swap_b32 v32, v34
    v_permlane32_swap_b32 v33, v35
    v_cvt_pk_bf16_f32 v52, v32, v34
    v_cvt_pk_bf16_f32 v53, v33, v35
    ds_write_b64 v8, v[52:53] offset:128
    s_waitcnt lgkmcnt(0)
    ds_read_b128 v[56:59], v13
    ds_read_b128 v[60:63], v14
    ds_read_b128 v[64:67], v15
    s_waitcnt lgkmcnt(2)
    buffer_store_dwordx4 v[56:59], v10, s[16:19], s60 offen
    s_waitcnt lgkmcnt(1)
    buffer_store_dwordx4 v[60:63], v11, s[16:19], s60 offen
    s_waitcnt lgkmcnt(0)
    buffer_store_dwordx4 v[64:67], v12, s[16:19], s60 offen
    s_endpgm
L_en0:
    s_mov_b32 s53, 0
L_en0_l:
    buffer_load_dwordx2 v[254:255], v250, s[8:11], s64 offen sc1
    s_add_u32 s53, s53, 1
    s_cmp_gt_u32 s53, 0x100000
    s_cbranch_scc1 L_en0_r
    s_waitcnt vmcnt(0)
    v_cmp_ne_u64 vcc, s[12:13], v[254:255]
    s_nop 1
    s_mov_b32 s66, vcc_lo
    s_and_b32 s67, s66, 0xf
    s_cbranch_scc0 L_en0_r
    s_sleep 1
    s_branch L_en0_l
L_en1:
    s_mov_b32 s53, 0
L_en1_l:
    buffer_load_dwordx2 v[254:255], v250, s[8:11], s64 offen sc1
    s_add_u32 s53, s53, 1
    s_cmp_gt_u32 s53, 0x100000
    s_cbranch_scc1 L_en1_r
    s_waitcnt vmcnt(0)
    v_cmp_ne_u64 vcc, s[12:13], v[254:255]
    s_nop 1
    s_mov_b32 s66, vcc_lo
    s_and_b32 s67, s66, 0xf0
    s_cbranch_scc0 L_en1_r
    s_sleep 1
    s_branch L_en1_l
L_en2:
    s_mov_b32 s53, 0
L_en2_l:
    buffer_load_dwordx2 v[254:255], v250, s[8:11], s64 offen sc1
    s_add_u32 s53, s53, 1
    s_cmp_gt_u32 s53, 0x100000
    s_cbranch_scc1 L_en2_r
    s_waitcnt vmcnt(0)
    v_cmp_ne_u64 vcc, s[12:13], v[254:255]
    s_nop 1
    s_mov_b32 s66, vcc_lo
    s_and_b32 s67, s66, 0xf00
    s_cbranch_scc0 L_en2_r
    s_sleep 1
    s_branch L_en2_l
L_en3:
    s_mov_b32 s53, 0
L_en3_l:
    buffer_load_dwordx2 v[254:255], v250, s[8:11], s64 offen sc1
    s_add_u32 s53, s53, 1
    s_cmp_gt_u32 s53, 0x100000
    s_cbranch_scc1 L_en3_r
    s_waitcnt vmcnt(0)
    v_cmp_ne_u64 vcc, s[12:13], v[254:255]
    s_nop 1
    s_mov_b32 s66, vcc_lo
    s_and_b32 s67, s66, 0xf000
    s_cbranch_scc0 L_en3_r
    s_sleep 1
    s_branch L_en3_l
L_en4:
    s_mov_b32 s53, 0
L_en4_l:
    buffer_load_dwordx2 v[254:255], v250, s[8:11], s64 offen sc1
    s_add_u32 s53, s53, 1
    s_cmp_gt_u32 s53, 0x100000
    s_cbranch_scc1 L_en4_r
    s_waitcnt vmcnt(0)
    v_cmp_ne_u64 vcc, s[12:13], v[254:255]
    s_nop 1
    s_mov_b32 s66, vcc_lo
    s_and_b32 s67, s66, 0xf0000
    s_cbranch_scc0 L_en4_r
    s_sleep 1
    s_branch L_en4_l
L_en5:
    s_mov_b32 s53, 0
L_en5_l:
    buffer_load_dwordx2 v[254:255], v250, s[8:11], s64 offen sc1
    s_add_u32 s53, s53, 1
    s_cmp_gt_u32 s53, 0x100000
    s_cbranch_scc1 L_en5_r
    s_waitcnt vmcnt(0)
    v_cmp_ne_u64 vcc, s[12:13], v[254:255]
    s_nop 1
    s_mov_b32 s66, vcc_lo
    s_and_b32 s67, s66, 0xf00000
    s_cbranch_scc0 L_en5_r
    s_sleep 1
    s_branch L_en5_l
L_end:
    s_endpgm
.section .rodata,"a"
.p2align 6
.amdhsa_kernel parallel_sum__spectral_fnet__swiglu_ffn__prompt_kernel
  .amdhsa_next_free_vgpr 256
  .amdhsa_next_free_sgpr 102
  .amdhsa_accum_offset 256
  .amdhsa_group_segment_fixed_size 0
  .amdhsa_kernarg_size 96
  .amdhsa_user_sgpr_count 2
  .amdhsa_user_sgpr_kernarg_segment_ptr 1
  .amdhsa_system_sgpr_workgroup_id_x 1
.end_amdhsa_kernel
```
